```python
import torch

def _softmax(x, axis=-1):
    return torch.softmax(x, dim=axis)
def _gelu(x):
    return torch.nn.functional.gelu(x, approximate="tanh")
def _silu(x):
    return torch.nn.functional.silu(x)
def _sigmoid(x):
    return torch.sigmoid(x)
def _layernorm(x, axis=-1, eps=1e-5):
    m = x.mean(dim=axis, keepdim=True)
    v = x.var(dim=axis, keepdim=True, unbiased=False)
    return (x - m) / torch.sqrt(v + eps)
def _scatter_add(tgt, idx, src, axis=0):
    return tgt.clone().index_add_(axis, idx, src)
def _segment_sum(src, seg, n):
    out = torch.zeros((n,) + src.shape[1:], dtype=src.dtype)
    return out.index_add_(0, seg, src)
def _pad(x, pw):
    flat = tuple(v for pair in reversed(pw) for v in pair)
    return torch.nn.functional.pad(x, flat)

kernel_name = 'standalone__batchnorm__sampling'

def setup_inputs():

    _w = (lambda a: (lambda t: t.to(torch.bfloat16) if t.is_floating_point() else t)(torch.as_tensor(a)))
    B, S, C = 1024, 32, 512
    K = 3
    return {
        "x": _w((lambda *s: torch.randn(*s, dtype=torch.bfloat16) * 0.05)(B, S, C)),
        "w": _w((lambda *s: torch.randn(*s, dtype=torch.bfloat16) * 0.05)(K, C, C) * (1.0 / (K * C) ** 0.5)),
        "mean": _w((lambda *s: torch.randn(*s, dtype=torch.bfloat16) * 0.05)(C) * 0.1),
        "var": _w(torch.abs((lambda *s: torch.randn(*s, dtype=torch.bfloat16) * 0.05)(C)) + 0.5),
        "g": _w((lambda *s: torch.randn(*s, dtype=torch.bfloat16) * 0.05)(C) + 1.0),
        "b": _w((lambda *s: torch.randn(*s, dtype=torch.bfloat16) * 0.05)(C) * 0.1),
    }

def reference(x, w, mean, var, g, b):
    K = 3
    P = K // 2
    S = x.shape[1]
    xp = _pad(x, ((0, 0), (P, P), (0, 0)))
    y = sum(torch.einsum('bsc,cd->bsd', xp[:, k:k + S, :], w[k]) for k in range(K))
    inv_std = 1.0 / torch.sqrt(var + 1e-5)
    y = (y - mean) * (g * inv_std) + b
    return _silu(y)
```

```asm
; @launch grid=(256,1,1) block=(256,1,1) lds=163840
.amdgcn_target "amdgcn-amd-amdhsa--gfx950"
.text
.globl standalone__batchnorm__sampling_kernel
.p2align 8
.type standalone__batchnorm__sampling_kernel,@function
standalone__batchnorm__sampling_kernel:
  s_cmp_ge_u32 s2, 256
  s_cbranch_scc1 L_end
  s_load_dwordx2 s[8:9], s[0:1], 0
  s_load_dwordx2 s[12:13], s[0:1], 8
  s_getpc_b64 s[48:49]
L_pc:
  s_mov_b32 s50, L_end-L_pc
  s_mov_b32 s51, 0x20000
  s_lshr_b32 s64, s2, 3
  s_lshl_b32 s64, s64, 11
  v_lshl_add_u32 v2, v0, 3, s64
  buffer_load_dword v39, v2, s[48:51], 0 offen
  s_load_dwordx2 s[16:17], s[0:1], 48
  s_load_dwordx8 s[56:63], s[0:1], 16
  v_lshrrev_b32 v1, 6, v0
  v_and_b32 v0, 63, v0
  v_readfirstlane_b32 s39, v1
  s_mov_b32 s54, 0xbfb8aa3b
  s_mov_b32 s10, 33554432
  s_mov_b32 s11, 0x20000
  s_mov_b32 s14, 1572864
  s_mov_b32 s15, 0x20000
  s_mov_b32 s18, 33554432
  s_mov_b32 s19, 0x20000
  s_and_b32 s3, s2, 7
  s_lshr_b32 s64, s2, 5
  s_lshl_b32 s3, s3, 3
  s_add_u32 s3, s3, s64
  s_lshr_b32 s64, s2, 3
  s_and_b32 s64, s64, 3
  s_lshl_b32 s65, s3, 19
  s_lshl_b32 s66, s64, 8
  s_lshl_b32 s36, s39, 10
  s_lshr_b32 s52, s2, 3
  s_lshl_b32 s52, s52, 2
  s_add_u32 s52, s52, s39
  s_lshl_b32 s52, s52, 9
  s_lshl_b32 s67, s39, 6
  s_add_u32 s66, s66, s67
  s_lshl_b32 s67, s39, 2
  s_and_b32 s40, s2, 3
  s_mov_b32 s55, 0
  s_mov_b32 s41, 0
  s_mov_b32 s42, 1048576
  s_add_u32 s43, s40, 0
  s_and_b32 s43, s43, 3
  s_lshl_b32 s84, s43, 8
  s_add_u32 s84, s84, s55
  s_lshl_b32 s43, s43, 17
  s_add_u32 s88, s43, s41
  s_add_u32 s92, s43, 524288
  s_add_u32 s96, s43, s42
  s_add_u32 s43, s40, 1
  s_and_b32 s43, s43, 3
  s_lshl_b32 s85, s43, 8
  s_add_u32 s85, s85, s55
  s_lshl_b32 s43, s43, 17
  s_add_u32 s89, s43, s41
  s_add_u32 s93, s43, 524288
  s_add_u32 s97, s43, s42
  s_add_u32 s43, s40, 2
  s_and_b32 s43, s43, 3
  s_lshl_b32 s86, s43, 8
  s_add_u32 s86, s86, s55
  s_lshl_b32 s43, s43, 17
  s_add_u32 s90, s43, s41
  s_add_u32 s94, s43, 524288
  s_add_u32 s98, s43, s42
  s_add_u32 s43, s40, 3
  s_and_b32 s43, s43, 3
  s_lshl_b32 s87, s43, 8
  s_add_u32 s87, s87, s55
  s_lshl_b32 s43, s43, 17
  s_add_u32 s91, s43, s41
  s_add_u32 s95, s43, 524288
  s_add_u32 s99, s43, s42
  v_lshrrev_b32 v1, 4, v0
  v_and_b32 v2, 15, v0
  v_add_u32 v3, s67, v1
  v_xor_b32 v15, v2, v3
  v_lshlrev_b32 v15, 4, v15
  v_lshl_add_u32 v15, v3, 15, v15
  v_add_u32 v15, s65, v15
  v_bfe_u32 v3, v0, 2, 2
  v_lshl_add_u32 v3, v1, 3, v3
  v_and_b32 v16, 3, v0
  v_lshlrev_b32 v16, 4, v16
  v_lshl_add_u32 v16, v3, 10, v16
  v_add_u32 v16, s66, v16
  s_waitcnt lgkmcnt(0)
  s_add_u32 m0, s36, 0
  s_add_u32 s37, s84, 0
  buffer_load_dwordx4 v15, s[8:11], s37 offen nt lds
  s_add_u32 m0, s36, 131072
  s_add_u32 s37, s88, 0
  buffer_load_dwordx4 v16, s[12:15], s37 offen lds
  s_add_u32 m0, s36, 135168
  s_add_u32 s37, s88, 4096
  buffer_load_dwordx4 v16, s[12:15], s37 offen lds
  s_add_u32 m0, s36, 139264
  s_add_u32 s37, s92, 0
  buffer_load_dwordx4 v16, s[12:15], s37 offen lds
  s_add_u32 m0, s36, 143360
  s_add_u32 s37, s92, 4096
  buffer_load_dwordx4 v16, s[12:15], s37 offen lds
  s_add_u32 m0, s36, 4096
  s_add_u32 s37, s84, 1024
  buffer_load_dwordx4 v15, s[8:11], s37 offen nt lds
  s_add_u32 m0, s36, 147456
  s_add_u32 s37, s96, 0
  buffer_load_dwordx4 v16, s[12:15], s37 offen lds
  s_add_u32 m0, s36, 151552
  s_add_u32 s37, s96, 4096
  buffer_load_dwordx4 v16, s[12:15], s37 offen lds
  s_add_u32 m0, s36, 8192
  s_add_u32 s37, s84, 2048
  buffer_load_dwordx4 v15, s[8:11], s37 offen nt lds
  s_add_u32 m0, s36, 12288
  s_add_u32 s37, s84, 3072
  buffer_load_dwordx4 v15, s[8:11], s37 offen nt lds
  s_add_u32 m0, s36, 16384
  s_add_u32 s37, s84, 4096
  buffer_load_dwordx4 v15, s[8:11], s37 offen nt lds
  s_add_u32 m0, s36, 20480
  s_add_u32 s37, s84, 5120
  buffer_load_dwordx4 v15, s[8:11], s37 offen nt lds
  s_add_u32 m0, s36, 24576
  s_add_u32 s37, s84, 6144
  buffer_load_dwordx4 v15, s[8:11], s37 offen nt lds
  s_add_u32 m0, s36, 28672
  s_add_u32 s37, s84, 7168
  buffer_load_dwordx4 v15, s[8:11], s37 offen nt lds
  v_xor_b32 v4, v1, v2
  v_lshlrev_b32 v4, 4, v4
  v_lshl_add_u32 v4, v2, 8, v4
  v_xor_b32 v5, 64, v4
  v_xor_b32 v6, 128, v4
  v_xor_b32 v7, 192, v4
  v_add_u32 v8, 65536, v4
  v_add_u32 v9, 65536, v5
  v_add_u32 v10, 65536, v6
  v_add_u32 v11, 65536, v7
  v_lshl_add_u32 v12, v0, 4, s36
  v_add_u32 v13, 65536, v12
  v_add_u32 v14, 131072, v12
  v_lshl_add_u32 v18, v1, 4, s66
  v_lshlrev_b32 v17, 15, v2
  v_add3_u32 v17, v17, v18, s65
  s_mov_b32 s20, s56
  s_mov_b32 s21, s57
  s_mov_b32 s22, 1024
  s_mov_b32 s23, 0x20000
  s_mov_b32 s24, s58
  s_mov_b32 s25, s59
  s_mov_b32 s26, 1024
  s_mov_b32 s27, 0x20000
  s_mov_b32 s28, s60
  s_mov_b32 s29, s61
  s_mov_b32 s30, 1024
  s_mov_b32 s31, 0x20000
  s_mov_b32 s32, s62
  s_mov_b32 s33, s63
  s_mov_b32 s34, 1024
  s_mov_b32 s35, 0x20000
  buffer_load_dwordx4 v[24:27], v18, s[24:27], 0 offen
  buffer_load_dwordx4 v[32:35], v18, s[32:35], 0 offen
  buffer_load_dwordx4 v[0:3], v18, s[28:31], 0 offen
  s_add_u32 m0, s36, 155648
  s_add_u32 s37, s88, 32768
  buffer_load_dwordx4 v16, s[12:15], s37 offen lds
  s_add_u32 m0, s36, 159744
  s_add_u32 s37, s88, 36864
  buffer_load_dwordx4 v16, s[12:15], s37 offen lds
  s_add_u32 m0, s36, 32768
  s_add_u32 s37, s92, 32768
  buffer_load_dwordx4 v16, s[12:15], s37 offen lds
  s_add_u32 m0, s36, 36864
  s_add_u32 s37, s92, 36864
  buffer_load_dwordx4 v16, s[12:15], s37 offen lds
  s_add_u32 m0, s36, 40960
  s_add_u32 s37, s96, 32768
  buffer_load_dwordx4 v16, s[12:15], s37 offen lds
  s_add_u32 m0, s36, 45056
  s_add_u32 s37, s96, 36864
  buffer_load_dwordx4 v16, s[12:15], s37 offen lds
  s_waitcnt vmcnt(21)
  ds_read_b64_tr_b16 a[0:1], v14 offset:0
  ds_read_b64_tr_b16 a[4:5], v14 offset:8
  s_waitcnt vmcnt(20)
  ds_read_b64_tr_b16 a[2:3], v14 offset:4096
  ds_read_b64_tr_b16 a[6:7], v14 offset:4104
  s_waitcnt vmcnt(19)
  ds_read_b64_tr_b16 a[8:9], v14 offset:8192
  ds_read_b64_tr_b16 a[12:13], v14 offset:8200
  s_waitcnt vmcnt(18)
  ds_read_b64_tr_b16 a[10:11], v14 offset:12288
  ds_read_b64_tr_b16 a[14:15], v14 offset:12296
  s_waitcnt vmcnt(16)
  ds_read_b64_tr_b16 a[16:17], v14 offset:16384
  ds_read_b64_tr_b16 a[20:21], v14 offset:16392
  s_waitcnt vmcnt(15)
  ds_read_b64_tr_b16 a[18:19], v14 offset:20480
  ds_read_b64_tr_b16 a[22:23], v14 offset:20488
  s_waitcnt vmcnt(9)
  s_barrier
  ds_read_b128 v[40:43], v4 offset:0
  ds_read_b128 v[44:47], v4 offset:4096
  ds_read_b128 v[48:51], v4 offset:8192
  s_waitcnt lgkmcnt(2)
  v_mfma_f32_16x16x32_bf16 v[56:59], a[0:3], v[40:43], 0
  ds_read_b128 v[52:55], v4 offset:12288
  s_add_u32 m0, s36, 49152
  v_mfma_f32_16x16x32_bf16 v[60:63], a[4:7], v[40:43], 0
  s_add_u32 s37, s85, 0
  buffer_load_dwordx4 v15, s[8:11], s37 offen nt lds
  v_mfma_f32_16x16x32_bf16 v[64:67], a[8:11], v[40:43], 0
  s_add_u32 m0, s36, 53248
  s_add_u32 s37, s85, 1024
  v_mfma_f32_16x16x32_bf16 v[68:71], a[12:15], v[40:43], 0
  buffer_load_dwordx4 v15, s[8:11], s37 offen nt lds
  s_waitcnt lgkmcnt(2)
  v_mfma_f32_16x16x32_bf16 v[72:75], a[0:3], v[44:47], 0
  ds_read_b128 v[40:43], v4 offset:16384
  s_add_u32 m0, s36, 57344
  v_mfma_f32_16x16x32_bf16 v[76:79], a[4:7], v[44:47], 0
  s_add_u32 s37, s85, 2048
  buffer_load_dwordx4 v15, s[8:11], s37 offen nt lds
  v_mfma_f32_16x16x32_bf16 v[56:59], a[8:11], v[44:47], v[56:59]
  s_add_u32 m0, s36, 61440
  s_add_u32 s37, s85, 3072
  v_mfma_f32_16x16x32_bf16 v[60:63], a[12:15], v[44:47], v[60:63]
  buffer_load_dwordx4 v15, s[8:11], s37 offen nt lds
  s_add_u32 m0, s36, 65536
  v_mfma_f32_16x16x32_bf16 v[64:67], a[16:19], v[44:47], v[64:67]
  s_add_u32 s37, s85, 4096
  buffer_load_dwordx4 v15, s[8:11], s37 offen nt lds
  v_mfma_f32_16x16x32_bf16 v[68:71], a[20:23], v[44:47], v[68:71]
  s_add_u32 m0, s36, 69632
  s_waitcnt lgkmcnt(2)
  v_mfma_f32_16x16x32_bf16 v[80:83], a[0:3], v[48:51], 0
  ds_read_b128 v[44:47], v4 offset:20480
  s_add_u32 s37, s85, 5120
  v_mfma_f32_16x16x32_bf16 v[84:87], a[4:7], v[48:51], 0
  s_waitcnt vmcnt(10)
  ds_read_b64_tr_b16 a[24:25], v14 offset:24576
  v_mfma_f32_16x16x32_bf16 v[72:75], a[8:11], v[48:51], v[72:75]
  ds_read_b64_tr_b16 a[28:29], v14 offset:24584
  buffer_load_dwordx4 v15, s[8:11], s37 offen nt lds
  v_mfma_f32_16x16x32_bf16 v[76:79], a[12:15], v[48:51], v[76:79]
  s_waitcnt vmcnt(10)
  ds_read_b64_tr_b16 a[26:27], v14 offset:28672
  v_mfma_f32_16x16x32_bf16 v[56:59], a[16:19], v[48:51], v[56:59]
  ds_read_b64_tr_b16 a[30:31], v14 offset:28680
  s_add_u32 m0, s36, 73728
  v_mfma_f32_16x16x32_bf16 v[60:63], a[20:23], v[48:51], v[60:63]
  s_add_u32 s37, s85, 6144
  s_waitcnt lgkmcnt(6)
  v_mfma_f32_16x16x32_bf16 v[88:91], a[0:3], v[52:55], 0
  ds_read_b128 v[48:51], v4 offset:24576
  buffer_load_dwordx4 v15, s[8:11], s37 offen nt lds
  v_mfma_f32_16x16x32_bf16 v[92:95], a[4:7], v[52:55], 0
  s_waitcnt vmcnt(10)
  ds_read_b64_tr_b16 a[32:33], v12 offset:32768
  v_mfma_f32_16x16x32_bf16 v[80:83], a[8:11], v[52:55], v[80:83]
  ds_read_b64_tr_b16 a[36:37], v12 offset:32776
  s_add_u32 m0, s36, 77824
  v_mfma_f32_16x16x32_bf16 v[84:87], a[12:15], v[52:55], v[84:87]
  s_waitcnt vmcnt(9)
  ds_read_b64_tr_b16 a[34:35], v12 offset:36864
  v_mfma_f32_16x16x32_bf16 v[72:75], a[16:19], v[52:55], v[72:75]
  ds_read_b64_tr_b16 a[38:39], v12 offset:36872
  s_add_u32 s37, s85, 7168
  v_mfma_f32_16x16x32_bf16 v[76:79], a[20:23], v[52:55], v[76:79]
  buffer_load_dwordx4 v15, s[8:11], s37 offen nt lds
  s_waitcnt lgkmcnt(10)
  v_mfma_f32_16x16x32_bf16 v[96:99], a[0:3], v[40:43], 0
  ds_read_b128 v[52:55], v4 offset:28672
  s_add_u32 m0, s36, 131072
  v_mfma_f32_16x16x32_bf16 v[100:103], a[4:7], v[40:43], 0
  s_waitcnt vmcnt(9)
  ds_read_b64_tr_b16 a[40:41], v12 offset:40960
  v_mfma_f32_16x16x32_bf16 v[88:91], a[8:11], v[40:43], v[88:91]
  ds_read_b64_tr_b16 a[44:45], v12 offset:40968
  s_add_u32 s37, s88, 65536
  v_mfma_f32_16x16x32_bf16 v[92:95], a[12:15], v[40:43], v[92:95]
  s_waitcnt vmcnt(8)
  ds_read_b64_tr_b16 a[42:43], v12 offset:45056
  v_mfma_f32_16x16x32_bf16 v[80:83], a[16:19], v[40:43], v[80:83]
  ds_read_b64_tr_b16 a[46:47], v12 offset:45064
  buffer_load_dwordx4 v16, s[12:15], s37 offen lds
  v_mfma_f32_16x16x32_bf16 v[84:87], a[20:23], v[40:43], v[84:87]
  s_add_u32 m0, s36, 135168
  s_waitcnt lgkmcnt(14)
  v_mfma_f32_16x16x32_bf16 v[104:107], a[0:3], v[44:47], 0
  ds_read_b128 v[40:43], v5 offset:0
  s_add_u32 s37, s88, 69632
  v_mfma_f32_16x16x32_bf16 v[108:111], a[4:7], v[44:47], 0
  buffer_load_dwordx4 v16, s[12:15], s37 offen lds
  s_add_u32 m0, s36, 139264
  v_mfma_f32_16x16x32_bf16 v[96:99], a[8:11], v[44:47], v[96:99]
  s_add_u32 s37, s92, 65536
  buffer_load_dwordx4 v16, s[12:15], s37 offen lds
  v_mfma_f32_16x16x32_bf16 v[100:103], a[12:15], v[44:47], v[100:103]
  s_add_u32 m0, s36, 143360
  s_add_u32 s37, s92, 69632
  v_mfma_f32_16x16x32_bf16 v[88:91], a[16:19], v[44:47], v[88:91]
  buffer_load_dwordx4 v16, s[12:15], s37 offen lds
  s_add_u32 m0, s36, 147456
  v_mfma_f32_16x16x32_bf16 v[92:95], a[20:23], v[44:47], v[92:95]
  s_add_u32 s37, s96, 65536
  s_waitcnt lgkmcnt(10)
  v_mfma_f32_16x16x32_bf16 v[112:115], a[0:3], v[48:51], 0
  ds_read_b128 v[44:47], v5 offset:4096
  buffer_load_dwordx4 v16, s[12:15], s37 offen lds
  v_mfma_f32_16x16x32_bf16 v[116:119], a[4:7], v[48:51], 0
  s_add_u32 m0, s36, 151552
  s_add_u32 s37, s96, 69632
  v_mfma_f32_16x16x32_bf16 v[104:107], a[8:11], v[48:51], v[104:107]
  buffer_load_dwordx4 v16, s[12:15], s37 offen lds
  s_add_u32 m0, s36, 155648
  v_mfma_f32_16x16x32_bf16 v[108:111], a[12:15], v[48:51], v[108:111]
  s_add_u32 s37, s88, 98304
  buffer_load_dwordx4 v16, s[12:15], s37 offen lds
  v_mfma_f32_16x16x32_bf16 v[96:99], a[16:19], v[48:51], v[96:99]
  s_add_u32 m0, s36, 159744
  s_add_u32 s37, s88, 102400
  v_mfma_f32_16x16x32_bf16 v[100:103], a[20:23], v[48:51], v[100:103]
  buffer_load_dwordx4 v16, s[12:15], s37 offen lds
  s_waitcnt lgkmcnt(6)
  v_mfma_f32_16x16x32_bf16 v[120:123], a[0:3], v[52:55], 0
  ds_read_b128 v[48:51], v5 offset:8192
  s_add_u32 m0, s36, 81920
  v_mfma_f32_16x16x32_bf16 v[124:127], a[4:7], v[52:55], 0
  s_add_u32 s37, s92, 98304
  buffer_load_dwordx4 v16, s[12:15], s37 offen lds
  v_mfma_f32_16x16x32_bf16 v[112:115], a[8:11], v[52:55], v[112:115]
  s_add_u32 m0, s36, 86016
  s_add_u32 s37, s92, 102400
  v_mfma_f32_16x16x32_bf16 v[116:119], a[12:15], v[52:55], v[116:119]
  buffer_load_dwordx4 v16, s[12:15], s37 offen lds
  s_add_u32 m0, s36, 90112
  v_mfma_f32_16x16x32_bf16 v[104:107], a[16:19], v[52:55], v[104:107]
  s_add_u32 s37, s96, 98304
  buffer_load_dwordx4 v16, s[12:15], s37 offen lds
  v_mfma_f32_16x16x32_bf16 v[108:111], a[20:23], v[52:55], v[108:111]
  s_add_u32 m0, s36, 94208
  s_waitcnt lgkmcnt(2)
  v_mfma_f32_16x16x32_bf16 v[56:59], a[24:27], v[40:43], v[56:59]
  ds_read_b128 v[52:55], v5 offset:12288
  s_add_u32 s37, s96, 102400
  v_mfma_f32_16x16x32_bf16 v[60:63], a[28:31], v[40:43], v[60:63]
  buffer_load_dwordx4 v16, s[12:15], s37 offen lds
  v_lshlrev_b32 v20, 16, v24
  v_mfma_f32_16x16x32_bf16 v[64:67], a[32:35], v[40:43], v[64:67]
  v_and_b32 v21, 0xffff0000, v24
  v_add_f32 v20, 0x3727c5ac, v20
  v_mfma_f32_16x16x32_bf16 v[68:71], a[36:39], v[40:43], v[68:71]
  v_add_f32 v21, 0x3727c5ac, v21
  s_waitcnt lgkmcnt(2)
  v_mfma_f32_16x16x32_bf16 v[72:75], a[24:27], v[44:47], v[72:75]
  ds_read_b128 v[40:43], v5 offset:16384
  v_cvt_pk_bf16_f32 v36, v20, v21
  v_mfma_f32_16x16x32_bf16 v[76:79], a[28:31], v[44:47], v[76:79]
  s_add_u32 m0, s36, 98304
  s_add_u32 s37, s89, 0
  v_mfma_f32_16x16x32_bf16 v[56:59], a[32:35], v[44:47], v[56:59]
  buffer_load_dwordx4 v16, s[12:15], s37 offen lds
  v_lshlrev_b32 v20, 16, v36
  v_mfma_f32_16x16x32_bf16 v[60:63], a[36:39], v[44:47], v[60:63]
  v_and_b32 v21, 0xffff0000, v36
  v_mfma_f32_16x16x32_bf16 v[64:67], a[40:43], v[44:47], v[64:67]
  v_sqrt_f32 v20, v20
  v_mfma_f32_16x16x32_bf16 v[68:71], a[44:47], v[44:47], v[68:71]
  s_waitcnt lgkmcnt(2)
  v_mfma_f32_16x16x32_bf16 v[80:83], a[24:27], v[48:51], v[80:83]
  ds_read_b128 v[44:47], v5 offset:20480
  s_add_u32 m0, s36, 102400
  v_mfma_f32_16x16x32_bf16 v[84:87], a[28:31], v[48:51], v[84:87]
  s_waitcnt vmcnt(12)
  ds_read_b64_tr_b16 a[48:49], v14 offset:0
  v_mfma_f32_16x16x32_bf16 v[72:75], a[32:35], v[48:51], v[72:75]
  ds_read_b64_tr_b16 a[52:53], v14 offset:8
  s_add_u32 s37, s89, 4096
  v_mfma_f32_16x16x32_bf16 v[76:79], a[36:39], v[48:51], v[76:79]
  s_waitcnt vmcnt(11)
  ds_read_b64_tr_b16 a[50:51], v14 offset:4096
  v_mfma_f32_16x16x32_bf16 v[56:59], a[40:43], v[48:51], v[56:59]
  ds_read_b64_tr_b16 a[54:55], v14 offset:4104
  buffer_load_dwordx4 v16, s[12:15], s37 offen lds
  v_mfma_f32_16x16x32_bf16 v[60:63], a[44:47], v[48:51], v[60:63]
  s_waitcnt lgkmcnt(6)
  v_mfma_f32_16x16x32_bf16 v[88:91], a[24:27], v[52:55], v[88:91]
  ds_read_b128 v[48:51], v5 offset:24576
  v_mfma_f32_16x16x32_bf16 v[92:95], a[28:31], v[52:55], v[92:95]
  s_waitcnt vmcnt(11)
  ds_read_b64_tr_b16 a[56:57], v14 offset:8192
  v_mfma_f32_16x16x32_bf16 v[80:83], a[32:35], v[52:55], v[80:83]
  ds_read_b64_tr_b16 a[60:61], v14 offset:8200
  s_add_u32 m0, s36, 106496
  v_mfma_f32_16x16x32_bf16 v[84:87], a[36:39], v[52:55], v[84:87]
  s_waitcnt vmcnt(10)
  ds_read_b64_tr_b16 a[58:59], v14 offset:12288
  v_mfma_f32_16x16x32_bf16 v[72:75], a[40:43], v[52:55], v[72:75]
  ds_read_b64_tr_b16 a[62:63], v14 offset:12296
  s_add_u32 s37, s93, 0
  v_mfma_f32_16x16x32_bf16 v[76:79], a[44:47], v[52:55], v[76:79]
  buffer_load_dwordx4 v16, s[12:15], s37 offen lds
  s_waitcnt lgkmcnt(10)
  v_mfma_f32_16x16x32_bf16 v[96:99], a[24:27], v[40:43], v[96:99]
  ds_read_b128 v[52:55], v5 offset:28672
  v_mfma_f32_16x16x32_bf16 v[100:103], a[28:31], v[40:43], v[100:103]
  s_waitcnt vmcnt(10)
  ds_read_b64_tr_b16 a[64:65], v14 offset:16384
  v_mfma_f32_16x16x32_bf16 v[88:91], a[32:35], v[40:43], v[88:91]
  ds_read_b64_tr_b16 a[68:69], v14 offset:16392
  v_mfma_f32_16x16x32_bf16 v[92:95], a[36:39], v[40:43], v[92:95]
  s_waitcnt vmcnt(9)
  ds_read_b64_tr_b16 a[66:67], v14 offset:20480
  v_mfma_f32_16x16x32_bf16 v[80:83], a[40:43], v[40:43], v[80:83]
  ds_read_b64_tr_b16 a[70:71], v14 offset:20488
  s_add_u32 m0, s36, 110592
  v_mfma_f32_16x16x32_bf16 v[84:87], a[44:47], v[40:43], v[84:87]
  s_add_u32 s37, s93, 4096
  s_waitcnt lgkmcnt(14)
  v_mfma_f32_16x16x32_bf16 v[104:107], a[24:27], v[44:47], v[104:107]
  ds_read_b128 v[40:43], v6 offset:0
  buffer_load_dwordx4 v16, s[12:15], s37 offen lds
  v_mfma_f32_16x16x32_bf16 v[108:111], a[28:31], v[44:47], v[108:111]
  v_sqrt_f32 v21, v21
  v_mfma_f32_16x16x32_bf16 v[96:99], a[32:35], v[44:47], v[96:99]
  v_cvt_pk_bf16_f32 v36, v20, v21
  v_lshlrev_b32 v20, 16, v36
  v_mfma_f32_16x16x32_bf16 v[100:103], a[36:39], v[44:47], v[100:103]
  v_and_b32 v21, 0xffff0000, v36
  v_mfma_f32_16x16x32_bf16 v[88:91], a[40:43], v[44:47], v[88:91]
  s_add_u32 m0, s36, 114688
  s_add_u32 s37, s97, 0
  v_mfma_f32_16x16x32_bf16 v[92:95], a[44:47], v[44:47], v[92:95]
  buffer_load_dwordx4 v16, s[12:15], s37 offen lds
  s_waitcnt lgkmcnt(10)
  v_mfma_f32_16x16x32_bf16 v[112:115], a[24:27], v[48:51], v[112:115]
  ds_read_b128 v[44:47], v6 offset:4096
  v_mfma_f32_16x16x32_bf16 v[116:119], a[28:31], v[48:51], v[116:119]
  v_rcp_f32 v20, v20
  v_mfma_f32_16x16x32_bf16 v[104:107], a[32:35], v[48:51], v[104:107]
  v_rcp_f32 v21, v21
  v_mfma_f32_16x16x32_bf16 v[108:111], a[36:39], v[48:51], v[108:111]
  s_add_u32 m0, s36, 131072
  s_add_u32 s37, s97, 4096
  v_mfma_f32_16x16x32_bf16 v[96:99], a[40:43], v[48:51], v[96:99]
  buffer_load_dwordx4 v16, s[12:15], s37 offen lds
  v_cvt_pk_bf16_f32 v36, v20, v21
  v_mfma_f32_16x16x32_bf16 v[100:103], a[44:47], v[48:51], v[100:103]
  v_lshlrev_b32 v20, 16, v36
  s_waitcnt lgkmcnt(6)
  v_mfma_f32_16x16x32_bf16 v[120:123], a[24:27], v[52:55], v[120:123]
  ds_read_b128 v[48:51], v6 offset:8192
  v_and_b32 v21, 0xffff0000, v36
  v_mfma_f32_16x16x32_bf16 v[124:127], a[28:31], v[52:55], v[124:127]
  v_lshlrev_b32 v37, 16, v0
  v_and_b32 v38, 0xffff0000, v0
  v_mfma_f32_16x16x32_bf16 v[112:115], a[32:35], v[52:55], v[112:115]
  s_add_u32 m0, s36, 135168
  s_add_u32 s37, s89, 32768
  v_mfma_f32_16x16x32_bf16 v[116:119], a[36:39], v[52:55], v[116:119]
  buffer_load_dwordx4 v16, s[12:15], s37 offen lds
  v_mul_f32 v20, v20, v37
  v_mfma_f32_16x16x32_bf16 v[104:107], a[40:43], v[52:55], v[104:107]
  v_mul_f32 v21, v21, v38
  v_cvt_pk_bf16_f32 v36, v20, v21
  v_mfma_f32_16x16x32_bf16 v[108:111], a[44:47], v[52:55], v[108:111]
  v_lshlrev_b32 v20, 16, v36
  s_waitcnt lgkmcnt(2)
  v_mfma_f32_16x16x32_bf16 v[56:59], a[48:51], v[40:43], v[56:59]
  ds_read_b128 v[52:55], v6 offset:12288
  v_and_b32 v21, 0xffff0000, v36
  v_mfma_f32_16x16x32_bf16 v[60:63], a[52:55], v[40:43], v[60:63]
  s_add_u32 m0, s36, 139264
  s_add_u32 s37, s89, 36864
  v_mfma_f32_16x16x32_bf16 v[64:67], a[56:59], v[40:43], v[64:67]
  buffer_load_dwordx4 v16, s[12:15], s37 offen lds
  v_lshlrev_b32 v22, 16, v25
  v_mfma_f32_16x16x32_bf16 v[68:71], a[60:63], v[40:43], v[68:71]
  v_and_b32 v23, 0xffff0000, v25
  s_waitcnt lgkmcnt(2)
  v_mfma_f32_16x16x32_bf16 v[72:75], a[48:51], v[44:47], v[72:75]
  ds_read_b128 v[40:43], v6 offset:16384
  v_add_f32 v22, 0x3727c5ac, v22
  v_mfma_f32_16x16x32_bf16 v[76:79], a[52:55], v[44:47], v[76:79]
  v_add_f32 v23, 0x3727c5ac, v23
  v_cvt_pk_bf16_f32 v36, v22, v23
  v_mfma_f32_16x16x32_bf16 v[56:59], a[56:59], v[44:47], v[56:59]
  s_add_u32 m0, s36, 143360
  s_add_u32 s37, s93, 32768
  v_mfma_f32_16x16x32_bf16 v[60:63], a[60:63], v[44:47], v[60:63]
  buffer_load_dwordx4 v16, s[12:15], s37 offen lds
  v_lshlrev_b32 v22, 16, v36
  v_mfma_f32_16x16x32_bf16 v[64:67], a[64:67], v[44:47], v[64:67]
  v_and_b32 v23, 0xffff0000, v36
  v_mfma_f32_16x16x32_bf16 v[68:71], a[68:71], v[44:47], v[68:71]
  s_waitcnt lgkmcnt(2)
  v_mfma_f32_16x16x32_bf16 v[80:83], a[48:51], v[48:51], v[80:83]
  ds_read_b128 v[44:47], v6 offset:20480
  v_mfma_f32_16x16x32_bf16 v[84:87], a[52:55], v[48:51], v[84:87]
  s_waitcnt vmcnt(14)
  ds_read_b64_tr_b16 a[72:73], v14 offset:24576
  v_mfma_f32_16x16x32_bf16 v[72:75], a[56:59], v[48:51], v[72:75]
  ds_read_b64_tr_b16 a[76:77], v14 offset:24584
  s_add_u32 m0, s36, 147456
  v_mfma_f32_16x16x32_bf16 v[76:79], a[60:63], v[48:51], v[76:79]
  s_waitcnt vmcnt(13)
  ds_read_b64_tr_b16 a[74:75], v14 offset:28672
  v_mfma_f32_16x16x32_bf16 v[56:59], a[64:67], v[48:51], v[56:59]
  ds_read_b64_tr_b16 a[78:79], v14 offset:28680
  s_add_u32 s37, s93, 36864
  v_mfma_f32_16x16x32_bf16 v[60:63], a[68:71], v[48:51], v[60:63]
  buffer_load_dwordx4 v16, s[12:15], s37 offen lds
  s_waitcnt lgkmcnt(6)
  v_mfma_f32_16x16x32_bf16 v[88:91], a[48:51], v[52:55], v[88:91]
  ds_read_b128 v[48:51], v6 offset:24576
  v_mfma_f32_16x16x32_bf16 v[92:95], a[52:55], v[52:55], v[92:95]
  s_waitcnt vmcnt(13)
  ds_read_b64_tr_b16 a[80:81], v13 offset:16384
  v_mfma_f32_16x16x32_bf16 v[80:83], a[56:59], v[52:55], v[80:83]
  ds_read_b64_tr_b16 a[84:85], v13 offset:16392
  v_mfma_f32_16x16x32_bf16 v[84:87], a[60:63], v[52:55], v[84:87]
  s_waitcnt vmcnt(12)
  ds_read_b64_tr_b16 a[82:83], v13 offset:20480
  v_mfma_f32_16x16x32_bf16 v[72:75], a[64:67], v[52:55], v[72:75]
  ds_read_b64_tr_b16 a[86:87], v13 offset:20488
  s_add_u32 m0, s36, 151552
  v_mfma_f32_16x16x32_bf16 v[76:79], a[68:71], v[52:55], v[76:79]
  s_add_u32 s37, s97, 32768
  s_waitcnt lgkmcnt(10)
  v_mfma_f32_16x16x32_bf16 v[96:99], a[48:51], v[40:43], v[96:99]
  ds_read_b128 v[52:55], v6 offset:28672
  buffer_load_dwordx4 v16, s[12:15], s37 offen lds
  v_mfma_f32_16x16x32_bf16 v[100:103], a[52:55], v[40:43], v[100:103]
  s_waitcnt vmcnt(12)
  ds_read_b64_tr_b16 a[88:89], v13 offset:24576
  v_mfma_f32_16x16x32_bf16 v[88:91], a[56:59], v[40:43], v[88:91]
  ds_read_b64_tr_b16 a[92:93], v13 offset:24584
  v_mfma_f32_16x16x32_bf16 v[92:95], a[60:63], v[40:43], v[92:95]
  s_waitcnt vmcnt(11)
  ds_read_b64_tr_b16 a[90:91], v13 offset:28672
  v_mfma_f32_16x16x32_bf16 v[80:83], a[64:67], v[40:43], v[80:83]
  ds_read_b64_tr_b16 a[94:95], v13 offset:28680
  s_add_u32 m0, s36, 118784
  v_mfma_f32_16x16x32_bf16 v[84:87], a[68:71], v[40:43], v[84:87]
  s_add_u32 s37, s97, 36864
  s_waitcnt lgkmcnt(14)
  v_mfma_f32_16x16x32_bf16 v[104:107], a[48:51], v[44:47], v[104:107]
  ds_read_b128 v[40:43], v7 offset:0
  buffer_load_dwordx4 v16, s[12:15], s37 offen lds
  v_mfma_f32_16x16x32_bf16 v[108:111], a[52:55], v[44:47], v[108:111]
  v_sqrt_f32 v22, v22
  v_mfma_f32_16x16x32_bf16 v[96:99], a[56:59], v[44:47], v[96:99]
  v_sqrt_f32 v23, v23
  v_mfma_f32_16x16x32_bf16 v[100:103], a[60:63], v[44:47], v[100:103]
  v_cvt_pk_bf16_f32 v36, v22, v23
  v_lshlrev_b32 v22, 16, v36
  v_mfma_f32_16x16x32_bf16 v[88:91], a[64:67], v[44:47], v[88:91]
  s_add_u32 m0, s36, 122880
  s_add_u32 s37, s86, 0
  v_mfma_f32_16x16x32_bf16 v[92:95], a[68:71], v[44:47], v[92:95]
  buffer_load_dwordx4 v15, s[8:11], s37 offen nt lds
  s_waitcnt lgkmcnt(10)
  v_mfma_f32_16x16x32_bf16 v[112:115], a[48:51], v[48:51], v[112:115]
  ds_read_b128 v[44:47], v7 offset:4096
  v_and_b32 v23, 0xffff0000, v36
  v_mfma_f32_16x16x32_bf16 v[116:119], a[52:55], v[48:51], v[116:119]
  v_rcp_f32 v22, v22
  v_mfma_f32_16x16x32_bf16 v[104:107], a[56:59], v[48:51], v[104:107]
  v_rcp_f32 v23, v23
  v_mfma_f32_16x16x32_bf16 v[108:111], a[60:63], v[48:51], v[108:111]
  s_add_u32 m0, s36, 126976
  s_add_u32 s37, s86, 1024
  v_mfma_f32_16x16x32_bf16 v[96:99], a[64:67], v[48:51], v[96:99]
  buffer_load_dwordx4 v15, s[8:11], s37 offen nt lds
  v_cvt_pk_bf16_f32 v36, v22, v23
  v_mfma_f32_16x16x32_bf16 v[100:103], a[68:71], v[48:51], v[100:103]
  v_lshlrev_b32 v22, 16, v36
  s_waitcnt lgkmcnt(6)
  v_mfma_f32_16x16x32_bf16 v[120:123], a[48:51], v[52:55], v[120:123]
  ds_read_b128 v[48:51], v7 offset:8192
  v_and_b32 v23, 0xffff0000, v36
  v_mfma_f32_16x16x32_bf16 v[124:127], a[52:55], v[52:55], v[124:127]
  v_lshlrev_b32 v37, 16, v1
  v_and_b32 v38, 0xffff0000, v1
  v_mfma_f32_16x16x32_bf16 v[112:115], a[56:59], v[52:55], v[112:115]
  s_add_u32 m0, s36, 32768
  s_add_u32 s37, s86, 2048
  v_mfma_f32_16x16x32_bf16 v[116:119], a[60:63], v[52:55], v[116:119]
  buffer_load_dwordx4 v15, s[8:11], s37 offen nt lds
  v_mul_f32 v22, v22, v37
  v_mfma_f32_16x16x32_bf16 v[104:107], a[64:67], v[52:55], v[104:107]
  v_mul_f32 v23, v23, v38
  v_cvt_pk_bf16_f32 v36, v22, v23
  v_mfma_f32_16x16x32_bf16 v[108:111], a[68:71], v[52:55], v[108:111]
  v_lshlrev_b32 v22, 16, v36
  s_waitcnt lgkmcnt(2)
  v_mfma_f32_16x16x32_bf16 v[56:59], a[72:75], v[40:43], v[56:59]
  ds_read_b128 v[52:55], v7 offset:12288
  v_and_b32 v23, 0xffff0000, v36
  v_mfma_f32_16x16x32_bf16 v[60:63], a[76:79], v[40:43], v[60:63]
  s_add_u32 m0, s36, 36864
  s_add_u32 s37, s86, 3072
  v_mfma_f32_16x16x32_bf16 v[64:67], a[80:83], v[40:43], v[64:67]
  buffer_load_dwordx4 v15, s[8:11], s37 offen nt lds
  v_lshlrev_b32 v24, 16, v26
  v_mfma_f32_16x16x32_bf16 v[68:71], a[84:87], v[40:43], v[68:71]
  v_and_b32 v25, 0xffff0000, v26
  s_waitcnt lgkmcnt(2)
  v_mfma_f32_16x16x32_bf16 v[72:75], a[72:75], v[44:47], v[72:75]
  ds_read_b128 v[40:43], v7 offset:16384
  v_add_f32 v24, 0x3727c5ac, v24
  v_mfma_f32_16x16x32_bf16 v[76:79], a[76:79], v[44:47], v[76:79]
  v_add_f32 v25, 0x3727c5ac, v25
  v_cvt_pk_bf16_f32 v36, v24, v25
  v_mfma_f32_16x16x32_bf16 v[56:59], a[80:83], v[44:47], v[56:59]
  s_add_u32 m0, s36, 40960
  s_add_u32 s37, s86, 4096
  v_mfma_f32_16x16x32_bf16 v[60:63], a[84:87], v[44:47], v[60:63]
  buffer_load_dwordx4 v15, s[8:11], s37 offen nt lds
  v_mfma_f32_16x16x32_bf16 v[64:67], a[88:91], v[44:47], v[64:67]
  v_lshlrev_b32 v24, 16, v36
  v_mfma_f32_16x16x32_bf16 v[68:71], a[92:95], v[44:47], v[68:71]
  v_and_b32 v25, 0xffff0000, v36
  s_waitcnt lgkmcnt(2)
  v_mfma_f32_16x16x32_bf16 v[80:83], a[72:75], v[48:51], v[80:83]
  ds_read_b128 v[44:47], v7 offset:20480
  v_mfma_f32_16x16x32_bf16 v[84:87], a[76:79], v[48:51], v[84:87]
  s_waitcnt vmcnt(16)
  ds_read_b64_tr_b16 a[96:97], v13 offset:32768
  v_mfma_f32_16x16x32_bf16 v[72:75], a[80:83], v[48:51], v[72:75]
  ds_read_b64_tr_b16 a[100:101], v13 offset:32776
  s_add_u32 m0, s36, 45056
  v_mfma_f32_16x16x32_bf16 v[76:79], a[84:87], v[48:51], v[76:79]
  s_waitcnt vmcnt(15)
  ds_read_b64_tr_b16 a[98:99], v13 offset:36864
  v_mfma_f32_16x16x32_bf16 v[56:59], a[88:91], v[48:51], v[56:59]
  ds_read_b64_tr_b16 a[102:103], v13 offset:36872
  s_add_u32 s37, s86, 5120
  v_mfma_f32_16x16x32_bf16 v[60:63], a[92:95], v[48:51], v[60:63]
  buffer_load_dwordx4 v15, s[8:11], s37 offen nt lds
  s_waitcnt lgkmcnt(6)
  v_mfma_f32_16x16x32_bf16 v[88:91], a[72:75], v[52:55], v[88:91]
  ds_read_b128 v[48:51], v7 offset:24576
  v_mfma_f32_16x16x32_bf16 v[92:95], a[76:79], v[52:55], v[92:95]
  s_waitcnt vmcnt(15)
  ds_read_b64_tr_b16 a[104:105], v13 offset:40960
  v_mfma_f32_16x16x32_bf16 v[80:83], a[80:83], v[52:55], v[80:83]
  ds_read_b64_tr_b16 a[108:109], v13 offset:40968
  v_mfma_f32_16x16x32_bf16 v[84:87], a[84:87], v[52:55], v[84:87]
  s_waitcnt vmcnt(14)
  ds_read_b64_tr_b16 a[106:107], v13 offset:45056
  v_mfma_f32_16x16x32_bf16 v[72:75], a[88:91], v[52:55], v[72:75]
  ds_read_b64_tr_b16 a[110:111], v13 offset:45064
  s_add_u32 m0, s36, 81920
  v_mfma_f32_16x16x32_bf16 v[76:79], a[92:95], v[52:55], v[76:79]
  s_add_u32 s37, s86, 6144
  s_waitcnt lgkmcnt(10)
  v_mfma_f32_16x16x32_bf16 v[96:99], a[72:75], v[40:43], v[96:99]
  ds_read_b128 v[52:55], v7 offset:28672
  buffer_load_dwordx4 v15, s[8:11], s37 offen nt lds
  v_mfma_f32_16x16x32_bf16 v[100:103], a[76:79], v[40:43], v[100:103]
  s_waitcnt vmcnt(14)
  ds_read_b64_tr_b16 a[112:113], v13 offset:49152
  v_mfma_f32_16x16x32_bf16 v[88:91], a[80:83], v[40:43], v[88:91]
  ds_read_b64_tr_b16 a[116:117], v13 offset:49160
  v_mfma_f32_16x16x32_bf16 v[92:95], a[84:87], v[40:43], v[92:95]
  s_waitcnt vmcnt(13)
  ds_read_b64_tr_b16 a[114:115], v14 offset:0
  v_mfma_f32_16x16x32_bf16 v[80:83], a[88:91], v[40:43], v[80:83]
  ds_read_b64_tr_b16 a[118:119], v14 offset:8
  s_add_u32 m0, s36, 86016
  v_mfma_f32_16x16x32_bf16 v[84:87], a[92:95], v[40:43], v[84:87]
  s_add_u32 s37, s86, 7168
  s_barrier
  s_waitcnt lgkmcnt(14)
  v_mfma_f32_16x16x32_bf16 v[104:107], a[72:75], v[44:47], v[104:107]
  ds_read_b128 v[40:43], v4 offset:49152
  buffer_load_dwordx4 v15, s[8:11], s37 offen nt lds
  v_mfma_f32_16x16x32_bf16 v[108:111], a[76:79], v[44:47], v[108:111]
  v_sqrt_f32 v24, v24
  v_mfma_f32_16x16x32_bf16 v[96:99], a[80:83], v[44:47], v[96:99]
  v_sqrt_f32 v25, v25
  v_mfma_f32_16x16x32_bf16 v[100:103], a[84:87], v[44:47], v[100:103]
  v_cvt_pk_bf16_f32 v36, v24, v25
  v_mfma_f32_16x16x32_bf16 v[88:91], a[88:91], v[44:47], v[88:91]
  s_add_u32 m0, s36, 155648
  s_add_u32 s37, s89, 65536
  v_mfma_f32_16x16x32_bf16 v[92:95], a[92:95], v[44:47], v[92:95]
  buffer_load_dwordx4 v16, s[12:15], s37 offen lds
  s_waitcnt lgkmcnt(10)
  v_mfma_f32_16x16x32_bf16 v[112:115], a[72:75], v[48:51], v[112:115]
  ds_read_b128 v[44:47], v4 offset:53248
  v_mfma_f32_16x16x32_bf16 v[116:119], a[76:79], v[48:51], v[116:119]
  v_lshlrev_b32 v24, 16, v36
  v_mfma_f32_16x16x32_bf16 v[104:107], a[80:83], v[48:51], v[104:107]
  v_and_b32 v25, 0xffff0000, v36
  v_mfma_f32_16x16x32_bf16 v[108:111], a[84:87], v[48:51], v[108:111]
  s_add_u32 m0, s36, 159744
  s_add_u32 s37, s89, 69632
  v_mfma_f32_16x16x32_bf16 v[96:99], a[88:91], v[48:51], v[96:99]
  buffer_load_dwordx4 v16, s[12:15], s37 offen lds
  v_mfma_f32_16x16x32_bf16 v[100:103], a[92:95], v[48:51], v[100:103]
  s_waitcnt lgkmcnt(6)
  v_mfma_f32_16x16x32_bf16 v[120:123], a[72:75], v[52:55], v[120:123]
  ds_read_b128 v[48:51], v4 offset:57344
  v_mfma_f32_16x16x32_bf16 v[124:127], a[76:79], v[52:55], v[124:127]
  v_rcp_f32 v24, v24
  v_mfma_f32_16x16x32_bf16 v[112:115], a[80:83], v[52:55], v[112:115]
  s_add_u32 m0, s36, 90112
  s_add_u32 s37, s93, 65536
  v_mfma_f32_16x16x32_bf16 v[116:119], a[84:87], v[52:55], v[116:119]
  buffer_load_dwordx4 v16, s[12:15], s37 offen lds
  v_mfma_f32_16x16x32_bf16 v[104:107], a[88:91], v[52:55], v[104:107]
  v_rcp_f32 v25, v25
  v_mfma_f32_16x16x32_bf16 v[108:111], a[92:95], v[52:55], v[108:111]
  v_cvt_pk_bf16_f32 v36, v24, v25
  s_waitcnt lgkmcnt(2)
  v_mfma_f32_16x16x32_bf16 v[56:59], a[96:99], v[40:43], v[56:59]
  ds_read_b128 v[52:55], v4 offset:61440
  v_mfma_f32_16x16x32_bf16 v[60:63], a[100:103], v[40:43], v[60:63]
  s_add_u32 m0, s36, 131072
  s_add_u32 s37, s93, 69632
  v_mfma_f32_16x16x32_bf16 v[64:67], a[104:107], v[40:43], v[64:67]
  buffer_load_dwordx4 v16, s[12:15], s37 offen lds
  v_mfma_f32_16x16x32_bf16 v[68:71], a[108:111], v[40:43], v[68:71]
  v_lshlrev_b32 v24, 16, v36
  s_barrier
  s_waitcnt lgkmcnt(2)
  v_mfma_f32_16x16x32_bf16 v[72:75], a[96:99], v[44:47], v[72:75]
  ds_read_b128 v[40:43], v8 offset:0
  v_mfma_f32_16x16x32_bf16 v[76:79], a[100:103], v[44:47], v[76:79]
  v_and_b32 v25, 0xffff0000, v36
  v_mfma_f32_16x16x32_bf16 v[56:59], a[104:107], v[44:47], v[56:59]
  s_add_u32 m0, s36, 94208
  s_add_u32 s37, s97, 65536
  v_mfma_f32_16x16x32_bf16 v[60:63], a[108:111], v[44:47], v[60:63]
  buffer_load_dwordx4 v16, s[12:15], s37 offen lds
  v_mfma_f32_16x16x32_bf16 v[64:67], a[112:115], v[44:47], v[64:67]
  v_lshlrev_b32 v37, 16, v2
  v_mfma_f32_16x16x32_bf16 v[68:71], a[116:119], v[44:47], v[68:71]
  v_and_b32 v38, 0xffff0000, v2
  s_waitcnt lgkmcnt(2)
  v_mfma_f32_16x16x32_bf16 v[80:83], a[96:99], v[48:51], v[80:83]
  ds_read_b128 v[44:47], v8 offset:4096
  v_mfma_f32_16x16x32_bf16 v[84:87], a[100:103], v[48:51], v[84:87]
  s_waitcnt vmcnt(18)
  ds_read_b64_tr_b16 a[120:121], v14 offset:4096
  v_mfma_f32_16x16x32_bf16 v[72:75], a[104:107], v[48:51], v[72:75]
  ds_read_b64_tr_b16 a[124:125], v14 offset:4104
  s_add_u32 m0, s36, 0
  v_mfma_f32_16x16x32_bf16 v[76:79], a[108:111], v[48:51], v[76:79]
  s_waitcnt vmcnt(17)
  ds_read_b64_tr_b16 a[122:123], v14 offset:8192
  v_mfma_f32_16x16x32_bf16 v[56:59], a[112:115], v[48:51], v[56:59]
  ds_read_b64_tr_b16 a[126:127], v14 offset:8200
  s_add_u32 s37, s97, 69632
  v_mfma_f32_16x16x32_bf16 v[60:63], a[116:119], v[48:51], v[60:63]
  buffer_load_dwordx4 v16, s[12:15], s37 offen lds
  s_waitcnt lgkmcnt(6)
  v_mfma_f32_16x16x32_bf16 v[88:91], a[96:99], v[52:55], v[88:91]
  ds_read_b128 v[48:51], v8 offset:8192
  v_mfma_f32_16x16x32_bf16 v[92:95], a[100:103], v[52:55], v[92:95]
  s_waitcnt vmcnt(17)
  ds_read_b64_tr_b16 a[128:129], v14 offset:12288
  v_mfma_f32_16x16x32_bf16 v[80:83], a[104:107], v[52:55], v[80:83]
  ds_read_b64_tr_b16 a[132:133], v14 offset:12296
  v_mfma_f32_16x16x32_bf16 v[84:87], a[108:111], v[52:55], v[84:87]
  s_waitcnt vmcnt(16)
  ds_read_b64_tr_b16 a[130:131], v14 offset:16384
  v_mfma_f32_16x16x32_bf16 v[72:75], a[112:115], v[52:55], v[72:75]
  ds_read_b64_tr_b16 a[134:135], v14 offset:16392
  s_add_u32 m0, s36, 4096
  v_mfma_f32_16x16x32_bf16 v[76:79], a[116:119], v[52:55], v[76:79]
  s_add_u32 s37, s89, 98304
  s_waitcnt lgkmcnt(10)
  v_mfma_f32_16x16x32_bf16 v[96:99], a[96:99], v[40:43], v[96:99]
  ds_read_b128 v[52:55], v8 offset:12288
  buffer_load_dwordx4 v16, s[12:15], s37 offen lds
  v_mfma_f32_16x16x32_bf16 v[100:103], a[100:103], v[40:43], v[100:103]
  s_waitcnt vmcnt(16)
  ds_read_b64_tr_b16 a[136:137], v14 offset:20480
  v_mfma_f32_16x16x32_bf16 v[88:91], a[104:107], v[40:43], v[88:91]
  ds_read_b64_tr_b16 a[140:141], v14 offset:20488
  v_mfma_f32_16x16x32_bf16 v[92:95], a[108:111], v[40:43], v[92:95]
  s_waitcnt vmcnt(15)
  ds_read_b64_tr_b16 a[138:139], v13 offset:53248
  v_mfma_f32_16x16x32_bf16 v[80:83], a[112:115], v[40:43], v[80:83]
  ds_read_b64_tr_b16 a[142:143], v13 offset:53256
  s_add_u32 m0, s36, 8192
  v_mfma_f32_16x16x32_bf16 v[84:87], a[116:119], v[40:43], v[84:87]
  s_add_u32 s37, s89, 102400
  s_waitcnt lgkmcnt(14)
  v_mfma_f32_16x16x32_bf16 v[104:107], a[96:99], v[44:47], v[104:107]
  ds_read_b128 v[40:43], v5 offset:49152
  buffer_load_dwordx4 v16, s[12:15], s37 offen lds
  v_mfma_f32_16x16x32_bf16 v[108:111], a[100:103], v[44:47], v[108:111]
  v_mul_f32 v24, v24, v37
  v_mfma_f32_16x16x32_bf16 v[96:99], a[104:107], v[44:47], v[96:99]
  v_mul_f32 v25, v25, v38
  v_mfma_f32_16x16x32_bf16 v[100:103], a[108:111], v[44:47], v[100:103]
  v_cvt_pk_bf16_f32 v36, v24, v25
  v_mfma_f32_16x16x32_bf16 v[88:91], a[112:115], v[44:47], v[88:91]
  s_add_u32 m0, s36, 12288
  s_add_u32 s37, s93, 98304
  v_mfma_f32_16x16x32_bf16 v[92:95], a[116:119], v[44:47], v[92:95]
  buffer_load_dwordx4 v16, s[12:15], s37 offen lds
  s_waitcnt lgkmcnt(10)
  v_mfma_f32_16x16x32_bf16 v[112:115], a[96:99], v[48:51], v[112:115]
  ds_read_b128 v[44:47], v5 offset:53248
  v_mfma_f32_16x16x32_bf16 v[116:119], a[100:103], v[48:51], v[116:119]
  v_lshlrev_b32 v24, 16, v36
  v_mfma_f32_16x16x32_bf16 v[104:107], a[104:107], v[48:51], v[104:107]
  v_and_b32 v25, 0xffff0000, v36
  v_mfma_f32_16x16x32_bf16 v[108:111], a[108:111], v[48:51], v[108:111]
  s_add_u32 m0, s36, 135168
  s_add_u32 s37, s93, 102400
  v_mfma_f32_16x16x32_bf16 v[96:99], a[112:115], v[48:51], v[96:99]
  buffer_load_dwordx4 v16, s[12:15], s37 offen lds
  v_mfma_f32_16x16x32_bf16 v[100:103], a[116:119], v[48:51], v[100:103]
  v_lshlrev_b32 v26, 16, v27
  s_waitcnt lgkmcnt(6)
  v_mfma_f32_16x16x32_bf16 v[120:123], a[96:99], v[52:55], v[120:123]
  ds_read_b128 v[48:51], v5 offset:57344
  v_mfma_f32_16x16x32_bf16 v[124:127], a[100:103], v[52:55], v[124:127]
  v_and_b32 v27, 0xffff0000, v27
  v_mfma_f32_16x16x32_bf16 v[112:115], a[104:107], v[52:55], v[112:115]
  s_add_u32 m0, s36, 139264
  s_add_u32 s37, s97, 98304
  v_mfma_f32_16x16x32_bf16 v[116:119], a[108:111], v[52:55], v[116:119]
  buffer_load_dwordx4 v16, s[12:15], s37 offen lds
  v_mfma_f32_16x16x32_bf16 v[104:107], a[112:115], v[52:55], v[104:107]
  v_add_f32 v26, 0x3727c5ac, v26
  v_mfma_f32_16x16x32_bf16 v[108:111], a[116:119], v[52:55], v[108:111]
  v_add_f32 v27, 0x3727c5ac, v27
  s_waitcnt lgkmcnt(2)
  v_mfma_f32_16x16x32_bf16 v[56:59], a[120:123], v[40:43], v[56:59]
  ds_read_b128 v[52:55], v5 offset:61440
  v_mfma_f32_16x16x32_bf16 v[60:63], a[124:127], v[40:43], v[60:63]
  s_add_u32 m0, s36, 143360
  s_add_u32 s37, s97, 102400
  v_mfma_f32_16x16x32_bf16 v[64:67], a[128:131], v[40:43], v[64:67]
  buffer_load_dwordx4 v16, s[12:15], s37 offen lds
  v_mfma_f32_16x16x32_bf16 v[68:71], a[132:135], v[40:43], v[68:71]
  v_cvt_pk_bf16_f32 v36, v26, v27
  s_waitcnt lgkmcnt(2)
  v_mfma_f32_16x16x32_bf16 v[72:75], a[120:123], v[44:47], v[72:75]
  ds_read_b128 v[40:43], v9 offset:0
  v_mfma_f32_16x16x32_bf16 v[76:79], a[124:127], v[44:47], v[76:79]
  v_lshlrev_b32 v26, 16, v36
  v_mfma_f32_16x16x32_bf16 v[56:59], a[128:131], v[44:47], v[56:59]
  s_add_u32 m0, s36, 147456
  s_add_u32 s37, s90, 0
  v_mfma_f32_16x16x32_bf16 v[60:63], a[132:135], v[44:47], v[60:63]
  buffer_load_dwordx4 v16, s[12:15], s37 offen lds
  v_mfma_f32_16x16x32_bf16 v[64:67], a[136:139], v[44:47], v[64:67]
  v_and_b32 v27, 0xffff0000, v36
  v_mfma_f32_16x16x32_bf16 v[68:71], a[140:143], v[44:47], v[68:71]
  s_waitcnt lgkmcnt(2)
  v_mfma_f32_16x16x32_bf16 v[80:83], a[120:123], v[48:51], v[80:83]
  ds_read_b128 v[44:47], v9 offset:4096
  v_mfma_f32_16x16x32_bf16 v[84:87], a[124:127], v[48:51], v[84:87]
  s_waitcnt vmcnt(12)
  ds_read_b64_tr_b16 a[144:145], v14 offset:24576
  v_mfma_f32_16x16x32_bf16 v[72:75], a[128:131], v[48:51], v[72:75]
  ds_read_b64_tr_b16 a[148:149], v14 offset:24584
  s_add_u32 m0, s36, 151552
  v_mfma_f32_16x16x32_bf16 v[76:79], a[132:135], v[48:51], v[76:79]
  s_waitcnt vmcnt(11)
  ds_read_b64_tr_b16 a[146:147], v14 offset:28672
  v_mfma_f32_16x16x32_bf16 v[56:59], a[136:139], v[48:51], v[56:59]
  ds_read_b64_tr_b16 a[150:151], v14 offset:28680
  s_add_u32 s37, s90, 4096
  v_mfma_f32_16x16x32_bf16 v[60:63], a[140:143], v[48:51], v[60:63]
  buffer_load_dwordx4 v16, s[12:15], s37 offen lds
  s_waitcnt lgkmcnt(6)
  v_mfma_f32_16x16x32_bf16 v[88:91], a[120:123], v[52:55], v[88:91]
  ds_read_b128 v[48:51], v9 offset:8192
  v_mfma_f32_16x16x32_bf16 v[92:95], a[124:127], v[52:55], v[92:95]
  s_waitcnt vmcnt(11)
  ds_read_b64_tr_b16 a[152:153], v13 offset:24576
  v_mfma_f32_16x16x32_bf16 v[80:83], a[128:131], v[52:55], v[80:83]
  ds_read_b64_tr_b16 a[156:157], v13 offset:24584
  v_mfma_f32_16x16x32_bf16 v[84:87], a[132:135], v[52:55], v[84:87]
  s_waitcnt vmcnt(10)
  ds_read_b64_tr_b16 a[154:155], v14 offset:0
  v_mfma_f32_16x16x32_bf16 v[72:75], a[136:139], v[52:55], v[72:75]
  ds_read_b64_tr_b16 a[158:159], v14 offset:8
  s_add_u32 m0, s36, 16384
  v_mfma_f32_16x16x32_bf16 v[76:79], a[140:143], v[52:55], v[76:79]
  s_add_u32 s37, s94, 0
  s_waitcnt lgkmcnt(10)
  v_mfma_f32_16x16x32_bf16 v[96:99], a[120:123], v[40:43], v[96:99]
  ds_read_b128 v[52:55], v9 offset:12288
  buffer_load_dwordx4 v16, s[12:15], s37 offen lds
  v_mfma_f32_16x16x32_bf16 v[100:103], a[124:127], v[40:43], v[100:103]
  s_waitcnt vmcnt(10)
  ds_read_b64_tr_b16 a[160:161], v13 offset:28672
  v_mfma_f32_16x16x32_bf16 v[88:91], a[128:131], v[40:43], v[88:91]
  ds_read_b64_tr_b16 a[164:165], v13 offset:28680
  v_mfma_f32_16x16x32_bf16 v[92:95], a[132:135], v[40:43], v[92:95]
  s_waitcnt vmcnt(9)
  ds_read_b64_tr_b16 a[162:163], v12 offset:0
  v_mfma_f32_16x16x32_bf16 v[80:83], a[136:139], v[40:43], v[80:83]
  ds_read_b64_tr_b16 a[166:167], v12 offset:8
  s_add_u32 m0, s36, 98304
  v_mfma_f32_16x16x32_bf16 v[84:87], a[140:143], v[40:43], v[84:87]
  s_add_u32 s37, s94, 4096
  s_waitcnt lgkmcnt(14)
  v_mfma_f32_16x16x32_bf16 v[104:107], a[120:123], v[44:47], v[104:107]
  ds_read_b128 v[40:43], v6 offset:49152
  buffer_load_dwordx4 v16, s[12:15], s37 offen lds
  v_mfma_f32_16x16x32_bf16 v[108:111], a[124:127], v[44:47], v[108:111]
  v_sqrt_f32 v26, v26
  v_mfma_f32_16x16x32_bf16 v[96:99], a[128:131], v[44:47], v[96:99]
  v_sqrt_f32 v27, v27
  v_mfma_f32_16x16x32_bf16 v[100:103], a[132:135], v[44:47], v[100:103]
  v_cvt_pk_bf16_f32 v36, v26, v27
  v_mfma_f32_16x16x32_bf16 v[88:91], a[136:139], v[44:47], v[88:91]
  s_add_u32 m0, s36, 102400
  s_add_u32 s37, s98, 0
  v_mfma_f32_16x16x32_bf16 v[92:95], a[140:143], v[44:47], v[92:95]
  buffer_load_dwordx4 v16, s[12:15], s37 offen lds
  s_waitcnt lgkmcnt(10)
  v_mfma_f32_16x16x32_bf16 v[112:115], a[120:123], v[48:51], v[112:115]
  ds_read_b128 v[44:47], v6 offset:53248
  v_mfma_f32_16x16x32_bf16 v[116:119], a[124:127], v[48:51], v[116:119]
  v_lshlrev_b32 v26, 16, v36
  v_mfma_f32_16x16x32_bf16 v[104:107], a[128:131], v[48:51], v[104:107]
  v_and_b32 v27, 0xffff0000, v36
  v_mfma_f32_16x16x32_bf16 v[108:111], a[132:135], v[48:51], v[108:111]
  s_add_u32 m0, s36, 155648
  s_add_u32 s37, s98, 4096
  v_mfma_f32_16x16x32_bf16 v[96:99], a[136:139], v[48:51], v[96:99]
  buffer_load_dwordx4 v16, s[12:15], s37 offen lds
  v_mfma_f32_16x16x32_bf16 v[100:103], a[140:143], v[48:51], v[100:103]
  s_waitcnt lgkmcnt(6)
  v_mfma_f32_16x16x32_bf16 v[120:123], a[120:123], v[52:55], v[120:123]
  ds_read_b128 v[48:51], v6 offset:57344
  v_mfma_f32_16x16x32_bf16 v[124:127], a[124:127], v[52:55], v[124:127]
  v_rcp_f32 v26, v26
  v_mfma_f32_16x16x32_bf16 v[112:115], a[128:131], v[52:55], v[112:115]
  s_add_u32 m0, s36, 159744
  s_add_u32 s37, s90, 32768
  v_mfma_f32_16x16x32_bf16 v[116:119], a[132:135], v[52:55], v[116:119]
  buffer_load_dwordx4 v16, s[12:15], s37 offen lds
  v_mfma_f32_16x16x32_bf16 v[104:107], a[136:139], v[52:55], v[104:107]
  v_rcp_f32 v27, v27
  v_mfma_f32_16x16x32_bf16 v[108:111], a[140:143], v[52:55], v[108:111]
  v_cvt_pk_bf16_f32 v36, v26, v27
  s_waitcnt lgkmcnt(2)
  v_mfma_f32_16x16x32_bf16 v[56:59], a[144:147], v[40:43], v[56:59]
  ds_read_b128 v[52:55], v6 offset:61440
  v_mfma_f32_16x16x32_bf16 v[60:63], a[148:151], v[40:43], v[60:63]
  s_add_u32 m0, s36, 131072
  s_add_u32 s37, s90, 36864
  v_mfma_f32_16x16x32_bf16 v[64:67], a[152:155], v[40:43], v[64:67]
  buffer_load_dwordx4 v16, s[12:15], s37 offen lds
  v_mfma_f32_16x16x32_bf16 v[68:71], a[156:159], v[40:43], v[68:71]
  v_lshlrev_b32 v26, 16, v36
  s_waitcnt lgkmcnt(2)
  v_mfma_f32_16x16x32_bf16 v[72:75], a[144:147], v[44:47], v[72:75]
  ds_read_b128 v[40:43], v10 offset:0
  v_mfma_f32_16x16x32_bf16 v[76:79], a[148:151], v[44:47], v[76:79]
  v_and_b32 v27, 0xffff0000, v36
  v_mfma_f32_16x16x32_bf16 v[56:59], a[152:155], v[44:47], v[56:59]
  s_add_u32 m0, s36, 106496
  s_add_u32 s37, s94, 32768
  v_mfma_f32_16x16x32_bf16 v[60:63], a[156:159], v[44:47], v[60:63]
  buffer_load_dwordx4 v16, s[12:15], s37 offen lds
  v_mfma_f32_16x16x32_bf16 v[64:67], a[160:163], v[44:47], v[64:67]
  v_lshlrev_b32 v37, 16, v3
  v_mfma_f32_16x16x32_bf16 v[68:71], a[164:167], v[44:47], v[68:71]
  v_and_b32 v38, 0xffff0000, v3
  s_waitcnt lgkmcnt(2)
  v_mfma_f32_16x16x32_bf16 v[80:83], a[144:147], v[48:51], v[80:83]
  ds_read_b128 v[44:47], v10 offset:4096
  v_mfma_f32_16x16x32_bf16 v[84:87], a[148:151], v[48:51], v[84:87]
  s_waitcnt vmcnt(14)
  ds_read_b64_tr_b16 a[168:169], v12 offset:4096
  v_mfma_f32_16x16x32_bf16 v[72:75], a[152:155], v[48:51], v[72:75]
  ds_read_b64_tr_b16 a[172:173], v12 offset:4104
  s_add_u32 m0, s36, 110592
  v_mfma_f32_16x16x32_bf16 v[76:79], a[156:159], v[48:51], v[76:79]
  s_waitcnt vmcnt(13)
  ds_read_b64_tr_b16 a[170:171], v12 offset:8192
  v_mfma_f32_16x16x32_bf16 v[56:59], a[160:163], v[48:51], v[56:59]
  ds_read_b64_tr_b16 a[174:175], v12 offset:8200
  s_add_u32 s37, s94, 36864
  v_mfma_f32_16x16x32_bf16 v[60:63], a[164:167], v[48:51], v[60:63]
  buffer_load_dwordx4 v16, s[12:15], s37 offen lds
  s_waitcnt lgkmcnt(6)
  v_mfma_f32_16x16x32_bf16 v[88:91], a[144:147], v[52:55], v[88:91]
  ds_read_b128 v[48:51], v10 offset:8192
  v_mfma_f32_16x16x32_bf16 v[92:95], a[148:151], v[52:55], v[92:95]
  s_waitcnt vmcnt(13)
  ds_read_b64_tr_b16 a[176:177], v12 offset:12288
  v_mfma_f32_16x16x32_bf16 v[80:83], a[152:155], v[52:55], v[80:83]
  ds_read_b64_tr_b16 a[180:181], v12 offset:12296
  v_mfma_f32_16x16x32_bf16 v[84:87], a[156:159], v[52:55], v[84:87]
  s_waitcnt vmcnt(12)
  ds_read_b64_tr_b16 a[178:179], v14 offset:4096
  v_mfma_f32_16x16x32_bf16 v[72:75], a[160:163], v[52:55], v[72:75]
  ds_read_b64_tr_b16 a[182:183], v14 offset:4104
  s_add_u32 m0, s36, 114688
  v_mfma_f32_16x16x32_bf16 v[76:79], a[164:167], v[52:55], v[76:79]
  s_add_u32 s37, s98, 32768
  s_waitcnt lgkmcnt(10)
  v_mfma_f32_16x16x32_bf16 v[96:99], a[144:147], v[40:43], v[96:99]
  ds_read_b128 v[52:55], v10 offset:12288
  buffer_load_dwordx4 v16, s[12:15], s37 offen lds
  v_mfma_f32_16x16x32_bf16 v[100:103], a[148:151], v[40:43], v[100:103]
  s_waitcnt vmcnt(12)
  ds_read_b64_tr_b16 a[184:185], v14 offset:8192
  v_mfma_f32_16x16x32_bf16 v[88:91], a[152:155], v[40:43], v[88:91]
  ds_read_b64_tr_b16 a[188:189], v14 offset:8200
  v_mfma_f32_16x16x32_bf16 v[92:95], a[156:159], v[40:43], v[92:95]
  s_waitcnt vmcnt(11)
  ds_read_b64_tr_b16 a[186:187], v14 offset:12288
  v_mfma_f32_16x16x32_bf16 v[80:83], a[160:163], v[40:43], v[80:83]
  ds_read_b64_tr_b16 a[190:191], v14 offset:12296
  s_add_u32 m0, s36, 20480
  v_mfma_f32_16x16x32_bf16 v[84:87], a[164:167], v[40:43], v[84:87]
  s_add_u32 s37, s98, 36864
  s_waitcnt lgkmcnt(14)
  v_mfma_f32_16x16x32_bf16 v[104:107], a[144:147], v[44:47], v[104:107]
  ds_read_b128 v[40:43], v7 offset:49152
  buffer_load_dwordx4 v16, s[12:15], s37 offen lds
  v_mfma_f32_16x16x32_bf16 v[108:111], a[148:151], v[44:47], v[108:111]
  v_mul_f32 v26, v26, v37
  v_mfma_f32_16x16x32_bf16 v[96:99], a[152:155], v[44:47], v[96:99]
  v_mul_f32 v27, v27, v38
  v_mfma_f32_16x16x32_bf16 v[100:103], a[156:159], v[44:47], v[100:103]
  v_cvt_pk_bf16_f32 v36, v26, v27
  v_mfma_f32_16x16x32_bf16 v[88:91], a[160:163], v[44:47], v[88:91]
  s_add_u32 m0, s36, 24576
  s_add_u32 s37, s87, 0
  v_mfma_f32_16x16x32_bf16 v[92:95], a[164:167], v[44:47], v[92:95]
  buffer_load_dwordx4 v15, s[8:11], s37 offen nt lds
  s_waitcnt lgkmcnt(10)
  v_mfma_f32_16x16x32_bf16 v[112:115], a[144:147], v[48:51], v[112:115]
  ds_read_b128 v[44:47], v7 offset:53248
  v_mfma_f32_16x16x32_bf16 v[116:119], a[148:151], v[48:51], v[116:119]
  v_lshlrev_b32 v26, 16, v36
  v_mfma_f32_16x16x32_bf16 v[104:107], a[152:155], v[48:51], v[104:107]
  v_and_b32 v27, 0xffff0000, v36
  v_mfma_f32_16x16x32_bf16 v[108:111], a[156:159], v[48:51], v[108:111]
  s_add_u32 m0, s36, 28672
  s_add_u32 s37, s87, 1024
  v_mfma_f32_16x16x32_bf16 v[96:99], a[160:163], v[48:51], v[96:99]
  buffer_load_dwordx4 v15, s[8:11], s37 offen nt lds
  v_mfma_f32_16x16x32_bf16 v[100:103], a[164:167], v[48:51], v[100:103]
  buffer_load_dwordx4 v[0:3], v18, s[20:23], 0 offen
  s_waitcnt lgkmcnt(6)
  v_mfma_f32_16x16x32_bf16 v[120:123], a[144:147], v[52:55], v[120:123]
  ds_read_b128 v[48:51], v7 offset:57344
  v_mfma_f32_16x16x32_bf16 v[124:127], a[148:151], v[52:55], v[124:127]
  v_mfma_f32_16x16x32_bf16 v[112:115], a[152:155], v[52:55], v[112:115]
  s_add_u32 m0, s36, 118784
  s_add_u32 s37, s87, 2048
  v_mfma_f32_16x16x32_bf16 v[116:119], a[156:159], v[52:55], v[116:119]
  buffer_load_dwordx4 v15, s[8:11], s37 offen nt lds
  v_mfma_f32_16x16x32_bf16 v[104:107], a[160:163], v[52:55], v[104:107]
  v_mfma_f32_16x16x32_bf16 v[108:111], a[164:167], v[52:55], v[108:111]
  s_waitcnt lgkmcnt(2)
  v_mfma_f32_16x16x32_bf16 v[56:59], a[168:171], v[40:43], v[56:59]
  ds_read_b128 v[52:55], v7 offset:61440
  v_mfma_f32_16x16x32_bf16 v[60:63], a[172:175], v[40:43], v[60:63]
  s_add_u32 m0, s36, 90112
  s_add_u32 s37, s87, 3072
  v_mfma_f32_16x16x32_bf16 v[64:67], a[176:179], v[40:43], v[64:67]
  buffer_load_dwordx4 v15, s[8:11], s37 offen nt lds
  v_mfma_f32_16x16x32_bf16 v[68:71], a[180:183], v[40:43], v[68:71]
  s_waitcnt lgkmcnt(2)
  v_mfma_f32_16x16x32_bf16 v[72:75], a[168:171], v[44:47], v[72:75]
  ds_read_b128 v[40:43], v11 offset:0
  v_mfma_f32_16x16x32_bf16 v[76:79], a[172:175], v[44:47], v[76:79]
  v_mfma_f32_16x16x32_bf16 v[56:59], a[176:179], v[44:47], v[56:59]
  s_add_u32 m0, s36, 94208
  s_add_u32 s37, s87, 4096
  v_mfma_f32_16x16x32_bf16 v[60:63], a[180:183], v[44:47], v[60:63]
  buffer_load_dwordx4 v15, s[8:11], s37 offen nt lds
  v_mfma_f32_16x16x32_bf16 v[64:67], a[184:187], v[44:47], v[64:67]
  v_mfma_f32_16x16x32_bf16 v[68:71], a[188:191], v[44:47], v[68:71]
  s_waitcnt lgkmcnt(2)
  v_mfma_f32_16x16x32_bf16 v[80:83], a[168:171], v[48:51], v[80:83]
  ds_read_b128 v[44:47], v11 offset:4096
  v_mfma_f32_16x16x32_bf16 v[84:87], a[172:175], v[48:51], v[84:87]
  s_waitcnt vmcnt(17)
  ds_read_b64_tr_b16 a[192:193], v14 offset:16384
  v_mfma_f32_16x16x32_bf16 v[72:75], a[176:179], v[48:51], v[72:75]
  ds_read_b64_tr_b16 a[196:197], v14 offset:16392
  s_add_u32 m0, s36, 0
  v_mfma_f32_16x16x32_bf16 v[76:79], a[180:183], v[48:51], v[76:79]
  s_waitcnt vmcnt(16)
  ds_read_b64_tr_b16 a[194:195], v14 offset:20480
  v_mfma_f32_16x16x32_bf16 v[56:59], a[184:187], v[48:51], v[56:59]
  ds_read_b64_tr_b16 a[198:199], v14 offset:20488
  s_add_u32 s37, s87, 5120
  v_mfma_f32_16x16x32_bf16 v[60:63], a[188:191], v[48:51], v[60:63]
  buffer_load_dwordx4 v15, s[8:11], s37 offen nt lds
  s_waitcnt lgkmcnt(6)
  v_mfma_f32_16x16x32_bf16 v[88:91], a[168:171], v[52:55], v[88:91]
  ds_read_b128 v[48:51], v11 offset:8192
  v_mfma_f32_16x16x32_bf16 v[92:95], a[172:175], v[52:55], v[92:95]
  s_waitcnt vmcnt(16)
  ds_read_b64_tr_b16 a[200:201], v12 offset:16384
  v_mfma_f32_16x16x32_bf16 v[80:83], a[176:179], v[52:55], v[80:83]
  ds_read_b64_tr_b16 a[204:205], v12 offset:16392
  v_mfma_f32_16x16x32_bf16 v[84:87], a[180:183], v[52:55], v[84:87]
  s_waitcnt vmcnt(15)
  ds_read_b64_tr_b16 a[202:203], v13 offset:32768
  v_mfma_f32_16x16x32_bf16 v[72:75], a[184:187], v[52:55], v[72:75]
  ds_read_b64_tr_b16 a[206:207], v13 offset:32776
  s_add_u32 m0, s36, 4096
  v_mfma_f32_16x16x32_bf16 v[76:79], a[188:191], v[52:55], v[76:79]
  s_add_u32 s37, s87, 6144
  s_waitcnt lgkmcnt(10)
  v_mfma_f32_16x16x32_bf16 v[96:99], a[168:171], v[40:43], v[96:99]
  ds_read_b128 v[52:55], v11 offset:12288
  buffer_load_dwordx4 v15, s[8:11], s37 offen nt lds
  v_mfma_f32_16x16x32_bf16 v[100:103], a[172:175], v[40:43], v[100:103]
  s_waitcnt vmcnt(15)
  ds_read_b64_tr_b16 a[208:209], v13 offset:36864
  v_mfma_f32_16x16x32_bf16 v[88:91], a[176:179], v[40:43], v[88:91]
  ds_read_b64_tr_b16 a[212:213], v13 offset:36872
  v_mfma_f32_16x16x32_bf16 v[92:95], a[180:183], v[40:43], v[92:95]
  s_waitcnt vmcnt(14)
  ds_read_b64_tr_b16 a[210:211], v14 offset:24576
  v_mfma_f32_16x16x32_bf16 v[80:83], a[184:187], v[40:43], v[80:83]
  ds_read_b64_tr_b16 a[214:215], v14 offset:24584
  s_add_u32 m0, s36, 8192
  v_mfma_f32_16x16x32_bf16 v[84:87], a[188:191], v[40:43], v[84:87]
  s_add_u32 s37, s87, 7168
  s_barrier
  s_waitcnt lgkmcnt(14)
  v_mfma_f32_16x16x32_bf16 v[104:107], a[168:171], v[44:47], v[104:107]
  ds_read_b128 v[40:43], v8 offset:57344
  buffer_load_dwordx4 v15, s[8:11], s37 offen nt lds
  v_mfma_f32_16x16x32_bf16 v[108:111], a[172:175], v[44:47], v[108:111]
  v_mfma_f32_16x16x32_bf16 v[96:99], a[176:179], v[44:47], v[96:99]
  v_mfma_f32_16x16x32_bf16 v[100:103], a[180:183], v[44:47], v[100:103]
  v_mfma_f32_16x16x32_bf16 v[88:91], a[184:187], v[44:47], v[88:91]
  s_add_u32 m0, s36, 135168
  s_add_u32 s37, s90, 65536
  v_mfma_f32_16x16x32_bf16 v[92:95], a[188:191], v[44:47], v[92:95]
  buffer_load_dwordx4 v16, s[12:15], s37 offen lds
  s_waitcnt lgkmcnt(10)
  v_mfma_f32_16x16x32_bf16 v[112:115], a[168:171], v[48:51], v[112:115]
  ds_read_b128 v[44:47], v8 offset:61440
  v_mfma_f32_16x16x32_bf16 v[116:119], a[172:175], v[48:51], v[116:119]
  v_mfma_f32_16x16x32_bf16 v[104:107], a[176:179], v[48:51], v[104:107]
  v_mfma_f32_16x16x32_bf16 v[108:111], a[180:183], v[48:51], v[108:111]
  s_add_u32 m0, s36, 139264
  s_add_u32 s37, s90, 69632
  v_mfma_f32_16x16x32_bf16 v[96:99], a[184:187], v[48:51], v[96:99]
  buffer_load_dwordx4 v16, s[12:15], s37 offen lds
  v_mfma_f32_16x16x32_bf16 v[100:103], a[188:191], v[48:51], v[100:103]
  s_waitcnt lgkmcnt(6)
  v_mfma_f32_16x16x32_bf16 v[120:123], a[168:171], v[52:55], v[120:123]
  ds_read_b128 v[48:51], v4 offset:32768
  v_mfma_f32_16x16x32_bf16 v[124:127], a[172:175], v[52:55], v[124:127]
  v_mfma_f32_16x16x32_bf16 v[112:115], a[176:179], v[52:55], v[112:115]
  s_add_u32 m0, s36, 143360
  s_add_u32 s37, s94, 65536
  v_mfma_f32_16x16x32_bf16 v[116:119], a[180:183], v[52:55], v[116:119]
  buffer_load_dwordx4 v16, s[12:15], s37 offen lds
  v_mfma_f32_16x16x32_bf16 v[104:107], a[184:187], v[52:55], v[104:107]
  v_mfma_f32_16x16x32_bf16 v[108:111], a[188:191], v[52:55], v[108:111]
  s_waitcnt lgkmcnt(2)
  v_mfma_f32_16x16x32_bf16 v[56:59], a[192:195], v[40:43], v[56:59]
  ds_read_b128 v[52:55], v4 offset:36864
  s_waitcnt vmcnt(9)
  v_mfma_f32_16x16x32_bf16 v[60:63], a[196:199], v[40:43], v[60:63]
  s_add_u32 m0, s36, 147456
  s_add_u32 s37, s94, 69632
  v_mfma_f32_16x16x32_bf16 v[64:67], a[200:203], v[40:43], v[64:67]
  buffer_load_dwordx4 v16, s[12:15], s37 offen lds
  v_mfma_f32_16x16x32_bf16 v[68:71], a[204:207], v[40:43], v[68:71]
  v_lshlrev_b32 v37, 16, v0
  s_barrier
  s_waitcnt lgkmcnt(2)
  v_mfma_f32_16x16x32_bf16 v[72:75], a[192:195], v[44:47], v[72:75]
  ds_read_b128 v[40:43], v4 offset:40960
  v_mfma_f32_16x16x32_bf16 v[76:79], a[196:199], v[44:47], v[76:79]
  v_and_b32 v38, 0xffff0000, v0
  v_mfma_f32_16x16x32_bf16 v[56:59], a[200:203], v[44:47], v[56:59]
  s_add_u32 m0, s36, 151552
  s_add_u32 s37, s98, 65536
  v_mfma_f32_16x16x32_bf16 v[60:63], a[204:207], v[44:47], v[60:63]
  buffer_load_dwordx4 v16, s[12:15], s37 offen lds
  v_mfma_f32_16x16x32_bf16 v[64:67], a[208:211], v[44:47], v[64:67]
  v_lshlrev_b32 v28, 16, v32
  v_mfma_f32_16x16x32_bf16 v[68:71], a[212:215], v[44:47], v[68:71]
  v_and_b32 v29, 0xffff0000, v32
  s_waitcnt lgkmcnt(2)
  v_mfma_f32_16x16x32_bf16 v[80:83], a[192:195], v[48:51], v[80:83]
  ds_read_b128 v[44:47], v4 offset:45056
  v_mfma_f32_16x16x32_bf16 v[84:87], a[196:199], v[48:51], v[84:87]
  ds_read_b64_tr_b16 a[216:217], v14 offset:28672
  ds_read_b64_tr_b16 a[220:221], v14 offset:28680
  v_mfma_f32_16x16x32_bf16 v[72:75], a[200:203], v[48:51], v[72:75]
  ds_read_b64_tr_b16 a[218:219], v14 offset:0
  ds_read_b64_tr_b16 a[222:223], v14 offset:8
  v_mfma_f32_16x16x32_bf16 v[76:79], a[204:207], v[48:51], v[76:79]
  ds_read_b64_tr_b16 a[224:225], v13 offset:40960
  ds_read_b64_tr_b16 a[228:229], v13 offset:40968
  v_mfma_f32_16x16x32_bf16 v[56:59], a[208:211], v[48:51], v[56:59]
  ds_read_b64_tr_b16 a[226:227], v13 offset:45056
  ds_read_b64_tr_b16 a[230:231], v13 offset:45064
  v_mfma_f32_16x16x32_bf16 v[60:63], a[212:215], v[48:51], v[60:63]
  s_add_u32 m0, s36, 155648
  s_waitcnt lgkmcnt(10)
  v_mfma_f32_16x16x32_bf16 v[88:91], a[192:195], v[52:55], v[88:91]
  ds_read_b128 v[48:51], v8 offset:16384
  s_add_u32 s37, s98, 69632
  v_mfma_f32_16x16x32_bf16 v[92:95], a[196:199], v[52:55], v[92:95]
  ds_read_b64_tr_b16 a[232:233], v13 offset:49152
  ds_read_b64_tr_b16 a[236:237], v13 offset:49160
  v_mfma_f32_16x16x32_bf16 v[80:83], a[200:203], v[52:55], v[80:83]
  ds_read_b64_tr_b16 a[234:235], v12 offset:20480
  ds_read_b64_tr_b16 a[238:239], v12 offset:20488
  v_mfma_f32_16x16x32_bf16 v[84:87], a[204:207], v[52:55], v[84:87]
  buffer_load_dwordx4 v16, s[12:15], s37 offen lds
  v_mfma_f32_16x16x32_bf16 v[72:75], a[208:211], v[52:55], v[72:75]
  v_fma_f32 v28, -v37, v20, v28
  v_mfma_f32_16x16x32_bf16 v[76:79], a[212:215], v[52:55], v[76:79]
  v_fma_f32 v29, -v38, v21, v29
  s_waitcnt lgkmcnt(14)
  v_mfma_f32_16x16x32_bf16 v[96:99], a[192:195], v[40:43], v[96:99]
  ds_read_b128 v[52:55], v8 offset:20480
  v_mfma_f32_16x16x32_bf16 v[100:103], a[196:199], v[40:43], v[100:103]
  s_add_u32 m0, s36, 12288
  s_add_u32 s37, s90, 98304
  v_mfma_f32_16x16x32_bf16 v[88:91], a[200:203], v[40:43], v[88:91]
  buffer_load_dwordx4 v16, s[12:15], s37 offen lds
  v_mfma_f32_16x16x32_bf16 v[92:95], a[204:207], v[40:43], v[92:95]
  v_mul_f32 v20, s54, v20
  v_mfma_f32_16x16x32_bf16 v[80:83], a[208:211], v[40:43], v[80:83]
  v_mul_f32 v21, s54, v21
  v_mfma_f32_16x16x32_bf16 v[84:87], a[212:215], v[40:43], v[84:87]
  v_mul_f32 v28, s54, v28
  s_waitcnt lgkmcnt(14)
  v_mfma_f32_16x16x32_bf16 v[104:107], a[192:195], v[44:47], v[104:107]
  ds_read_b128 v[40:43], v9 offset:57344
  s_add_u32 m0, s36, 49152
  v_mfma_f32_16x16x32_bf16 v[108:111], a[196:199], v[44:47], v[108:111]
  s_add_u32 s37, s90, 102400
  buffer_load_dwordx4 v16, s[12:15], s37 offen lds
  v_mfma_f32_16x16x32_bf16 v[96:99], a[200:203], v[44:47], v[96:99]
  v_mul_f32 v29, s54, v29
  v_mfma_f32_16x16x32_bf16 v[100:103], a[204:207], v[44:47], v[100:103]
  v_lshlrev_b32 v37, 16, v1
  v_mfma_f32_16x16x32_bf16 v[88:91], a[208:211], v[44:47], v[88:91]
  v_and_b32 v38, 0xffff0000, v1
  v_mfma_f32_16x16x32_bf16 v[92:95], a[212:215], v[44:47], v[92:95]
  s_add_u32 m0, s36, 53248
  s_waitcnt lgkmcnt(6)
  v_mfma_f32_16x16x32_bf16 v[112:115], a[192:195], v[48:51], v[112:115]
  ds_read_b128 v[44:47], v9 offset:61440
  s_add_u32 s37, s94, 98304
  v_mfma_f32_16x16x32_bf16 v[116:119], a[196:199], v[48:51], v[116:119]
  buffer_load_dwordx4 v16, s[12:15], s37 offen lds
  v_mfma_f32_16x16x32_bf16 v[104:107], a[200:203], v[48:51], v[104:107]
  v_lshlrev_b32 v30, 16, v33
  v_mfma_f32_16x16x32_bf16 v[108:111], a[204:207], v[48:51], v[108:111]
  v_and_b32 v31, 0xffff0000, v33
  v_mfma_f32_16x16x32_bf16 v[96:99], a[208:211], v[48:51], v[96:99]
  v_fma_f32 v30, -v37, v22, v30
  v_mfma_f32_16x16x32_bf16 v[100:103], a[212:215], v[48:51], v[100:103]
  s_add_u32 m0, s36, 159744
  s_waitcnt lgkmcnt(2)
  v_mfma_f32_16x16x32_bf16 v[120:123], a[192:195], v[52:55], v[120:123]
  ds_read_b128 v[48:51], v5 offset:32768
  s_add_u32 s37, s94, 102400
  v_mfma_f32_16x16x32_bf16 v[124:127], a[196:199], v[52:55], v[124:127]
  buffer_load_dwordx4 v16, s[12:15], s37 offen lds
  v_mfma_f32_16x16x32_bf16 v[112:115], a[200:203], v[52:55], v[112:115]
  v_fma_f32 v31, -v38, v23, v31
  v_mfma_f32_16x16x32_bf16 v[116:119], a[204:207], v[52:55], v[116:119]
  v_mul_f32 v22, s54, v22
  v_mfma_f32_16x16x32_bf16 v[104:107], a[208:211], v[52:55], v[104:107]
  v_mul_f32 v23, s54, v23
  v_mfma_f32_16x16x32_bf16 v[108:111], a[212:215], v[52:55], v[108:111]
  s_add_u32 m0, s36, 131072
  s_waitcnt lgkmcnt(2)
  v_mfma_f32_16x16x32_bf16 v[56:59], a[216:219], v[40:43], v[56:59]
  ds_read_b128 v[52:55], v5 offset:36864
  s_add_u32 s37, s98, 98304
  v_mfma_f32_16x16x32_bf16 v[60:63], a[220:223], v[40:43], v[60:63]
  buffer_load_dwordx4 v16, s[12:15], s37 offen lds
  v_mfma_f32_16x16x32_bf16 v[64:67], a[224:227], v[40:43], v[64:67]
  v_mul_f32 v30, s54, v30
  v_mfma_f32_16x16x32_bf16 v[68:71], a[228:231], v[40:43], v[68:71]
  v_mul_f32 v31, s54, v31
  s_waitcnt lgkmcnt(2)
  v_mfma_f32_16x16x32_bf16 v[72:75], a[216:219], v[44:47], v[72:75]
  ds_read_b128 v[40:43], v5 offset:40960
  v_mfma_f32_16x16x32_bf16 v[76:79], a[220:223], v[44:47], v[76:79]
  s_add_u32 m0, s36, 57344
  s_add_u32 s37, s98, 102400
  v_mfma_f32_16x16x32_bf16 v[56:59], a[224:227], v[44:47], v[56:59]
  buffer_load_dwordx4 v16, s[12:15], s37 offen lds
  v_mfma_f32_16x16x32_bf16 v[60:63], a[228:231], v[44:47], v[60:63]
  v_lshlrev_b32 v37, 16, v2
  v_mfma_f32_16x16x32_bf16 v[64:67], a[232:235], v[44:47], v[64:67]
  v_and_b32 v38, 0xffff0000, v2
  v_mfma_f32_16x16x32_bf16 v[68:71], a[236:239], v[44:47], v[68:71]
  v_lshlrev_b32 v32, 16, v34
  s_waitcnt lgkmcnt(2)
  v_mfma_f32_16x16x32_bf16 v[80:83], a[216:219], v[48:51], v[80:83]
  ds_read_b128 v[44:47], v5 offset:45056
  s_add_u32 m0, s36, 61440
  v_mfma_f32_16x16x32_bf16 v[84:87], a[220:223], v[48:51], v[84:87]
  s_waitcnt vmcnt(11)
  ds_read_b64_tr_b16 a[240:241], v14 offset:4096
  v_mfma_f32_16x16x32_bf16 v[72:75], a[224:227], v[48:51], v[72:75]
  ds_read_b64_tr_b16 a[244:245], v14 offset:4104
  s_add_u32 s37, s91, 0
  v_mfma_f32_16x16x32_bf16 v[76:79], a[228:231], v[48:51], v[76:79]
  s_waitcnt vmcnt(10)
  ds_read_b64_tr_b16 a[242:243], v14 offset:8192
  v_mfma_f32_16x16x32_bf16 v[56:59], a[232:235], v[48:51], v[56:59]
  ds_read_b64_tr_b16 a[246:247], v14 offset:8200
  buffer_load_dwordx4 v16, s[12:15], s37 offen lds
  v_mfma_f32_16x16x32_bf16 v[60:63], a[236:239], v[48:51], v[60:63]
  v_and_b32 v33, 0xffff0000, v34
  s_waitcnt lgkmcnt(6)
  v_mfma_f32_16x16x32_bf16 v[88:91], a[216:219], v[52:55], v[88:91]
  ds_read_b128 v[48:51], v9 offset:16384
  v_mfma_f32_16x16x32_bf16 v[92:95], a[220:223], v[52:55], v[92:95]
  s_waitcnt vmcnt(10)
  ds_read_b64_tr_b16 a[248:249], v14 offset:12288
  v_mfma_f32_16x16x32_bf16 v[80:83], a[224:227], v[52:55], v[80:83]
  ds_read_b64_tr_b16 a[252:253], v14 offset:12296
  s_add_u32 m0, s36, 65536
  v_mfma_f32_16x16x32_bf16 v[84:87], a[228:231], v[52:55], v[84:87]
  s_waitcnt vmcnt(9)
  ds_read_b64_tr_b16 a[250:251], v14 offset:16384
  v_mfma_f32_16x16x32_bf16 v[72:75], a[232:235], v[52:55], v[72:75]
  ds_read_b64_tr_b16 a[254:255], v14 offset:16392
  s_add_u32 s37, s91, 4096
  v_mfma_f32_16x16x32_bf16 v[76:79], a[236:239], v[52:55], v[76:79]
  buffer_load_dwordx4 v16, s[12:15], s37 offen lds
  s_waitcnt lgkmcnt(10)
  v_mfma_f32_16x16x32_bf16 v[96:99], a[216:219], v[40:43], v[96:99]
  ds_read_b128 v[52:55], v9 offset:20480
  v_mfma_f32_16x16x32_bf16 v[100:103], a[220:223], v[40:43], v[100:103]
  s_waitcnt vmcnt(9)
  ds_read_b64_tr_b16 v[128:129], v14 offset:20480
  v_mfma_f32_16x16x32_bf16 v[88:91], a[224:227], v[40:43], v[88:91]
  ds_read_b64_tr_b16 v[132:133], v14 offset:20488
  v_mfma_f32_16x16x32_bf16 v[92:95], a[228:231], v[40:43], v[92:95]
  s_waitcnt vmcnt(8)
  ds_read_b64_tr_b16 v[130:131], v14 offset:24576
  v_mfma_f32_16x16x32_bf16 v[80:83], a[232:235], v[40:43], v[80:83]
  ds_read_b64_tr_b16 v[134:135], v14 offset:24584
  s_add_u32 m0, s36, 16384
  v_mfma_f32_16x16x32_bf16 v[84:87], a[236:239], v[40:43], v[84:87]
  s_add_u32 s37, s95, 0
  s_waitcnt lgkmcnt(14)
  v_mfma_f32_16x16x32_bf16 v[104:107], a[216:219], v[44:47], v[104:107]
  ds_read_b128 v[40:43], v10 offset:57344
  buffer_load_dwordx4 v16, s[12:15], s37 offen lds
  v_mfma_f32_16x16x32_bf16 v[108:111], a[220:223], v[44:47], v[108:111]
  v_fma_f32 v32, -v37, v24, v32
  v_mfma_f32_16x16x32_bf16 v[96:99], a[224:227], v[44:47], v[96:99]
  v_fma_f32 v33, -v38, v25, v33
  v_mfma_f32_16x16x32_bf16 v[100:103], a[228:231], v[44:47], v[100:103]
  v_mul_f32 v24, s54, v24
  v_mfma_f32_16x16x32_bf16 v[88:91], a[232:235], v[44:47], v[88:91]
  s_add_u32 m0, s36, 98304
  s_add_u32 s37, s95, 4096
  v_mfma_f32_16x16x32_bf16 v[92:95], a[236:239], v[44:47], v[92:95]
  buffer_load_dwordx4 v16, s[12:15], s37 offen lds
  s_waitcnt lgkmcnt(10)
  v_mfma_f32_16x16x32_bf16 v[112:115], a[216:219], v[48:51], v[112:115]
  ds_read_b128 v[44:47], v10 offset:61440
  v_mfma_f32_16x16x32_bf16 v[116:119], a[220:223], v[48:51], v[116:119]
  v_mul_f32 v25, s54, v25
  v_mfma_f32_16x16x32_bf16 v[104:107], a[224:227], v[48:51], v[104:107]
  v_mul_f32 v32, s54, v32
  v_mfma_f32_16x16x32_bf16 v[108:111], a[228:231], v[48:51], v[108:111]
  s_add_u32 m0, s36, 135168
  s_add_u32 s37, s99, 0
  v_mfma_f32_16x16x32_bf16 v[96:99], a[232:235], v[48:51], v[96:99]
  buffer_load_dwordx4 v16, s[12:15], s37 offen lds
  v_mfma_f32_16x16x32_bf16 v[100:103], a[236:239], v[48:51], v[100:103]
  v_mul_f32 v33, s54, v33
  s_waitcnt lgkmcnt(6)
  v_mfma_f32_16x16x32_bf16 v[120:123], a[216:219], v[52:55], v[120:123]
  ds_read_b128 v[48:51], v6 offset:32768
  v_mfma_f32_16x16x32_bf16 v[124:127], a[220:223], v[52:55], v[124:127]
  v_lshlrev_b32 v37, 16, v3
  v_mfma_f32_16x16x32_bf16 v[112:115], a[224:227], v[52:55], v[112:115]
  s_add_u32 m0, s36, 139264
  s_add_u32 s37, s99, 4096
  v_mfma_f32_16x16x32_bf16 v[116:119], a[228:231], v[52:55], v[116:119]
  buffer_load_dwordx4 v16, s[12:15], s37 offen lds
  v_mfma_f32_16x16x32_bf16 v[104:107], a[232:235], v[52:55], v[104:107]
  v_and_b32 v38, 0xffff0000, v3
  v_mfma_f32_16x16x32_bf16 v[108:111], a[236:239], v[52:55], v[108:111]
  v_lshlrev_b32 v34, 16, v35
  s_waitcnt lgkmcnt(2)
  v_mfma_f32_16x16x32_bf16 v[56:59], a[240:243], v[40:43], v[56:59]
  ds_read_b128 v[52:55], v6 offset:36864
  v_mfma_f32_16x16x32_bf16 v[60:63], a[244:247], v[40:43], v[60:63]
  s_add_u32 m0, s36, 143360
  s_add_u32 s37, s91, 32768
  v_mfma_f32_16x16x32_bf16 v[64:67], a[248:251], v[40:43], v[64:67]
  buffer_load_dwordx4 v16, s[12:15], s37 offen lds
  v_mfma_f32_16x16x32_bf16 v[68:71], a[252:255], v[40:43], v[68:71]
  v_and_b32 v35, 0xffff0000, v35
  s_waitcnt lgkmcnt(2)
  v_mfma_f32_16x16x32_bf16 v[72:75], a[240:243], v[44:47], v[72:75]
  ds_read_b128 v[40:43], v6 offset:40960
  v_mfma_f32_16x16x32_bf16 v[76:79], a[244:247], v[44:47], v[76:79]
  v_fma_f32 v34, -v37, v26, v34
  v_mfma_f32_16x16x32_bf16 v[56:59], a[248:251], v[44:47], v[56:59]
  s_add_u32 m0, s36, 147456
  s_add_u32 s37, s91, 36864
  v_mfma_f32_16x16x32_bf16 v[60:63], a[252:255], v[44:47], v[60:63]
  buffer_load_dwordx4 v16, s[12:15], s37 offen lds
  v_mfma_f32_16x16x32_bf16 v[64:67], v[128:131], v[44:47], v[64:67]
  v_fma_f32 v35, -v38, v27, v35
  v_mfma_f32_16x16x32_bf16 v[68:71], v[132:135], v[44:47], v[68:71]
  v_mul_f32 v26, s54, v26
  s_waitcnt lgkmcnt(2)
  v_mfma_f32_16x16x32_bf16 v[80:83], a[240:243], v[48:51], v[80:83]
  ds_read_b128 v[44:47], v6 offset:45056
  v_mfma_f32_16x16x32_bf16 v[84:87], a[244:247], v[48:51], v[84:87]
  s_waitcnt vmcnt(13)
  ds_read_b64_tr_b16 v[136:137], v12 offset:12288
  v_mfma_f32_16x16x32_bf16 v[72:75], a[248:251], v[48:51], v[72:75]
  ds_read_b64_tr_b16 v[140:141], v12 offset:12296
  s_add_u32 m0, s36, 151552
  v_mfma_f32_16x16x32_bf16 v[76:79], a[252:255], v[48:51], v[76:79]
  s_waitcnt vmcnt(12)
  ds_read_b64_tr_b16 v[138:139], v12 offset:49152
  v_mfma_f32_16x16x32_bf16 v[56:59], v[128:131], v[48:51], v[56:59]
  ds_read_b64_tr_b16 v[142:143], v12 offset:49160
  s_add_u32 s37, s95, 32768
  v_mfma_f32_16x16x32_bf16 v[60:63], v[132:135], v[48:51], v[60:63]
  buffer_load_dwordx4 v16, s[12:15], s37 offen lds
  s_waitcnt lgkmcnt(6)
  v_mfma_f32_16x16x32_bf16 v[88:91], a[240:243], v[52:55], v[88:91]
  ds_read_b128 v[48:51], v10 offset:16384
  v_mfma_f32_16x16x32_bf16 v[92:95], a[244:247], v[52:55], v[92:95]
  s_waitcnt vmcnt(12)
  ds_read_b64_tr_b16 v[144:145], v12 offset:53248
  v_mfma_f32_16x16x32_bf16 v[80:83], a[248:251], v[52:55], v[80:83]
  ds_read_b64_tr_b16 v[148:149], v12 offset:53256
  v_mfma_f32_16x16x32_bf16 v[84:87], a[252:255], v[52:55], v[84:87]
  s_waitcnt vmcnt(11)
  ds_read_b64_tr_b16 v[146:147], v14 offset:28672
  v_mfma_f32_16x16x32_bf16 v[72:75], v[128:131], v[52:55], v[72:75]
  ds_read_b64_tr_b16 v[150:151], v14 offset:28680
  s_add_u32 m0, s36, 155648
  v_mfma_f32_16x16x32_bf16 v[76:79], v[132:135], v[52:55], v[76:79]
  s_add_u32 s37, s95, 36864
  s_waitcnt lgkmcnt(10)
  v_mfma_f32_16x16x32_bf16 v[96:99], a[240:243], v[40:43], v[96:99]
  ds_read_b128 v[52:55], v10 offset:20480
  buffer_load_dwordx4 v16, s[12:15], s37 offen lds
  v_mfma_f32_16x16x32_bf16 v[100:103], a[244:247], v[40:43], v[100:103]
  s_waitcnt vmcnt(11)
  ds_read_b64_tr_b16 v[152:153], v14 offset:0
  v_mfma_f32_16x16x32_bf16 v[88:91], a[248:251], v[40:43], v[88:91]
  ds_read_b64_tr_b16 v[156:157], v14 offset:8
  v_mfma_f32_16x16x32_bf16 v[92:95], a[252:255], v[40:43], v[92:95]
  s_waitcnt vmcnt(10)
  ds_read_b64_tr_b16 v[154:155], v12 offset:57344
  v_mfma_f32_16x16x32_bf16 v[80:83], v[128:131], v[40:43], v[80:83]
  ds_read_b64_tr_b16 v[158:159], v12 offset:57352
  s_add_u32 m0, s36, 102400
  v_mfma_f32_16x16x32_bf16 v[84:87], v[132:135], v[40:43], v[84:87]
  s_add_u32 s37, s99, 32768
  s_waitcnt lgkmcnt(14)
  v_mfma_f32_16x16x32_bf16 v[104:107], a[240:243], v[44:47], v[104:107]
  ds_read_b128 v[40:43], v11 offset:57344
  buffer_load_dwordx4 v16, s[12:15], s37 offen lds
  v_mfma_f32_16x16x32_bf16 v[108:111], a[244:247], v[44:47], v[108:111]
  v_mul_f32 v27, s54, v27
  v_mfma_f32_16x16x32_bf16 v[96:99], a[248:251], v[44:47], v[96:99]
  v_mul_f32 v34, s54, v34
  v_mfma_f32_16x16x32_bf16 v[100:103], a[252:255], v[44:47], v[100:103]
  v_mul_f32 v35, s54, v35
  v_mfma_f32_16x16x32_bf16 v[88:91], v[128:131], v[44:47], v[88:91]
  s_add_u32 m0, s36, 69632
  s_add_u32 s37, s99, 36864
  v_mfma_f32_16x16x32_bf16 v[92:95], v[132:135], v[44:47], v[92:95]
  buffer_load_dwordx4 v16, s[12:15], s37 offen lds
  s_waitcnt lgkmcnt(10)
  v_mfma_f32_16x16x32_bf16 v[112:115], a[240:243], v[48:51], v[112:115]
  ds_read_b128 v[44:47], v11 offset:61440
  v_mfma_f32_16x16x32_bf16 v[116:119], a[244:247], v[48:51], v[116:119]
  v_mfma_f32_16x16x32_bf16 v[104:107], a[248:251], v[48:51], v[104:107]
  v_mfma_f32_16x16x32_bf16 v[108:111], a[252:255], v[48:51], v[108:111]
  s_add_u32 m0, s36, 73728
  s_add_u32 s37, s91, 65536
  v_mfma_f32_16x16x32_bf16 v[96:99], v[128:131], v[48:51], v[96:99]
  buffer_load_dwordx4 v16, s[12:15], s37 offen lds
  v_mfma_f32_16x16x32_bf16 v[100:103], v[132:135], v[48:51], v[100:103]
  s_waitcnt lgkmcnt(6)
  v_mfma_f32_16x16x32_bf16 v[120:123], a[240:243], v[52:55], v[120:123]
  ds_read_b128 v[48:51], v7 offset:32768
  v_mfma_f32_16x16x32_bf16 v[124:127], a[244:247], v[52:55], v[124:127]
  v_mfma_f32_16x16x32_bf16 v[112:115], a[248:251], v[52:55], v[112:115]
  s_add_u32 m0, s36, 159744
  s_add_u32 s37, s91, 69632
  v_mfma_f32_16x16x32_bf16 v[116:119], a[252:255], v[52:55], v[116:119]
  buffer_load_dwordx4 v16, s[12:15], s37 offen lds
  v_mfma_f32_16x16x32_bf16 v[104:107], v[128:131], v[52:55], v[104:107]
  v_mfma_f32_16x16x32_bf16 v[108:111], v[132:135], v[52:55], v[108:111]
  s_waitcnt lgkmcnt(2)
  v_mfma_f32_16x16x32_bf16 v[56:59], v[136:139], v[40:43], v[56:59]
  ds_read_b128 v[52:55], v7 offset:36864
  v_mfma_f32_16x16x32_bf16 v[60:63], v[140:143], v[40:43], v[60:63]
  s_add_u32 m0, s36, 131072
  s_add_u32 s37, s95, 65536
  v_mfma_f32_16x16x32_bf16 v[64:67], v[144:147], v[40:43], v[64:67]
  buffer_load_dwordx4 v16, s[12:15], s37 offen lds
  v_mfma_f32_16x16x32_bf16 v[68:71], v[148:151], v[40:43], v[68:71]
  s_waitcnt lgkmcnt(2)
  v_mfma_f32_16x16x32_bf16 v[72:75], v[136:139], v[44:47], v[72:75]
  ds_read_b128 v[40:43], v7 offset:40960
  v_mfma_f32_16x16x32_bf16 v[76:79], v[140:143], v[44:47], v[76:79]
  v_mfma_f32_16x16x32_bf16 v[56:59], v[144:147], v[44:47], v[56:59]
  s_add_u32 m0, s36, 77824
  s_add_u32 s37, s95, 69632
  v_mfma_f32_16x16x32_bf16 v[60:63], v[148:151], v[44:47], v[60:63]
  buffer_load_dwordx4 v16, s[12:15], s37 offen lds
  v_mfma_f32_16x16x32_bf16 v[64:67], v[152:155], v[44:47], v[64:67]
  v_mfma_f32_16x16x32_bf16 v[68:71], v[156:159], v[44:47], v[68:71]
  s_waitcnt lgkmcnt(2)
  v_mfma_f32_16x16x32_bf16 v[80:83], v[136:139], v[48:51], v[80:83]
  ds_read_b128 v[44:47], v7 offset:45056
  v_mfma_f32_16x16x32_bf16 v[84:87], v[140:143], v[48:51], v[84:87]
  s_waitcnt vmcnt(15)
  ds_read_b64_tr_b16 v[160:161], v12 offset:61440
  v_mfma_f32_16x16x32_bf16 v[72:75], v[144:147], v[48:51], v[72:75]
  ds_read_b64_tr_b16 v[164:165], v12 offset:61448
  s_add_u32 m0, s36, 106496
  v_mfma_f32_16x16x32_bf16 v[76:79], v[148:151], v[48:51], v[76:79]
  s_waitcnt vmcnt(14)
  ds_read_b64_tr_b16 v[162:163], v13 offset:0
  v_mfma_f32_16x16x32_bf16 v[56:59], v[152:155], v[48:51], v[56:59]
  ds_read_b64_tr_b16 v[166:167], v13 offset:8
  s_add_u32 s37, s99, 65536
  v_mfma_f32_16x16x32_bf16 v[60:63], v[156:159], v[48:51], v[60:63]
  buffer_load_dwordx4 v16, s[12:15], s37 offen lds
  s_waitcnt lgkmcnt(6)
  v_mfma_f32_16x16x32_bf16 v[88:91], v[136:139], v[52:55], v[88:91]
  ds_read_b128 v[48:51], v11 offset:16384
  v_mfma_f32_16x16x32_bf16 v[92:95], v[140:143], v[52:55], v[92:95]
  s_waitcnt vmcnt(14)
  ds_read_b64_tr_b16 v[168:169], v12 offset:16384
  v_mfma_f32_16x16x32_bf16 v[80:83], v[144:147], v[52:55], v[80:83]
  ds_read_b64_tr_b16 v[172:173], v12 offset:16392
  v_mfma_f32_16x16x32_bf16 v[84:87], v[148:151], v[52:55], v[84:87]
  s_waitcnt vmcnt(13)
  ds_read_b64_tr_b16 v[170:171], v13 offset:32768
  v_mfma_f32_16x16x32_bf16 v[72:75], v[152:155], v[52:55], v[72:75]
  ds_read_b64_tr_b16 v[174:175], v13 offset:32776
  s_add_u32 m0, s36, 110592
  v_mfma_f32_16x16x32_bf16 v[76:79], v[156:159], v[52:55], v[76:79]
  s_add_u32 s37, s99, 69632
  s_waitcnt lgkmcnt(10)
  v_mfma_f32_16x16x32_bf16 v[96:99], v[136:139], v[40:43], v[96:99]
  ds_read_b128 v[52:55], v11 offset:20480
  buffer_load_dwordx4 v16, s[12:15], s37 offen lds
  v_mfma_f32_16x16x32_bf16 v[100:103], v[140:143], v[40:43], v[100:103]
  s_waitcnt vmcnt(13)
  ds_read_b64_tr_b16 v[176:177], v14 offset:4096
  v_mfma_f32_16x16x32_bf16 v[88:91], v[144:147], v[40:43], v[88:91]
  ds_read_b64_tr_b16 v[180:181], v14 offset:4104
  v_mfma_f32_16x16x32_bf16 v[92:95], v[148:151], v[40:43], v[92:95]
  s_waitcnt vmcnt(12)
  ds_read_b64_tr_b16 v[178:179], v14 offset:8192
  v_mfma_f32_16x16x32_bf16 v[80:83], v[152:155], v[40:43], v[80:83]
  ds_read_b64_tr_b16 v[182:183], v14 offset:8200
  s_add_u32 m0, s36, 114688
  v_mfma_f32_16x16x32_bf16 v[84:87], v[156:159], v[40:43], v[84:87]
  s_add_u32 s37, s91, 98304
  s_barrier
  s_waitcnt lgkmcnt(14)
  v_mfma_f32_16x16x32_bf16 v[104:107], v[136:139], v[44:47], v[104:107]
  ds_read_b128 v[40:43], v4 offset:24576
  buffer_load_dwordx4 v16, s[12:15], s37 offen lds
  v_mfma_f32_16x16x32_bf16 v[108:111], v[140:143], v[44:47], v[108:111]
  v_mfma_f32_16x16x32_bf16 v[96:99], v[144:147], v[44:47], v[96:99]
  v_mfma_f32_16x16x32_bf16 v[100:103], v[148:151], v[44:47], v[100:103]
  v_mfma_f32_16x16x32_bf16 v[88:91], v[152:155], v[44:47], v[88:91]
  s_add_u32 m0, s36, 20480
  s_add_u32 s37, s91, 102400
  v_mfma_f32_16x16x32_bf16 v[92:95], v[156:159], v[44:47], v[92:95]
  buffer_load_dwordx4 v16, s[12:15], s37 offen lds
  s_waitcnt lgkmcnt(10)
  v_mfma_f32_16x16x32_bf16 v[112:115], v[136:139], v[48:51], v[112:115]
  ds_read_b128 v[44:47], v4 offset:28672
  v_mfma_f32_16x16x32_bf16 v[116:119], v[140:143], v[48:51], v[116:119]
  v_mfma_f32_16x16x32_bf16 v[104:107], v[144:147], v[48:51], v[104:107]
  v_mfma_f32_16x16x32_bf16 v[108:111], v[148:151], v[48:51], v[108:111]
  s_add_u32 m0, s36, 12288
  s_add_u32 s37, s95, 98304
  v_mfma_f32_16x16x32_bf16 v[96:99], v[152:155], v[48:51], v[96:99]
  buffer_load_dwordx4 v16, s[12:15], s37 offen lds
  v_mfma_f32_16x16x32_bf16 v[100:103], v[156:159], v[48:51], v[100:103]
  s_waitcnt lgkmcnt(6)
  v_mfma_f32_16x16x32_bf16 v[120:123], v[136:139], v[52:55], v[120:123]
  ds_read_b128 v[48:51], v8 offset:53248
  v_mfma_f32_16x16x32_bf16 v[124:127], v[140:143], v[52:55], v[124:127]
  v_mfma_f32_16x16x32_bf16 v[112:115], v[144:147], v[52:55], v[112:115]
  s_add_u32 m0, s36, 49152
  s_add_u32 s37, s95, 102400
  v_mfma_f32_16x16x32_bf16 v[116:119], v[148:151], v[52:55], v[116:119]
  buffer_load_dwordx4 v16, s[12:15], s37 offen lds
  v_mfma_f32_16x16x32_bf16 v[104:107], v[152:155], v[52:55], v[104:107]
  v_mfma_f32_16x16x32_bf16 v[108:111], v[156:159], v[52:55], v[108:111]
  s_waitcnt lgkmcnt(2)
  v_mfma_f32_16x16x32_bf16 v[56:59], v[160:163], v[40:43], v[56:59]
  ds_read_b128 v[52:55], v8 offset:24576
  v_mfma_f32_16x16x32_bf16 v[60:63], v[164:167], v[40:43], v[60:63]
  s_add_u32 m0, s36, 135168
  s_add_u32 s37, s99, 98304
  v_mfma_f32_16x16x32_bf16 v[64:67], v[168:171], v[40:43], v[64:67]
  buffer_load_dwordx4 v16, s[12:15], s37 offen lds
  v_mfma_f32_16x16x32_bf16 v[68:71], v[172:175], v[40:43], v[68:71]
  s_barrier
  s_waitcnt lgkmcnt(2)
  v_mfma_f32_16x16x32_bf16 v[72:75], v[160:163], v[44:47], v[72:75]
  ds_read_b128 v[40:43], v8 offset:28672
  v_mfma_f32_16x16x32_bf16 v[76:79], v[164:167], v[44:47], v[76:79]
  v_mfma_f32_16x16x32_bf16 v[56:59], v[168:171], v[44:47], v[56:59]
  s_add_u32 m0, s36, 139264
  s_add_u32 s37, s99, 102400
  v_mfma_f32_16x16x32_bf16 v[60:63], v[172:175], v[44:47], v[60:63]
  buffer_load_dwordx4 v16, s[12:15], s37 offen lds
  v_mfma_f32_16x16x32_bf16 v[64:67], v[176:179], v[44:47], v[64:67]
  v_mfma_f32_16x16x32_bf16 v[68:71], v[180:183], v[44:47], v[68:71]
  s_waitcnt lgkmcnt(2)
  v_mfma_f32_16x16x32_bf16 v[80:83], v[160:163], v[48:51], v[80:83]
  ds_read_b128 v[44:47], v4 offset:0
  v_mfma_f32_16x16x32_bf16 v[84:87], v[164:167], v[48:51], v[84:87]
  s_waitcnt vmcnt(17)
  ds_read_b64_tr_b16 v[184:185], v14 offset:12288
  v_mfma_f32_16x16x32_bf16 v[72:75], v[168:171], v[48:51], v[72:75]
  ds_read_b64_tr_b16 v[188:189], v14 offset:12296
  s_add_u32 m0, s36, 53248
  v_mfma_f32_16x16x32_bf16 v[76:79], v[172:175], v[48:51], v[76:79]
  s_waitcnt vmcnt(16)
  ds_read_b64_tr_b16 v[186:187], v14 offset:16384
  v_mfma_f32_16x16x32_bf16 v[56:59], v[176:179], v[48:51], v[56:59]
  ds_read_b64_tr_b16 v[190:191], v14 offset:16392
  s_add_u32 s37, s84, 8192
  v_mfma_f32_16x16x32_bf16 v[60:63], v[180:183], v[48:51], v[60:63]
  buffer_load_dwordx4 v15, s[8:11], s37 offen lds
  s_waitcnt lgkmcnt(6)
  v_mfma_f32_16x16x32_bf16 v[88:91], v[160:163], v[52:55], v[88:91]
  ds_read_b128 v[48:51], v4 offset:4096
  v_mfma_f32_16x16x32_bf16 v[92:95], v[164:167], v[52:55], v[92:95]
  s_waitcnt vmcnt(16)
  ds_read_b64_tr_b16 v[192:193], v14 offset:20480
  v_mfma_f32_16x16x32_bf16 v[80:83], v[168:171], v[52:55], v[80:83]
  ds_read_b64_tr_b16 v[196:197], v14 offset:20488
  v_mfma_f32_16x16x32_bf16 v[84:87], v[172:175], v[52:55], v[84:87]
  s_waitcnt vmcnt(15)
  ds_read_b64_tr_b16 v[194:195], v14 offset:24576
  v_mfma_f32_16x16x32_bf16 v[72:75], v[176:179], v[52:55], v[72:75]
  ds_read_b64_tr_b16 v[198:199], v14 offset:24584
  s_add_u32 m0, s36, 57344
  v_mfma_f32_16x16x32_bf16 v[76:79], v[180:183], v[52:55], v[76:79]
  s_add_u32 s37, s85, 8192
  s_waitcnt lgkmcnt(10)
  v_mfma_f32_16x16x32_bf16 v[96:99], v[160:163], v[40:43], v[96:99]
  ds_read_b128 v[52:55], v4 offset:8192
  buffer_load_dwordx4 v15, s[8:11], s37 offen lds
  v_mfma_f32_16x16x32_bf16 v[100:103], v[164:167], v[40:43], v[100:103]
  s_waitcnt vmcnt(15)
  ds_read_b64_tr_b16 v[200:201], v13 offset:36864
  v_mfma_f32_16x16x32_bf16 v[88:91], v[168:171], v[40:43], v[88:91]
  ds_read_b64_tr_b16 v[204:205], v13 offset:36872
  v_mfma_f32_16x16x32_bf16 v[92:95], v[172:175], v[40:43], v[92:95]
  s_waitcnt vmcnt(14)
  ds_read_b64_tr_b16 v[202:203], v13 offset:4096
  v_mfma_f32_16x16x32_bf16 v[80:83], v[176:179], v[40:43], v[80:83]
  ds_read_b64_tr_b16 v[206:207], v13 offset:4104
  s_add_u32 m0, s36, 122880
  v_mfma_f32_16x16x32_bf16 v[84:87], v[180:183], v[40:43], v[84:87]
  s_add_u32 s37, s86, 8192
  s_waitcnt lgkmcnt(14)
  v_mfma_f32_16x16x32_bf16 v[104:107], v[160:163], v[44:47], v[104:107]
  ds_read_b128 v[40:43], v5 offset:24576
  buffer_load_dwordx4 v15, s[8:11], s37 offen lds
  v_mfma_f32_16x16x32_bf16 v[108:111], v[164:167], v[44:47], v[108:111]
  v_mfma_f32_16x16x32_bf16 v[96:99], v[168:171], v[44:47], v[96:99]
  v_mfma_f32_16x16x32_bf16 v[100:103], v[172:175], v[44:47], v[100:103]
  v_mfma_f32_16x16x32_bf16 v[88:91], v[176:179], v[44:47], v[88:91]
  s_add_u32 m0, s36, 126976
  s_add_u32 s37, s87, 8192
  v_mfma_f32_16x16x32_bf16 v[92:95], v[180:183], v[44:47], v[92:95]
  buffer_load_dwordx4 v15, s[8:11], s37 offen lds
  s_waitcnt lgkmcnt(10)
  v_mfma_f32_16x16x32_bf16 v[112:115], v[160:163], v[48:51], v[112:115]
  ds_read_b128 v[44:47], v5 offset:28672
  v_mfma_f32_16x16x32_bf16 v[116:119], v[164:167], v[48:51], v[116:119]
  v_mfma_f32_16x16x32_bf16 v[104:107], v[168:171], v[48:51], v[104:107]
  v_mfma_f32_16x16x32_bf16 v[108:111], v[172:175], v[48:51], v[108:111]
  s_add_u32 m0, s36, 32768
  s_add_u32 s37, s84, 9216
  v_mfma_f32_16x16x32_bf16 v[96:99], v[176:179], v[48:51], v[96:99]
  buffer_load_dwordx4 v15, s[8:11], s37 offen lds
  v_mfma_f32_16x16x32_bf16 v[100:103], v[180:183], v[48:51], v[100:103]
  s_waitcnt lgkmcnt(6)
  v_mfma_f32_16x16x32_bf16 v[120:123], v[160:163], v[52:55], v[120:123]
  ds_read_b128 v[48:51], v9 offset:53248
  v_mfma_f32_16x16x32_bf16 v[124:127], v[164:167], v[52:55], v[124:127]
  v_mfma_f32_16x16x32_bf16 v[112:115], v[168:171], v[52:55], v[112:115]
  s_add_u32 m0, s36, 36864
  s_add_u32 s37, s85, 9216
  v_mfma_f32_16x16x32_bf16 v[116:119], v[172:175], v[52:55], v[116:119]
  buffer_load_dwordx4 v15, s[8:11], s37 offen lds
  v_mfma_f32_16x16x32_bf16 v[104:107], v[176:179], v[52:55], v[104:107]
  v_mfma_f32_16x16x32_bf16 v[108:111], v[180:183], v[52:55], v[108:111]
  s_waitcnt lgkmcnt(2)
  v_mfma_f32_16x16x32_bf16 v[56:59], v[184:187], v[40:43], v[56:59]
  ds_read_b128 v[52:55], v9 offset:24576
  v_mfma_f32_16x16x32_bf16 v[60:63], v[188:191], v[40:43], v[60:63]
  s_add_u32 m0, s36, 40960
  s_add_u32 s37, s86, 9216
  v_mfma_f32_16x16x32_bf16 v[64:67], v[192:195], v[40:43], v[64:67]
  buffer_load_dwordx4 v15, s[8:11], s37 offen lds
  v_mfma_f32_16x16x32_bf16 v[68:71], v[196:199], v[40:43], v[68:71]
  s_waitcnt lgkmcnt(2)
  v_mfma_f32_16x16x32_bf16 v[72:75], v[184:187], v[44:47], v[72:75]
  ds_read_b128 v[40:43], v9 offset:28672
  v_mfma_f32_16x16x32_bf16 v[76:79], v[188:191], v[44:47], v[76:79]
  v_mfma_f32_16x16x32_bf16 v[56:59], v[192:195], v[44:47], v[56:59]
  s_add_u32 m0, s36, 61440
  s_add_u32 s37, s87, 9216
  v_mfma_f32_16x16x32_bf16 v[60:63], v[196:199], v[44:47], v[60:63]
  buffer_load_dwordx4 v15, s[8:11], s37 offen lds
  v_mfma_f32_16x16x32_bf16 v[64:67], v[200:203], v[44:47], v[64:67]
  v_mfma_f32_16x16x32_bf16 v[68:71], v[204:207], v[44:47], v[68:71]
  s_waitcnt lgkmcnt(2)
  v_mfma_f32_16x16x32_bf16 v[80:83], v[184:187], v[48:51], v[80:83]
  ds_read_b128 v[44:47], v5 offset:0
  v_mfma_f32_16x16x32_bf16 v[84:87], v[188:191], v[48:51], v[84:87]
  s_waitcnt vmcnt(19)
  ds_read_b64_tr_b16 v[208:209], v13 offset:8192
  v_mfma_f32_16x16x32_bf16 v[72:75], v[192:195], v[48:51], v[72:75]
  ds_read_b64_tr_b16 v[212:213], v13 offset:8200
  s_add_u32 m0, s36, 65536
  v_mfma_f32_16x16x32_bf16 v[76:79], v[196:199], v[48:51], v[76:79]
  s_waitcnt vmcnt(18)
  ds_read_b64_tr_b16 v[210:211], v14 offset:28672
  v_mfma_f32_16x16x32_bf16 v[56:59], v[200:203], v[48:51], v[56:59]
  ds_read_b64_tr_b16 v[214:215], v14 offset:28680
  s_add_u32 s37, s84, 10240
  v_mfma_f32_16x16x32_bf16 v[60:63], v[204:207], v[48:51], v[60:63]
  buffer_load_dwordx4 v15, s[8:11], s37 offen lds
  s_waitcnt lgkmcnt(6)
  v_mfma_f32_16x16x32_bf16 v[88:91], v[184:187], v[52:55], v[88:91]
  ds_read_b128 v[48:51], v5 offset:4096
  v_mfma_f32_16x16x32_bf16 v[92:95], v[188:191], v[52:55], v[92:95]
  s_waitcnt vmcnt(18)
  ds_read_b64_tr_b16 v[216:217], v14 offset:0
  v_mfma_f32_16x16x32_bf16 v[80:83], v[192:195], v[52:55], v[80:83]
  ds_read_b64_tr_b16 v[220:221], v14 offset:8
  v_mfma_f32_16x16x32_bf16 v[84:87], v[196:199], v[52:55], v[84:87]
  s_waitcnt vmcnt(17)
  ds_read_b64_tr_b16 v[218:219], v13 offset:12288
  v_mfma_f32_16x16x32_bf16 v[72:75], v[200:203], v[52:55], v[72:75]
  ds_read_b64_tr_b16 v[222:223], v13 offset:12296
  s_add_u32 m0, s36, 16384
  v_mfma_f32_16x16x32_bf16 v[76:79], v[204:207], v[52:55], v[76:79]
  s_add_u32 s37, s85, 10240
  s_waitcnt lgkmcnt(10)
  v_mfma_f32_16x16x32_bf16 v[96:99], v[184:187], v[40:43], v[96:99]
  ds_read_b128 v[52:55], v5 offset:8192
  buffer_load_dwordx4 v15, s[8:11], s37 offen lds
  v_mfma_f32_16x16x32_bf16 v[100:103], v[188:191], v[40:43], v[100:103]
  s_waitcnt vmcnt(17)
  ds_read_b64_tr_b16 v[224:225], v13 offset:40960
  v_mfma_f32_16x16x32_bf16 v[88:91], v[192:195], v[40:43], v[88:91]
  ds_read_b64_tr_b16 v[228:229], v13 offset:40968
  v_mfma_f32_16x16x32_bf16 v[92:95], v[196:199], v[40:43], v[92:95]
  s_waitcnt vmcnt(16)
  ds_read_b64_tr_b16 v[226:227], v13 offset:45056
  v_mfma_f32_16x16x32_bf16 v[80:83], v[200:203], v[40:43], v[80:83]
  ds_read_b64_tr_b16 v[230:231], v13 offset:45064
  s_add_u32 m0, s36, 98304
  v_mfma_f32_16x16x32_bf16 v[84:87], v[204:207], v[40:43], v[84:87]
  s_add_u32 s37, s86, 10240
  s_waitcnt lgkmcnt(14)
  v_mfma_f32_16x16x32_bf16 v[104:107], v[184:187], v[44:47], v[104:107]
  ds_read_b128 v[40:43], v6 offset:24576
  buffer_load_dwordx4 v15, s[8:11], s37 offen lds
  v_mfma_f32_16x16x32_bf16 v[108:111], v[188:191], v[44:47], v[108:111]
  s_waitcnt vmcnt(16)
  ds_read_b64_tr_b16 v[232:233], v13 offset:49152
  v_mfma_f32_16x16x32_bf16 v[96:99], v[192:195], v[44:47], v[96:99]
  ds_read_b64_tr_b16 v[236:237], v13 offset:49160
  v_mfma_f32_16x16x32_bf16 v[100:103], v[196:199], v[44:47], v[100:103]
  s_waitcnt vmcnt(15)
  ds_read_b64_tr_b16 v[234:235], v12 offset:20480
  v_mfma_f32_16x16x32_bf16 v[88:91], v[200:203], v[44:47], v[88:91]
  ds_read_b64_tr_b16 v[238:239], v12 offset:20488
  s_add_u32 m0, s36, 45056
  v_mfma_f32_16x16x32_bf16 v[92:95], v[204:207], v[44:47], v[92:95]
  s_add_u32 s37, s87, 10240
  s_waitcnt lgkmcnt(14)
  v_mfma_f32_16x16x32_bf16 v[112:115], v[184:187], v[48:51], v[112:115]
  ds_read_b128 v[44:47], v7 offset:24576
  buffer_load_dwordx4 v15, s[8:11], s37 offen lds
  v_mfma_f32_16x16x32_bf16 v[116:119], v[188:191], v[48:51], v[116:119]
  s_waitcnt vmcnt(15)
  ds_read_b64_tr_b16 v[240:241], v12 offset:12288
  v_mfma_f32_16x16x32_bf16 v[104:107], v[192:195], v[48:51], v[104:107]
  ds_read_b64_tr_b16 v[244:245], v12 offset:12296
  v_mfma_f32_16x16x32_bf16 v[108:111], v[196:199], v[48:51], v[108:111]
  s_waitcnt vmcnt(14)
  ds_read_b64_tr_b16 v[242:243], v12 offset:49152
  v_mfma_f32_16x16x32_bf16 v[96:99], v[200:203], v[48:51], v[96:99]
  ds_read_b64_tr_b16 v[246:247], v12 offset:49160
  s_add_u32 m0, s36, 81920
  v_mfma_f32_16x16x32_bf16 v[100:103], v[204:207], v[48:51], v[100:103]
  s_add_u32 s37, s84, 11264
  s_waitcnt lgkmcnt(14)
  v_mfma_f32_16x16x32_bf16 v[120:123], v[184:187], v[52:55], v[120:123]
  ds_read_b128 v[48:51], v6 offset:28672
  buffer_load_dwordx4 v15, s[8:11], s37 offen lds
  v_mfma_f32_16x16x32_bf16 v[124:127], v[188:191], v[52:55], v[124:127]
  s_waitcnt vmcnt(14)
  ds_read_b64_tr_b16 v[248:249], v14 offset:4096
  v_mfma_f32_16x16x32_bf16 v[112:115], v[192:195], v[52:55], v[112:115]
  ds_read_b64_tr_b16 v[252:253], v14 offset:4104
  v_mfma_f32_16x16x32_bf16 v[116:119], v[196:199], v[52:55], v[116:119]
  s_waitcnt vmcnt(13)
  ds_read_b64_tr_b16 v[250:251], v14 offset:8192
  v_mfma_f32_16x16x32_bf16 v[104:107], v[200:203], v[52:55], v[104:107]
  ds_read_b64_tr_b16 v[254:255], v14 offset:8200
  s_add_u32 m0, s36, 86016
  v_mfma_f32_16x16x32_bf16 v[108:111], v[204:207], v[52:55], v[108:111]
  s_add_u32 s37, s85, 11264
  s_waitcnt lgkmcnt(14)
  v_mfma_f32_16x16x32_bf16 v[56:59], v[208:211], v[40:43], v[56:59]
  ds_read_b128 v[52:55], v7 offset:28672
  buffer_load_dwordx4 v15, s[8:11], s37 offen lds
  v_mfma_f32_16x16x32_bf16 v[60:63], v[212:215], v[40:43], v[60:63]
  v_mfma_f32_16x16x32_bf16 v[64:67], v[216:219], v[40:43], v[64:67]
  v_mfma_f32_16x16x32_bf16 v[68:71], v[220:223], v[40:43], v[68:71]
  s_waitcnt lgkmcnt(10)
  v_mfma_f32_16x16x32_bf16 v[56:59], v[232:235], v[44:47], v[56:59]
  ds_read_b128 v[40:43], v10 offset:53248
  s_add_u32 m0, s36, 102400
  v_mfma_f32_16x16x32_bf16 v[60:63], v[236:239], v[44:47], v[60:63]
  s_add_u32 s37, s86, 11264
  buffer_load_dwordx4 v15, s[8:11], s37 offen lds
  s_waitcnt lgkmcnt(8)
  v_mfma_f32_16x16x32_bf16 v[64:67], v[240:243], v[44:47], v[64:67]
  s_waitcnt lgkmcnt(7)
  v_mfma_f32_16x16x32_bf16 v[68:71], v[244:247], v[44:47], v[68:71]
  s_waitcnt lgkmcnt(6)
  v_mfma_f32_16x16x32_bf16 v[72:75], v[208:211], v[48:51], v[72:75]
  ds_read_b128 v[44:47], v11 offset:53248
  v_mfma_f32_16x16x32_bf16 v[76:79], v[212:215], v[48:51], v[76:79]
  s_add_u32 m0, s36, 69632
  s_add_u32 s37, s87, 11264
  v_mfma_f32_16x16x32_bf16 v[56:59], v[216:219], v[48:51], v[56:59]
  buffer_load_dwordx4 v15, s[8:11], s37 offen lds
  v_mfma_f32_16x16x32_bf16 v[60:63], v[220:223], v[48:51], v[60:63]
  v_mfma_f32_16x16x32_bf16 v[64:67], v[224:227], v[48:51], v[64:67]
  v_mfma_f32_16x16x32_bf16 v[68:71], v[228:231], v[48:51], v[68:71]
  s_waitcnt lgkmcnt(2)
  v_mfma_f32_16x16x32_bf16 v[72:75], v[232:235], v[52:55], v[72:75]
  ds_read_b128 v[48:51], v10 offset:24576
  s_add_u32 m0, s36, 73728
  v_mfma_f32_16x16x32_bf16 v[76:79], v[236:239], v[52:55], v[76:79]
  s_add_u32 s37, s84, 12288
  buffer_load_dwordx4 v15, s[8:11], s37 offen lds
  v_mfma_f32_16x16x32_bf16 v[56:59], v[240:243], v[52:55], v[56:59]
  v_mfma_f32_16x16x32_bf16 v[60:63], v[244:247], v[52:55], v[60:63]
  v_mfma_f32_16x16x32_bf16 v[64:67], v[248:251], v[52:55], v[64:67]
  v_mfma_f32_16x16x32_bf16 v[68:71], v[252:255], v[52:55], v[68:71]
  s_add_u32 m0, s36, 77824
  s_waitcnt lgkmcnt(2)
  v_mfma_f32_16x16x32_bf16 v[80:83], v[208:211], v[40:43], v[80:83]
  ds_read_b128 v[52:55], v11 offset:24576
  s_add_u32 s37, s85, 12288
  v_mfma_f32_16x16x32_bf16 v[84:87], v[212:215], v[40:43], v[84:87]
  buffer_load_dwordx4 v15, s[8:11], s37 offen lds
  v_mfma_f32_16x16x32_bf16 v[72:75], v[216:219], v[40:43], v[72:75]
  v_mfma_f32_16x16x32_bf16 v[76:79], v[220:223], v[40:43], v[76:79]
  v_mfma_f32_16x16x32_bf16 v[56:59], v[224:227], v[40:43], v[56:59]
  v_mfma_f32_16x16x32_bf16 v[60:63], v[228:231], v[40:43], v[60:63]
  s_add_u32 m0, s36, 106496
  s_waitcnt lgkmcnt(2)
  v_mfma_f32_16x16x32_bf16 v[80:83], v[232:235], v[44:47], v[80:83]
  ds_read_b128 v[40:43], v10 offset:28672
  s_add_u32 s37, s86, 12288
  v_mfma_f32_16x16x32_bf16 v[84:87], v[236:239], v[44:47], v[84:87]
  buffer_load_dwordx4 v15, s[8:11], s37 offen lds
  v_fma_f32 v64, v64, v20, v28
  v_mfma_f32_16x16x32_bf16 v[72:75], v[240:243], v[44:47], v[72:75]
  v_fma_f32 v65, v65, v21, v29
  v_mfma_f32_16x16x32_bf16 v[76:79], v[244:247], v[44:47], v[76:79]
  v_fma_f32 v66, v66, v22, v30
  v_mfma_f32_16x16x32_bf16 v[56:59], v[248:251], v[44:47], v[56:59]
  v_fma_f32 v67, v67, v23, v31
  v_mfma_f32_16x16x32_bf16 v[60:63], v[252:255], v[44:47], v[60:63]
  s_add_u32 m0, s36, 110592
  s_waitcnt lgkmcnt(2)
  v_mfma_f32_16x16x32_bf16 v[88:91], v[208:211], v[48:51], v[88:91]
  ds_read_b128 v[44:47], v11 offset:28672
  s_add_u32 s37, s87, 12288
  v_mfma_f32_16x16x32_bf16 v[92:95], v[212:215], v[48:51], v[92:95]
  buffer_load_dwordx4 v15, s[8:11], s37 offen lds
  v_mfma_f32_16x16x32_bf16 v[80:83], v[216:219], v[48:51], v[80:83]
  v_exp_f32 v36, v64
  v_mfma_f32_16x16x32_bf16 v[84:87], v[220:223], v[48:51], v[84:87]
  v_exp_f32 v37, v65
  v_mfma_f32_16x16x32_bf16 v[72:75], v[224:227], v[48:51], v[72:75]
  v_exp_f32 v38, v66
  v_mfma_f32_16x16x32_bf16 v[76:79], v[228:231], v[48:51], v[76:79]
  s_add_u32 m0, s36, 114688
  s_waitcnt lgkmcnt(2)
  v_mfma_f32_16x16x32_bf16 v[88:91], v[232:235], v[52:55], v[88:91]
  ds_read_b128 v[48:51], v6 offset:0
  s_add_u32 s37, s84, 13312
  v_mfma_f32_16x16x32_bf16 v[92:95], v[236:239], v[52:55], v[92:95]
  buffer_load_dwordx4 v15, s[8:11], s37 offen lds
  v_mfma_f32_16x16x32_bf16 v[80:83], v[240:243], v[52:55], v[80:83]
  v_exp_f32 v39, v67
  v_mfma_f32_16x16x32_bf16 v[84:87], v[244:247], v[52:55], v[84:87]
  v_fma_f32 v36, v36, s54, s54
  v_fma_f32 v37, v37, s54, s54
  v_mfma_f32_16x16x32_bf16 v[72:75], v[248:251], v[52:55], v[72:75]
  v_fma_f32 v38, v38, s54, s54
  v_fma_f32 v39, v39, s54, s54
  v_mfma_f32_16x16x32_bf16 v[76:79], v[252:255], v[52:55], v[76:79]
  s_add_u32 m0, s36, 20480
  s_waitcnt lgkmcnt(2)
  v_mfma_f32_16x16x32_bf16 v[96:99], v[208:211], v[40:43], v[96:99]
  ds_read_b128 v[52:55], v7 offset:0
  s_add_u32 s37, s85, 13312
  v_mfma_f32_16x16x32_bf16 v[100:103], v[212:215], v[40:43], v[100:103]
  buffer_load_dwordx4 v15, s[8:11], s37 offen lds
  v_mfma_f32_16x16x32_bf16 v[88:91], v[216:219], v[40:43], v[88:91]
  v_rcp_f32 v36, v36
  v_mfma_f32_16x16x32_bf16 v[92:95], v[220:223], v[40:43], v[92:95]
  v_rcp_f32 v37, v37
  v_mfma_f32_16x16x32_bf16 v[80:83], v[224:227], v[40:43], v[80:83]
  v_rcp_f32 v38, v38
  v_mfma_f32_16x16x32_bf16 v[84:87], v[228:231], v[40:43], v[84:87]
  s_add_u32 m0, s36, 12288
  s_waitcnt lgkmcnt(2)
  v_mfma_f32_16x16x32_bf16 v[96:99], v[232:235], v[44:47], v[96:99]
  ds_read_b128 v[40:43], v6 offset:4096
  s_add_u32 s37, s86, 13312
  v_mfma_f32_16x16x32_bf16 v[100:103], v[236:239], v[44:47], v[100:103]
  buffer_load_dwordx4 v15, s[8:11], s37 offen lds
  v_mfma_f32_16x16x32_bf16 v[88:91], v[240:243], v[44:47], v[88:91]
  v_rcp_f32 v39, v39
  v_mfma_f32_16x16x32_bf16 v[92:95], v[244:247], v[44:47], v[92:95]
  v_mul_f32 v64, v64, v36
  v_mul_f32 v65, v65, v37
  v_mfma_f32_16x16x32_bf16 v[80:83], v[248:251], v[44:47], v[80:83]
  v_mul_f32 v66, v66, v38
  v_mul_f32 v67, v67, v39
  v_mfma_f32_16x16x32_bf16 v[84:87], v[252:255], v[44:47], v[84:87]
  s_add_u32 m0, s36, 49152
  s_waitcnt lgkmcnt(2)
  v_mfma_f32_16x16x32_bf16 v[104:107], v[208:211], v[48:51], v[104:107]
  ds_read_b128 v[44:47], v7 offset:4096
  s_add_u32 s37, s87, 13312
  v_mfma_f32_16x16x32_bf16 v[108:111], v[212:215], v[48:51], v[108:111]
  buffer_load_dwordx4 v15, s[8:11], s37 offen lds
  v_fma_f32 v68, v68, v24, v32
  v_mfma_f32_16x16x32_bf16 v[96:99], v[216:219], v[48:51], v[96:99]
  v_fma_f32 v69, v69, v25, v33
  v_fma_f32 v70, v70, v26, v34
  v_mfma_f32_16x16x32_bf16 v[100:103], v[220:223], v[48:51], v[100:103]
  v_fma_f32 v71, v71, v27, v35
  v_mfma_f32_16x16x32_bf16 v[88:91], v[224:227], v[48:51], v[88:91]
  v_exp_f32 v36, v68
  v_mfma_f32_16x16x32_bf16 v[92:95], v[228:231], v[48:51], v[92:95]
  s_waitcnt lgkmcnt(2)
  v_mfma_f32_16x16x32_bf16 v[104:107], v[232:235], v[52:55], v[104:107]
  ds_read_b128 v[48:51], v6 offset:8192
  v_mfma_f32_16x16x32_bf16 v[108:111], v[236:239], v[52:55], v[108:111]
  v_exp_f32 v37, v69
  v_mfma_f32_16x16x32_bf16 v[96:99], v[240:243], v[52:55], v[96:99]
  v_exp_f32 v38, v70
  v_mfma_f32_16x16x32_bf16 v[100:103], v[244:247], v[52:55], v[100:103]
  v_exp_f32 v39, v71
  v_mfma_f32_16x16x32_bf16 v[88:91], v[248:251], v[52:55], v[88:91]
  v_fma_f32 v36, v36, s54, s54
  v_fma_f32 v37, v37, s54, s54
  v_mfma_f32_16x16x32_bf16 v[92:95], v[252:255], v[52:55], v[92:95]
  v_fma_f32 v38, v38, s54, s54
  s_waitcnt lgkmcnt(2)
  v_mfma_f32_16x16x32_bf16 v[112:115], v[208:211], v[40:43], v[112:115]
  ds_read_b128 v[52:55], v7 offset:8192
  v_fma_f32 v39, v39, s54, s54
  v_mfma_f32_16x16x32_bf16 v[116:119], v[212:215], v[40:43], v[116:119]
  v_rcp_f32 v36, v36
  v_mfma_f32_16x16x32_bf16 v[104:107], v[216:219], v[40:43], v[104:107]
  v_rcp_f32 v37, v37
  v_mfma_f32_16x16x32_bf16 v[108:111], v[220:223], v[40:43], v[108:111]
  v_rcp_f32 v38, v38
  v_mfma_f32_16x16x32_bf16 v[96:99], v[224:227], v[40:43], v[96:99]
  v_rcp_f32 v39, v39
  v_mfma_f32_16x16x32_bf16 v[100:103], v[228:231], v[40:43], v[100:103]
  v_mul_f32 v68, v68, v36
  s_waitcnt vmcnt(23)
  s_barrier
  s_waitcnt lgkmcnt(2)
  v_mfma_f32_16x16x32_bf16 v[112:115], v[232:235], v[44:47], v[112:115]
  ds_read_b128 v[40:43], v4 offset:53248
  s_add_u32 m0, s36, 24576
  v_mfma_f32_16x16x32_bf16 v[116:119], v[236:239], v[44:47], v[116:119]
  s_add_u32 s37, s84, 14336
  buffer_load_dwordx4 v15, s[8:11], s37 offen nt lds
  v_mfma_f32_16x16x32_bf16 v[104:107], v[240:243], v[44:47], v[104:107]
  v_mul_f32 v69, v69, v37
  v_mul_f32 v70, v70, v38
  v_mfma_f32_16x16x32_bf16 v[108:111], v[244:247], v[44:47], v[108:111]
  v_mul_f32 v71, v71, v39
  v_cvt_pk_bf16_f32 v64, v64, v65
  v_mfma_f32_16x16x32_bf16 v[96:99], v[248:251], v[44:47], v[96:99]
  v_cvt_pk_bf16_f32 v65, v66, v67
  v_cvt_pk_bf16_f32 v66, v68, v69
  v_mfma_f32_16x16x32_bf16 v[100:103], v[252:255], v[44:47], v[100:103]
  s_add_u32 m0, s36, 28672
  s_waitcnt lgkmcnt(2)
  v_mfma_f32_16x16x32_bf16 v[120:123], v[208:211], v[48:51], v[120:123]
  ds_read_b128 v[44:47], v5 offset:53248
  s_add_u32 s37, s85, 14336
  v_mfma_f32_16x16x32_bf16 v[124:127], v[212:215], v[48:51], v[124:127]
  buffer_load_dwordx4 v15, s[8:11], s37 offen nt lds
  v_cvt_pk_bf16_f32 v67, v70, v71
  v_mfma_f32_16x16x32_bf16 v[112:115], v[216:219], v[48:51], v[112:115]
  s_mov_b32 s38, 0
  buffer_store_dwordx4 v[64:67], v17, s[16:19], s38 offen sc1
  v_mfma_f32_16x16x32_bf16 v[116:119], v[220:223], v[48:51], v[116:119]
  v_fma_f32 v56, v56, v20, v28
  v_fma_f32 v57, v57, v21, v29
  v_mfma_f32_16x16x32_bf16 v[104:107], v[224:227], v[48:51], v[104:107]
  v_fma_f32 v58, v58, v22, v30
  v_fma_f32 v59, v59, v23, v31
  v_mfma_f32_16x16x32_bf16 v[108:111], v[228:231], v[48:51], v[108:111]
  s_add_u32 m0, s36, 118784
  s_waitcnt lgkmcnt(2)
  v_mfma_f32_16x16x32_bf16 v[120:123], v[232:235], v[52:55], v[120:123]
  ds_read_b128 v[48:51], v6 offset:53248
  s_add_u32 s37, s86, 14336
  v_mfma_f32_16x16x32_bf16 v[124:127], v[236:239], v[52:55], v[124:127]
  buffer_load_dwordx4 v15, s[8:11], s37 offen nt lds
  v_mfma_f32_16x16x32_bf16 v[112:115], v[240:243], v[52:55], v[112:115]
  v_exp_f32 v36, v56
  v_mfma_f32_16x16x32_bf16 v[116:119], v[244:247], v[52:55], v[116:119]
  v_exp_f32 v37, v57
  v_mfma_f32_16x16x32_bf16 v[104:107], v[248:251], v[52:55], v[104:107]
  v_exp_f32 v38, v58
  v_mfma_f32_16x16x32_bf16 v[108:111], v[252:255], v[52:55], v[108:111]
  s_add_u32 m0, s36, 90112
  s_waitcnt lgkmcnt(2)
  v_mfma_f32_16x16x32_bf16 v[64:67], a[0:3], v[40:43], 0
  ds_read_b128 v[52:55], v7 offset:53248
  s_add_u32 s37, s87, 14336
  v_mfma_f32_16x16x32_bf16 v[68:71], a[4:7], v[40:43], 0
  buffer_load_dwordx4 v15, s[8:11], s37 offen nt lds
  v_mfma_f32_16x16x32_bf16 v[120:123], a[8:11], v[40:43], v[120:123]
  v_exp_f32 v39, v59
  v_mfma_f32_16x16x32_bf16 v[124:127], a[12:15], v[40:43], v[124:127]
  v_fma_f32 v36, v36, s54, s54
  v_fma_f32 v37, v37, s54, s54
  v_mfma_f32_16x16x32_bf16 v[112:115], a[16:19], v[40:43], v[112:115]
  v_fma_f32 v38, v38, s54, s54
  v_fma_f32 v39, v39, s54, s54
  v_mfma_f32_16x16x32_bf16 v[116:119], a[20:23], v[40:43], v[116:119]
  s_waitcnt vmcnt(26)
  s_barrier
  s_waitcnt lgkmcnt(2)
  v_mfma_f32_16x16x32_bf16 v[64:67], a[24:27], v[44:47], v[64:67]
  ds_read_b128 v[40:43], v4 offset:57344
  v_mfma_f32_16x16x32_bf16 v[68:71], a[28:31], v[44:47], v[68:71]
  v_rcp_f32 v36, v36
  v_mfma_f32_16x16x32_bf16 v[120:123], a[32:35], v[44:47], v[120:123]
  v_rcp_f32 v37, v37
  v_mfma_f32_16x16x32_bf16 v[124:127], a[36:39], v[44:47], v[124:127]
  v_rcp_f32 v38, v38
  v_mfma_f32_16x16x32_bf16 v[112:115], a[40:43], v[44:47], v[112:115]
  v_rcp_f32 v39, v39
  v_mfma_f32_16x16x32_bf16 v[116:119], a[44:47], v[44:47], v[116:119]
  v_mul_f32 v56, v56, v36
  s_waitcnt lgkmcnt(2)
  v_mfma_f32_16x16x32_bf16 v[64:67], a[48:51], v[48:51], v[64:67]
  ds_read_b128 v[44:47], v5 offset:57344
  v_mul_f32 v57, v57, v37
  v_mfma_f32_16x16x32_bf16 v[68:71], a[52:55], v[48:51], v[68:71]
  v_mul_f32 v58, v58, v38
  v_mul_f32 v59, v59, v39
  v_mfma_f32_16x16x32_bf16 v[120:123], a[56:59], v[48:51], v[120:123]
  v_fma_f32 v60, v60, v24, v32
  v_fma_f32 v61, v61, v25, v33
  v_mfma_f32_16x16x32_bf16 v[124:127], a[60:63], v[48:51], v[124:127]
  v_fma_f32 v62, v62, v26, v34
  v_fma_f32 v63, v63, v27, v35
  v_mfma_f32_16x16x32_bf16 v[112:115], a[64:67], v[48:51], v[112:115]
  v_exp_f32 v36, v60
  v_mfma_f32_16x16x32_bf16 v[116:119], a[68:71], v[48:51], v[116:119]
  s_waitcnt lgkmcnt(2)
  v_mfma_f32_16x16x32_bf16 v[64:67], a[72:75], v[52:55], v[64:67]
  ds_read_b128 v[48:51], v6 offset:57344
  v_mfma_f32_16x16x32_bf16 v[68:71], a[76:79], v[52:55], v[68:71]
  v_exp_f32 v37, v61
  v_mfma_f32_16x16x32_bf16 v[120:123], a[80:83], v[52:55], v[120:123]
  s_add_u32 m0, s36, 94208
  s_add_u32 s37, s84, 15360
  v_mfma_f32_16x16x32_bf16 v[124:127], a[84:87], v[52:55], v[124:127]
  buffer_load_dwordx4 v15, s[8:11], s37 offen nt lds
  v_mfma_f32_16x16x32_bf16 v[112:115], a[88:91], v[52:55], v[112:115]
  v_exp_f32 v38, v62
  v_mfma_f32_16x16x32_bf16 v[116:119], a[92:95], v[52:55], v[116:119]
  s_waitcnt lgkmcnt(2)
  v_mfma_f32_16x16x32_bf16 v[64:67], a[96:99], v[40:43], v[64:67]
  ds_read_b128 v[52:55], v7 offset:57344
  v_mfma_f32_16x16x32_bf16 v[68:71], a[100:103], v[40:43], v[68:71]
  v_exp_f32 v39, v63
  v_mfma_f32_16x16x32_bf16 v[120:123], a[104:107], v[40:43], v[120:123]
  v_fma_f32 v36, v36, s54, s54
  v_fma_f32 v37, v37, s54, s54
  v_mfma_f32_16x16x32_bf16 v[124:127], a[108:111], v[40:43], v[124:127]
  v_fma_f32 v38, v38, s54, s54
  v_fma_f32 v39, v39, s54, s54
  v_mfma_f32_16x16x32_bf16 v[112:115], a[112:115], v[40:43], v[112:115]
  v_rcp_f32 v36, v36
  v_mfma_f32_16x16x32_bf16 v[116:119], a[116:119], v[40:43], v[116:119]
  s_waitcnt lgkmcnt(2)
  v_mfma_f32_16x16x32_bf16 v[64:67], a[120:123], v[44:47], v[64:67]
  ds_read_b128 v[40:43], v8 offset:57344
  v_mfma_f32_16x16x32_bf16 v[68:71], a[124:127], v[44:47], v[68:71]
  v_rcp_f32 v37, v37
  v_mfma_f32_16x16x32_bf16 v[120:123], a[128:131], v[44:47], v[120:123]
  v_rcp_f32 v38, v38
  v_mfma_f32_16x16x32_bf16 v[124:127], a[132:135], v[44:47], v[124:127]
  v_rcp_f32 v39, v39
  v_mfma_f32_16x16x32_bf16 v[112:115], a[136:139], v[44:47], v[112:115]
  v_mul_f32 v60, v60, v36
  v_mul_f32 v61, v61, v37
  v_mfma_f32_16x16x32_bf16 v[116:119], a[140:143], v[44:47], v[116:119]
  v_mul_f32 v62, v62, v38
  s_waitcnt vmcnt(23)
  s_barrier
  s_waitcnt lgkmcnt(2)
  v_mfma_f32_16x16x32_bf16 v[64:67], a[144:147], v[48:51], v[64:67]
  ds_read_b128 v[44:47], v9 offset:57344
  v_mul_f32 v63, v63, v39
  v_mfma_f32_16x16x32_bf16 v[68:71], a[148:151], v[48:51], v[68:71]
  v_cvt_pk_bf16_f32 v56, v56, v57
  v_cvt_pk_bf16_f32 v57, v58, v59
  v_mfma_f32_16x16x32_bf16 v[120:123], a[152:155], v[48:51], v[120:123]
  v_cvt_pk_bf16_f32 v58, v60, v61
  v_cvt_pk_bf16_f32 v59, v62, v63
  v_mfma_f32_16x16x32_bf16 v[124:127], a[156:159], v[48:51], v[124:127]
  s_mov_b32 s38, 1024
  buffer_store_dwordx4 v[56:59], v17, s[16:19], s38 offen sc1
  v_mfma_f32_16x16x32_bf16 v[112:115], a[160:163], v[48:51], v[112:115]
  s_add_u32 m0, s36, 0
  s_add_u32 s37, s85, 15360
  v_mfma_f32_16x16x32_bf16 v[116:119], a[164:167], v[48:51], v[116:119]
  buffer_load_dwordx4 v15, s[8:11], s37 offen nt lds
  s_waitcnt lgkmcnt(2)
  v_mfma_f32_16x16x32_bf16 v[64:67], a[168:171], v[52:55], v[64:67]
  ds_read_b128 v[48:51], v10 offset:57344
  v_fma_f32 v72, v72, v20, v28
  v_mfma_f32_16x16x32_bf16 v[68:71], a[172:175], v[52:55], v[68:71]
  v_fma_f32 v73, v73, v21, v29
  v_fma_f32 v74, v74, v22, v30
  v_mfma_f32_16x16x32_bf16 v[120:123], a[176:179], v[52:55], v[120:123]
  v_fma_f32 v75, v75, v23, v31
  v_mfma_f32_16x16x32_bf16 v[124:127], a[180:183], v[52:55], v[124:127]
  v_exp_f32 v36, v72
  v_mfma_f32_16x16x32_bf16 v[112:115], a[184:187], v[52:55], v[112:115]
  v_exp_f32 v37, v73
  v_mfma_f32_16x16x32_bf16 v[116:119], a[188:191], v[52:55], v[116:119]
  s_waitcnt lgkmcnt(2)
  v_mfma_f32_16x16x32_bf16 v[64:67], a[192:195], v[40:43], v[64:67]
  ds_read_b128 v[52:55], v11 offset:57344
  v_mfma_f32_16x16x32_bf16 v[68:71], a[196:199], v[40:43], v[68:71]
  v_exp_f32 v38, v74
  v_mfma_f32_16x16x32_bf16 v[120:123], a[200:203], v[40:43], v[120:123]
  v_exp_f32 v39, v75
  v_mfma_f32_16x16x32_bf16 v[124:127], a[204:207], v[40:43], v[124:127]
  v_fma_f32 v36, v36, s54, s54
  v_fma_f32 v37, v37, s54, s54
  v_mfma_f32_16x16x32_bf16 v[112:115], a[208:211], v[40:43], v[112:115]
  v_fma_f32 v38, v38, s54, s54
  v_fma_f32 v39, v39, s54, s54
  v_mfma_f32_16x16x32_bf16 v[116:119], a[212:215], v[40:43], v[116:119]
  s_waitcnt lgkmcnt(2)
  v_mfma_f32_16x16x32_bf16 v[64:67], a[216:219], v[44:47], v[64:67]
  ds_read_b128 v[40:43], v8 offset:61440
  v_mfma_f32_16x16x32_bf16 v[68:71], a[220:223], v[44:47], v[68:71]
  v_rcp_f32 v36, v36
  v_mfma_f32_16x16x32_bf16 v[120:123], a[224:227], v[44:47], v[120:123]
  v_rcp_f32 v37, v37
  v_mfma_f32_16x16x32_bf16 v[124:127], a[228:231], v[44:47], v[124:127]
  v_rcp_f32 v38, v38
  v_mfma_f32_16x16x32_bf16 v[112:115], a[232:235], v[44:47], v[112:115]
  v_rcp_f32 v39, v39
  v_mfma_f32_16x16x32_bf16 v[116:119], a[236:239], v[44:47], v[116:119]
  v_mul_f32 v72, v72, v36
  s_waitcnt lgkmcnt(2)
  v_mfma_f32_16x16x32_bf16 v[64:67], a[240:243], v[48:51], v[64:67]
  ds_read_b128 v[44:47], v9 offset:61440
  s_add_u32 m0, s36, 4096
  v_mfma_f32_16x16x32_bf16 v[68:71], a[244:247], v[48:51], v[68:71]
  s_add_u32 s37, s86, 15360
  buffer_load_dwordx4 v15, s[8:11], s37 offen nt lds
  v_mfma_f32_16x16x32_bf16 v[120:123], a[248:251], v[48:51], v[120:123]
  v_mul_f32 v73, v73, v37
  v_mul_f32 v74, v74, v38
  v_mfma_f32_16x16x32_bf16 v[124:127], a[252:255], v[48:51], v[124:127]
  v_mul_f32 v75, v75, v39
  v_fma_f32 v76, v76, v24, v32
  v_mfma_f32_16x16x32_bf16 v[112:115], v[128:131], v[48:51], v[112:115]
  v_fma_f32 v77, v77, v25, v33
  v_fma_f32 v78, v78, v26, v34
  v_mfma_f32_16x16x32_bf16 v[116:119], v[132:135], v[48:51], v[116:119]
  v_fma_f32 v79, v79, v27, v35
  s_waitcnt lgkmcnt(2)
  v_mfma_f32_16x16x32_bf16 v[64:67], v[136:139], v[52:55], v[64:67]
  ds_read_b128 v[48:51], v10 offset:61440
  v_mfma_f32_16x16x32_bf16 v[68:71], v[140:143], v[52:55], v[68:71]
  v_exp_f32 v36, v76
  v_mfma_f32_16x16x32_bf16 v[120:123], v[144:147], v[52:55], v[120:123]
  v_exp_f32 v37, v77
  v_mfma_f32_16x16x32_bf16 v[124:127], v[148:151], v[52:55], v[124:127]
  v_exp_f32 v38, v78
  v_mfma_f32_16x16x32_bf16 v[112:115], v[152:155], v[52:55], v[112:115]
  v_exp_f32 v39, v79
  v_mfma_f32_16x16x32_bf16 v[116:119], v[156:159], v[52:55], v[116:119]
  v_fma_f32 v36, v36, s54, s54
  s_waitcnt lgkmcnt(2)
  v_mfma_f32_16x16x32_bf16 v[64:67], v[160:163], v[40:43], v[64:67]
  ds_read_b128 v[52:55], v11 offset:61440
  v_fma_f32 v37, v37, s54, s54
  v_mfma_f32_16x16x32_bf16 v[68:71], v[164:167], v[40:43], v[68:71]
  v_fma_f32 v38, v38, s54, s54
  v_fma_f32 v39, v39, s54, s54
  v_mfma_f32_16x16x32_bf16 v[120:123], v[168:171], v[40:43], v[120:123]
  v_rcp_f32 v36, v36
  v_mfma_f32_16x16x32_bf16 v[124:127], v[172:175], v[40:43], v[124:127]
  v_rcp_f32 v37, v37
  v_mfma_f32_16x16x32_bf16 v[112:115], v[176:179], v[40:43], v[112:115]
  v_rcp_f32 v38, v38
  v_mfma_f32_16x16x32_bf16 v[116:119], v[180:183], v[40:43], v[116:119]
  s_waitcnt lgkmcnt(2)
  v_mfma_f32_16x16x32_bf16 v[64:67], v[184:187], v[44:47], v[64:67]
  ds_read_b128 v[40:43], v4 offset:32768
  v_mfma_f32_16x16x32_bf16 v[68:71], v[188:191], v[44:47], v[68:71]
  v_rcp_f32 v39, v39
  v_mfma_f32_16x16x32_bf16 v[120:123], v[192:195], v[44:47], v[120:123]
  s_add_u32 m0, s36, 8192
  s_add_u32 s37, s87, 15360
  v_mfma_f32_16x16x32_bf16 v[124:127], v[196:199], v[44:47], v[124:127]
  buffer_load_dwordx4 v15, s[8:11], s37 offen nt lds
  v_mul_f32 v76, v76, v36
  v_mfma_f32_16x16x32_bf16 v[112:115], v[200:203], v[44:47], v[112:115]
  v_mul_f32 v77, v77, v37
  v_mul_f32 v78, v78, v38
  v_mfma_f32_16x16x32_bf16 v[116:119], v[204:207], v[44:47], v[116:119]
  v_mul_f32 v79, v79, v39
  s_waitcnt lgkmcnt(2)
  v_mfma_f32_16x16x32_bf16 v[64:67], v[208:211], v[48:51], v[64:67]
  ds_read_b128 v[44:47], v5 offset:32768
  v_cvt_pk_bf16_f32 v72, v72, v73
  v_mfma_f32_16x16x32_bf16 v[68:71], v[212:215], v[48:51], v[68:71]
  v_cvt_pk_bf16_f32 v73, v74, v75
  v_cvt_pk_bf16_f32 v74, v76, v77
  v_mfma_f32_16x16x32_bf16 v[120:123], v[216:219], v[48:51], v[120:123]
  v_cvt_pk_bf16_f32 v75, v78, v79
  s_mov_b32 s38, 2048
  v_mfma_f32_16x16x32_bf16 v[124:127], v[220:223], v[48:51], v[124:127]
  buffer_store_dwordx4 v[72:75], v17, s[16:19], s38 offen sc1
  v_fma_f32 v80, v80, v20, v28
  v_mfma_f32_16x16x32_bf16 v[112:115], v[224:227], v[48:51], v[112:115]
  v_fma_f32 v81, v81, v21, v29
  v_fma_f32 v82, v82, v22, v30
  v_mfma_f32_16x16x32_bf16 v[116:119], v[228:231], v[48:51], v[116:119]
  v_fma_f32 v83, v83, v23, v31
  s_waitcnt lgkmcnt(2)
  v_mfma_f32_16x16x32_bf16 v[64:67], v[232:235], v[52:55], v[64:67]
  ds_read_b128 v[48:51], v6 offset:32768
  v_mfma_f32_16x16x32_bf16 v[68:71], v[236:239], v[52:55], v[68:71]
  v_exp_f32 v36, v80
  v_mfma_f32_16x16x32_bf16 v[120:123], v[240:243], v[52:55], v[120:123]
  v_exp_f32 v37, v81
  v_mfma_f32_16x16x32_bf16 v[124:127], v[244:247], v[52:55], v[124:127]
  v_exp_f32 v38, v82
  v_mfma_f32_16x16x32_bf16 v[112:115], v[248:251], v[52:55], v[112:115]
  v_exp_f32 v39, v83
  v_mfma_f32_16x16x32_bf16 v[116:119], v[252:255], v[52:55], v[116:119]
  v_fma_f32 v36, v36, s54, s54
  s_waitcnt lgkmcnt(2)
  v_mfma_f32_16x16x32_bf16 v[56:59], a[0:3], v[40:43], 0
  ds_read_b128 v[52:55], v7 offset:32768
  v_fma_f32 v37, v37, s54, s54
  v_mfma_f32_16x16x32_bf16 v[60:63], a[4:7], v[40:43], 0
  v_fma_f32 v38, v38, s54, s54
  v_fma_f32 v39, v39, s54, s54
  v_mfma_f32_16x16x32_bf16 v[64:67], a[8:11], v[40:43], v[64:67]
  v_rcp_f32 v36, v36
  v_mfma_f32_16x16x32_bf16 v[68:71], a[12:15], v[40:43], v[68:71]
  v_rcp_f32 v37, v37
  v_mfma_f32_16x16x32_bf16 v[120:123], a[16:19], v[40:43], v[120:123]
  s_add_u32 m0, s36, 53248
  s_add_u32 s37, s84, 16384
  v_mfma_f32_16x16x32_bf16 v[124:127], a[20:23], v[40:43], v[124:127]
  buffer_load_dwordx4 v15, s[8:11], s37 offen nt lds
  s_waitcnt lgkmcnt(2)
  v_mfma_f32_16x16x32_bf16 v[56:59], a[24:27], v[44:47], v[56:59]
  ds_read_b128 v[40:43], v4 offset:36864
  v_mfma_f32_16x16x32_bf16 v[60:63], a[28:31], v[44:47], v[60:63]
  v_rcp_f32 v38, v38
  v_mfma_f32_16x16x32_bf16 v[64:67], a[32:35], v[44:47], v[64:67]
  v_rcp_f32 v39, v39
  v_mfma_f32_16x16x32_bf16 v[68:71], a[36:39], v[44:47], v[68:71]
  v_mul_f32 v80, v80, v36
  v_mul_f32 v81, v81, v37
  v_mfma_f32_16x16x32_bf16 v[120:123], a[40:43], v[44:47], v[120:123]
  v_mul_f32 v82, v82, v38
  v_mul_f32 v83, v83, v39
  v_mfma_f32_16x16x32_bf16 v[124:127], a[44:47], v[44:47], v[124:127]
  v_fma_f32 v84, v84, v24, v32
  s_waitcnt lgkmcnt(2)
  v_mfma_f32_16x16x32_bf16 v[56:59], a[48:51], v[48:51], v[56:59]
  ds_read_b128 v[44:47], v5 offset:36864
  v_fma_f32 v85, v85, v25, v33
  v_mfma_f32_16x16x32_bf16 v[60:63], a[52:55], v[48:51], v[60:63]
  v_fma_f32 v86, v86, v26, v34
  v_fma_f32 v87, v87, v27, v35
  v_mfma_f32_16x16x32_bf16 v[64:67], a[56:59], v[48:51], v[64:67]
  v_exp_f32 v36, v84
  v_mfma_f32_16x16x32_bf16 v[68:71], a[60:63], v[48:51], v[68:71]
  v_exp_f32 v37, v85
  v_mfma_f32_16x16x32_bf16 v[120:123], a[64:67], v[48:51], v[120:123]
  v_exp_f32 v38, v86
  v_mfma_f32_16x16x32_bf16 v[124:127], a[68:71], v[48:51], v[124:127]
  s_waitcnt lgkmcnt(2)
  v_mfma_f32_16x16x32_bf16 v[56:59], a[72:75], v[52:55], v[56:59]
  ds_read_b128 v[48:51], v6 offset:36864
  v_mfma_f32_16x16x32_bf16 v[60:63], a[76:79], v[52:55], v[60:63]
  v_exp_f32 v39, v87
  v_mfma_f32_16x16x32_bf16 v[64:67], a[80:83], v[52:55], v[64:67]
  v_fma_f32 v36, v36, s54, s54
  v_fma_f32 v37, v37, s54, s54
  v_mfma_f32_16x16x32_bf16 v[68:71], a[84:87], v[52:55], v[68:71]
  v_fma_f32 v38, v38, s54, s54
  v_fma_f32 v39, v39, s54, s54
  v_mfma_f32_16x16x32_bf16 v[120:123], a[88:91], v[52:55], v[120:123]
  v_rcp_f32 v36, v36
  v_mfma_f32_16x16x32_bf16 v[124:127], a[92:95], v[52:55], v[124:127]
  s_waitcnt lgkmcnt(2)
  v_mfma_f32_16x16x32_bf16 v[56:59], a[96:99], v[40:43], v[56:59]
  ds_read_b128 v[52:55], v7 offset:36864
  v_mfma_f32_16x16x32_bf16 v[60:63], a[100:103], v[40:43], v[60:63]
  v_rcp_f32 v37, v37
  v_mfma_f32_16x16x32_bf16 v[64:67], a[104:107], v[40:43], v[64:67]
  v_rcp_f32 v38, v38
  v_mfma_f32_16x16x32_bf16 v[68:71], a[108:111], v[40:43], v[68:71]
  v_rcp_f32 v39, v39
  v_mfma_f32_16x16x32_bf16 v[120:123], a[112:115], v[40:43], v[120:123]
  v_mul_f32 v84, v84, v36
  v_mul_f32 v85, v85, v37
  v_mfma_f32_16x16x32_bf16 v[124:127], a[116:119], v[40:43], v[124:127]
  v_mul_f32 v86, v86, v38
  s_waitcnt lgkmcnt(2)
  v_mfma_f32_16x16x32_bf16 v[56:59], a[120:123], v[44:47], v[56:59]
  ds_read_b128 v[40:43], v4 offset:40960
  v_mul_f32 v87, v87, v39
  v_mfma_f32_16x16x32_bf16 v[60:63], a[124:127], v[44:47], v[60:63]
  v_cvt_pk_bf16_f32 v80, v80, v81
  v_cvt_pk_bf16_f32 v81, v82, v83
  v_mfma_f32_16x16x32_bf16 v[64:67], a[128:131], v[44:47], v[64:67]
  v_cvt_pk_bf16_f32 v82, v84, v85
  v_cvt_pk_bf16_f32 v83, v86, v87
  v_mfma_f32_16x16x32_bf16 v[68:71], a[132:135], v[44:47], v[68:71]
  s_mov_b32 s38, 3072
  buffer_store_dwordx4 v[80:83], v17, s[16:19], s38 offen sc1
  v_mfma_f32_16x16x32_bf16 v[120:123], a[136:139], v[44:47], v[120:123]
  v_fma_f32 v88, v88, v20, v28
  v_fma_f32 v89, v89, v21, v29
  v_mfma_f32_16x16x32_bf16 v[124:127], a[140:143], v[44:47], v[124:127]
  v_fma_f32 v90, v90, v22, v30
  s_waitcnt vmcnt(26)
  s_barrier
  s_waitcnt lgkmcnt(2)
  v_mfma_f32_16x16x32_bf16 v[56:59], a[144:147], v[48:51], v[56:59]
  ds_read_b128 v[44:47], v5 offset:40960
  s_add_u32 m0, s36, 57344
  v_mfma_f32_16x16x32_bf16 v[60:63], a[148:151], v[48:51], v[60:63]
  s_add_u32 s37, s85, 16384
  buffer_load_dwordx4 v15, s[8:11], s37 offen nt lds
  v_mfma_f32_16x16x32_bf16 v[64:67], a[152:155], v[48:51], v[64:67]
  v_fma_f32 v91, v91, v23, v31
  v_mfma_f32_16x16x32_bf16 v[68:71], a[156:159], v[48:51], v[68:71]
  v_exp_f32 v36, v88
  v_mfma_f32_16x16x32_bf16 v[120:123], a[160:163], v[48:51], v[120:123]
  v_exp_f32 v37, v89
  v_mfma_f32_16x16x32_bf16 v[124:127], a[164:167], v[48:51], v[124:127]
  s_waitcnt lgkmcnt(2)
  v_mfma_f32_16x16x32_bf16 v[56:59], a[168:171], v[52:55], v[56:59]
  ds_read_b128 v[48:51], v6 offset:40960
  v_mfma_f32_16x16x32_bf16 v[60:63], a[172:175], v[52:55], v[60:63]
  v_exp_f32 v38, v90
  v_mfma_f32_16x16x32_bf16 v[64:67], a[176:179], v[52:55], v[64:67]
  v_exp_f32 v39, v91
  v_mfma_f32_16x16x32_bf16 v[68:71], a[180:183], v[52:55], v[68:71]
  v_fma_f32 v36, v36, s54, s54
  v_fma_f32 v37, v37, s54, s54
  v_mfma_f32_16x16x32_bf16 v[120:123], a[184:187], v[52:55], v[120:123]
  v_fma_f32 v38, v38, s54, s54
  v_fma_f32 v39, v39, s54, s54
  v_mfma_f32_16x16x32_bf16 v[124:127], a[188:191], v[52:55], v[124:127]
  s_waitcnt lgkmcnt(2)
  v_mfma_f32_16x16x32_bf16 v[56:59], a[192:195], v[40:43], v[56:59]
  ds_read_b128 v[52:55], v7 offset:40960
  v_mfma_f32_16x16x32_bf16 v[60:63], a[196:199], v[40:43], v[60:63]
  v_rcp_f32 v36, v36
  v_mfma_f32_16x16x32_bf16 v[64:67], a[200:203], v[40:43], v[64:67]
  v_rcp_f32 v37, v37
  v_mfma_f32_16x16x32_bf16 v[68:71], a[204:207], v[40:43], v[68:71]
  v_rcp_f32 v38, v38
  v_mfma_f32_16x16x32_bf16 v[120:123], a[208:211], v[40:43], v[120:123]
  v_rcp_f32 v39, v39
  v_mfma_f32_16x16x32_bf16 v[124:127], a[212:215], v[40:43], v[124:127]
  v_mul_f32 v88, v88, v36
  s_waitcnt lgkmcnt(2)
  v_mfma_f32_16x16x32_bf16 v[56:59], a[216:219], v[44:47], v[56:59]
  ds_read_b128 v[40:43], v4 offset:61440
  v_mul_f32 v89, v89, v37
  v_mfma_f32_16x16x32_bf16 v[60:63], a[220:223], v[44:47], v[60:63]
  v_mul_f32 v90, v90, v38
  v_mul_f32 v91, v91, v39
  v_mfma_f32_16x16x32_bf16 v[64:67], a[224:227], v[44:47], v[64:67]
  s_add_u32 m0, s36, 122880
  s_add_u32 s37, s86, 16384
  v_mfma_f32_16x16x32_bf16 v[68:71], a[228:231], v[44:47], v[68:71]
  buffer_load_dwordx4 v15, s[8:11], s37 offen nt lds
  v_fma_f32 v92, v92, v24, v32
  v_mfma_f32_16x16x32_bf16 v[120:123], a[232:235], v[44:47], v[120:123]
  v_fma_f32 v93, v93, v25, v33
  v_fma_f32 v94, v94, v26, v34
  v_mfma_f32_16x16x32_bf16 v[124:127], a[236:239], v[44:47], v[124:127]
  v_fma_f32 v95, v95, v27, v35
  s_waitcnt lgkmcnt(2)
  v_mfma_f32_16x16x32_bf16 v[56:59], a[240:243], v[48:51], v[56:59]
  ds_read_b128 v[44:47], v5 offset:61440
  v_mfma_f32_16x16x32_bf16 v[60:63], a[244:247], v[48:51], v[60:63]
  v_exp_f32 v36, v92
  v_mfma_f32_16x16x32_bf16 v[64:67], a[248:251], v[48:51], v[64:67]
  v_exp_f32 v37, v93
  v_mfma_f32_16x16x32_bf16 v[68:71], a[252:255], v[48:51], v[68:71]
  v_exp_f32 v38, v94
  v_mfma_f32_16x16x32_bf16 v[120:123], v[128:131], v[48:51], v[120:123]
  v_exp_f32 v39, v95
  v_mfma_f32_16x16x32_bf16 v[124:127], v[132:135], v[48:51], v[124:127]
  v_fma_f32 v36, v36, s54, s54
  s_waitcnt lgkmcnt(2)
  v_mfma_f32_16x16x32_bf16 v[56:59], v[136:139], v[52:55], v[56:59]
  ds_read_b128 v[48:51], v6 offset:61440
  v_fma_f32 v37, v37, s54, s54
  v_mfma_f32_16x16x32_bf16 v[60:63], v[140:143], v[52:55], v[60:63]
  v_fma_f32 v38, v38, s54, s54
  v_fma_f32 v39, v39, s54, s54
  v_mfma_f32_16x16x32_bf16 v[64:67], v[144:147], v[52:55], v[64:67]
  v_rcp_f32 v36, v36
  v_mfma_f32_16x16x32_bf16 v[68:71], v[148:151], v[52:55], v[68:71]
  v_rcp_f32 v37, v37
  v_mfma_f32_16x16x32_bf16 v[120:123], v[152:155], v[52:55], v[120:123]
  v_rcp_f32 v38, v38
  v_mfma_f32_16x16x32_bf16 v[124:127], v[156:159], v[52:55], v[124:127]
  s_waitcnt lgkmcnt(2)
  v_mfma_f32_16x16x32_bf16 v[56:59], v[160:163], v[40:43], v[56:59]
  ds_read_b128 v[52:55], v7 offset:61440
  v_mfma_f32_16x16x32_bf16 v[60:63], v[164:167], v[40:43], v[60:63]
  v_rcp_f32 v39, v39
  v_mfma_f32_16x16x32_bf16 v[64:67], v[168:171], v[40:43], v[64:67]
  v_mul_f32 v92, v92, v36
  v_mul_f32 v93, v93, v37
  v_mfma_f32_16x16x32_bf16 v[68:71], v[172:175], v[40:43], v[68:71]
  v_mul_f32 v94, v94, v38
  v_mul_f32 v95, v95, v39
  v_mfma_f32_16x16x32_bf16 v[120:123], v[176:179], v[40:43], v[120:123]
  s_add_u32 m0, s36, 126976
  s_add_u32 s37, s87, 16384
  v_mfma_f32_16x16x32_bf16 v[124:127], v[180:183], v[40:43], v[124:127]
  buffer_load_dwordx4 v15, s[8:11], s37 offen nt lds
  s_waitcnt lgkmcnt(2)
  v_mfma_f32_16x16x32_bf16 v[56:59], v[184:187], v[44:47], v[56:59]
  ds_read_b128 v[40:43], v8 offset:0
  v_cvt_pk_bf16_f32 v88, v88, v89
  v_mfma_f32_16x16x32_bf16 v[60:63], v[188:191], v[44:47], v[60:63]
  v_cvt_pk_bf16_f32 v89, v90, v91
  v_cvt_pk_bf16_f32 v90, v92, v93
  v_mfma_f32_16x16x32_bf16 v[64:67], v[192:195], v[44:47], v[64:67]
  v_cvt_pk_bf16_f32 v91, v94, v95
  s_mov_b32 s38, 4096
  v_mfma_f32_16x16x32_bf16 v[68:71], v[196:199], v[44:47], v[68:71]
  buffer_store_dwordx4 v[88:91], v17, s[16:19], s38 offen sc1
  v_fma_f32 v96, v96, v20, v28
  v_mfma_f32_16x16x32_bf16 v[120:123], v[200:203], v[44:47], v[120:123]
  v_fma_f32 v97, v97, v21, v29
  v_fma_f32 v98, v98, v22, v30
  v_mfma_f32_16x16x32_bf16 v[124:127], v[204:207], v[44:47], v[124:127]
  v_fma_f32 v99, v99, v23, v31
  s_waitcnt lgkmcnt(2)
  v_mfma_f32_16x16x32_bf16 v[56:59], v[208:211], v[48:51], v[56:59]
  ds_read_b128 v[44:47], v9 offset:0
  v_mfma_f32_16x16x32_bf16 v[60:63], v[212:215], v[48:51], v[60:63]
  v_exp_f32 v36, v96
  v_mfma_f32_16x16x32_bf16 v[64:67], v[216:219], v[48:51], v[64:67]
  v_exp_f32 v37, v97
  v_mfma_f32_16x16x32_bf16 v[68:71], v[220:223], v[48:51], v[68:71]
  v_exp_f32 v38, v98
  v_mfma_f32_16x16x32_bf16 v[120:123], v[224:227], v[48:51], v[120:123]
  v_exp_f32 v39, v99
  v_mfma_f32_16x16x32_bf16 v[124:127], v[228:231], v[48:51], v[124:127]
  v_fma_f32 v36, v36, s54, s54
  s_waitcnt lgkmcnt(2)
  v_mfma_f32_16x16x32_bf16 v[56:59], v[232:235], v[52:55], v[56:59]
  ds_read_b128 v[48:51], v10 offset:0
  v_fma_f32 v37, v37, s54, s54
  v_mfma_f32_16x16x32_bf16 v[60:63], v[236:239], v[52:55], v[60:63]
  v_fma_f32 v38, v38, s54, s54
  v_fma_f32 v39, v39, s54, s54
  v_mfma_f32_16x16x32_bf16 v[64:67], v[240:243], v[52:55], v[64:67]
  v_rcp_f32 v36, v36
  v_mfma_f32_16x16x32_bf16 v[68:71], v[244:247], v[52:55], v[68:71]
  v_rcp_f32 v37, v37
  v_mfma_f32_16x16x32_bf16 v[120:123], v[248:251], v[52:55], v[120:123]
  v_rcp_f32 v38, v38
  v_mfma_f32_16x16x32_bf16 v[124:127], v[252:255], v[52:55], v[124:127]
  s_waitcnt lgkmcnt(2)
  v_mfma_f32_16x16x32_bf16 v[72:75], a[0:3], v[40:43], 0
  ds_read_b128 v[52:55], v11 offset:0
  s_add_u32 m0, s36, 32768
  v_mfma_f32_16x16x32_bf16 v[76:79], a[4:7], v[40:43], 0
  s_add_u32 s37, s84, 17408
  buffer_load_dwordx4 v15, s[8:11], s37 offen nt lds
  v_mfma_f32_16x16x32_bf16 v[56:59], a[8:11], v[40:43], v[56:59]
  v_rcp_f32 v39, v39
  v_mfma_f32_16x16x32_bf16 v[60:63], a[12:15], v[40:43], v[60:63]
  v_mul_f32 v96, v96, v36
  v_mul_f32 v97, v97, v37
  v_mfma_f32_16x16x32_bf16 v[64:67], a[16:19], v[40:43], v[64:67]
  v_mul_f32 v98, v98, v38
  v_mul_f32 v99, v99, v39
  v_mfma_f32_16x16x32_bf16 v[68:71], a[20:23], v[40:43], v[68:71]
  v_fma_f32 v100, v100, v24, v32
  s_waitcnt lgkmcnt(2)
  v_mfma_f32_16x16x32_bf16 v[72:75], a[24:27], v[44:47], v[72:75]
  ds_read_b128 v[40:43], v4 offset:16384
  v_fma_f32 v101, v101, v25, v33
  v_mfma_f32_16x16x32_bf16 v[76:79], a[28:31], v[44:47], v[76:79]
  v_fma_f32 v102, v102, v26, v34
  v_fma_f32 v103, v103, v27, v35
  v_mfma_f32_16x16x32_bf16 v[56:59], a[32:35], v[44:47], v[56:59]
  v_exp_f32 v36, v100
  v_mfma_f32_16x16x32_bf16 v[60:63], a[36:39], v[44:47], v[60:63]
  v_exp_f32 v37, v101
  v_mfma_f32_16x16x32_bf16 v[64:67], a[40:43], v[44:47], v[64:67]
  v_exp_f32 v38, v102
  v_mfma_f32_16x16x32_bf16 v[68:71], a[44:47], v[44:47], v[68:71]
  s_waitcnt lgkmcnt(2)
  v_mfma_f32_16x16x32_bf16 v[72:75], a[48:51], v[48:51], v[72:75]
  ds_read_b128 v[44:47], v5 offset:16384
  v_mfma_f32_16x16x32_bf16 v[76:79], a[52:55], v[48:51], v[76:79]
  v_exp_f32 v39, v103
  v_mfma_f32_16x16x32_bf16 v[56:59], a[56:59], v[48:51], v[56:59]
  v_fma_f32 v36, v36, s54, s54
  v_fma_f32 v37, v37, s54, s54
  v_mfma_f32_16x16x32_bf16 v[60:63], a[60:63], v[48:51], v[60:63]
  v_fma_f32 v38, v38, s54, s54
  v_fma_f32 v39, v39, s54, s54
  v_mfma_f32_16x16x32_bf16 v[64:67], a[64:67], v[48:51], v[64:67]
  v_rcp_f32 v36, v36
  v_mfma_f32_16x16x32_bf16 v[68:71], a[68:71], v[48:51], v[68:71]
  s_waitcnt lgkmcnt(2)
  v_mfma_f32_16x16x32_bf16 v[72:75], a[72:75], v[52:55], v[72:75]
  ds_read_b128 v[48:51], v6 offset:16384
  v_mfma_f32_16x16x32_bf16 v[76:79], a[76:79], v[52:55], v[76:79]
  v_rcp_f32 v37, v37
  v_mfma_f32_16x16x32_bf16 v[56:59], a[80:83], v[52:55], v[56:59]
  v_rcp_f32 v38, v38
  v_mfma_f32_16x16x32_bf16 v[60:63], a[84:87], v[52:55], v[60:63]
  v_rcp_f32 v39, v39
  v_mfma_f32_16x16x32_bf16 v[64:67], a[88:91], v[52:55], v[64:67]
  v_mul_f32 v100, v100, v36
  v_mul_f32 v101, v101, v37
  v_mfma_f32_16x16x32_bf16 v[68:71], a[92:95], v[52:55], v[68:71]
  v_mul_f32 v102, v102, v38
  s_waitcnt lgkmcnt(2)
  v_mfma_f32_16x16x32_bf16 v[72:75], a[96:99], v[40:43], v[72:75]
  ds_read_b128 v[52:55], v7 offset:16384
  v_mul_f32 v103, v103, v39
  v_mfma_f32_16x16x32_bf16 v[76:79], a[100:103], v[40:43], v[76:79]
  v_cvt_pk_bf16_f32 v96, v96, v97
  v_cvt_pk_bf16_f32 v97, v98, v99
  v_mfma_f32_16x16x32_bf16 v[56:59], a[104:107], v[40:43], v[56:59]
  v_cvt_pk_bf16_f32 v98, v100, v101
  v_cvt_pk_bf16_f32 v99, v102, v103
  v_mfma_f32_16x16x32_bf16 v[60:63], a[108:111], v[40:43], v[60:63]
  s_mov_b32 s38, 5120
  buffer_store_dwordx4 v[96:99], v17, s[16:19], s38 offen sc1
  v_mfma_f32_16x16x32_bf16 v[64:67], a[112:115], v[40:43], v[64:67]
  v_fma_f32 v104, v104, v20, v28
  v_fma_f32 v105, v105, v21, v29
  v_mfma_f32_16x16x32_bf16 v[68:71], a[116:119], v[40:43], v[68:71]
  v_fma_f32 v106, v106, v22, v30
  s_waitcnt lgkmcnt(2)
  v_mfma_f32_16x16x32_bf16 v[72:75], a[120:123], v[44:47], v[72:75]
  ds_read_b128 v[40:43], v8 offset:32768
  v_fma_f32 v107, v107, v23, v31
  v_mfma_f32_16x16x32_bf16 v[76:79], a[124:127], v[44:47], v[76:79]
  v_exp_f32 v36, v104
  v_mfma_f32_16x16x32_bf16 v[56:59], a[128:131], v[44:47], v[56:59]
  v_exp_f32 v37, v105
  v_mfma_f32_16x16x32_bf16 v[60:63], a[132:135], v[44:47], v[60:63]
  v_exp_f32 v38, v106
  v_mfma_f32_16x16x32_bf16 v[64:67], a[136:139], v[44:47], v[64:67]
  v_exp_f32 v39, v107
  v_mfma_f32_16x16x32_bf16 v[68:71], a[140:143], v[44:47], v[68:71]
  v_fma_f32 v36, v36, s54, s54
  s_waitcnt vmcnt(20)
  s_barrier
  s_waitcnt lgkmcnt(2)
  v_mfma_f32_16x16x32_bf16 v[72:75], a[144:147], v[48:51], v[72:75]
  ds_read_b128 v[44:47], v9 offset:32768
  s_add_u32 m0, s36, 36864
  v_mfma_f32_16x16x32_bf16 v[76:79], a[148:151], v[48:51], v[76:79]
  s_add_u32 s37, s85, 17408
  buffer_load_dwordx4 v15, s[8:11], s37 offen nt lds
  v_mfma_f32_16x16x32_bf16 v[56:59], a[152:155], v[48:51], v[56:59]
  v_fma_f32 v37, v37, s54, s54
  v_fma_f32 v38, v38, s54, s54
  v_mfma_f32_16x16x32_bf16 v[60:63], a[156:159], v[48:51], v[60:63]
  v_fma_f32 v39, v39, s54, s54
  v_mfma_f32_16x16x32_bf16 v[64:67], a[160:163], v[48:51], v[64:67]
  v_rcp_f32 v36, v36
  v_mfma_f32_16x16x32_bf16 v[68:71], a[164:167], v[48:51], v[68:71]
  s_waitcnt lgkmcnt(2)
  v_mfma_f32_16x16x32_bf16 v[72:75], a[168:171], v[52:55], v[72:75]
  ds_read_b128 v[48:51], v10 offset:32768
  v_mfma_f32_16x16x32_bf16 v[76:79], a[172:175], v[52:55], v[76:79]
  v_rcp_f32 v37, v37
  v_mfma_f32_16x16x32_bf16 v[56:59], a[176:179], v[52:55], v[56:59]
  v_rcp_f32 v38, v38
  v_mfma_f32_16x16x32_bf16 v[60:63], a[180:183], v[52:55], v[60:63]
  v_rcp_f32 v39, v39
  v_mfma_f32_16x16x32_bf16 v[64:67], a[184:187], v[52:55], v[64:67]
  v_mul_f32 v104, v104, v36
  v_mul_f32 v105, v105, v37
  v_mfma_f32_16x16x32_bf16 v[68:71], a[188:191], v[52:55], v[68:71]
  v_mul_f32 v106, v106, v38
  s_waitcnt lgkmcnt(2)
  v_mfma_f32_16x16x32_bf16 v[72:75], a[192:195], v[40:43], v[72:75]
  ds_read_b128 v[52:55], v11 offset:32768
  v_mul_f32 v107, v107, v39
  v_mfma_f32_16x16x32_bf16 v[76:79], a[196:199], v[40:43], v[76:79]
  v_fma_f32 v108, v108, v24, v32
  v_fma_f32 v109, v109, v25, v33
  v_mfma_f32_16x16x32_bf16 v[56:59], a[200:203], v[40:43], v[56:59]
  v_fma_f32 v110, v110, v26, v34
  v_fma_f32 v111, v111, v27, v35
  v_mfma_f32_16x16x32_bf16 v[60:63], a[204:207], v[40:43], v[60:63]
  v_exp_f32 v36, v108
  v_mfma_f32_16x16x32_bf16 v[64:67], a[208:211], v[40:43], v[64:67]
  v_exp_f32 v37, v109
  v_mfma_f32_16x16x32_bf16 v[68:71], a[212:215], v[40:43], v[68:71]
  s_waitcnt lgkmcnt(2)
  v_mfma_f32_16x16x32_bf16 v[72:75], a[216:219], v[44:47], v[72:75]
  ds_read_b128 v[40:43], v4 offset:45056
  v_mfma_f32_16x16x32_bf16 v[76:79], a[220:223], v[44:47], v[76:79]
  v_exp_f32 v38, v110
  v_mfma_f32_16x16x32_bf16 v[56:59], a[224:227], v[44:47], v[56:59]
  s_add_u32 m0, s36, 40960
  s_add_u32 s37, s86, 17408
  v_mfma_f32_16x16x32_bf16 v[60:63], a[228:231], v[44:47], v[60:63]
  buffer_load_dwordx4 v15, s[8:11], s37 offen nt lds
  v_mfma_f32_16x16x32_bf16 v[64:67], a[232:235], v[44:47], v[64:67]
  v_exp_f32 v39, v111
  v_mfma_f32_16x16x32_bf16 v[68:71], a[236:239], v[44:47], v[68:71]
  v_fma_f32 v36, v36, s54, s54
  s_waitcnt lgkmcnt(2)
  v_mfma_f32_16x16x32_bf16 v[72:75], a[240:243], v[48:51], v[72:75]
  ds_read_b128 v[44:47], v5 offset:45056
  v_fma_f32 v37, v37, s54, s54
  v_mfma_f32_16x16x32_bf16 v[76:79], a[244:247], v[48:51], v[76:79]
  v_fma_f32 v38, v38, s54, s54
  v_fma_f32 v39, v39, s54, s54
  v_mfma_f32_16x16x32_bf16 v[56:59], a[248:251], v[48:51], v[56:59]
  v_rcp_f32 v36, v36
  v_mfma_f32_16x16x32_bf16 v[60:63], a[252:255], v[48:51], v[60:63]
  v_rcp_f32 v37, v37
  v_mfma_f32_16x16x32_bf16 v[64:67], v[128:131], v[48:51], v[64:67]
  v_rcp_f32 v38, v38
  v_mfma_f32_16x16x32_bf16 v[68:71], v[132:135], v[48:51], v[68:71]
  s_waitcnt lgkmcnt(2)
  v_mfma_f32_16x16x32_bf16 v[72:75], v[136:139], v[52:55], v[72:75]
  ds_read_b128 v[48:51], v6 offset:45056
  v_mfma_f32_16x16x32_bf16 v[76:79], v[140:143], v[52:55], v[76:79]
  v_rcp_f32 v39, v39
  v_mfma_f32_16x16x32_bf16 v[56:59], v[144:147], v[52:55], v[56:59]
  v_mul_f32 v108, v108, v36
  v_mul_f32 v109, v109, v37
  v_mfma_f32_16x16x32_bf16 v[60:63], v[148:151], v[52:55], v[60:63]
  v_mul_f32 v110, v110, v38
  v_mul_f32 v111, v111, v39
  v_mfma_f32_16x16x32_bf16 v[64:67], v[152:155], v[52:55], v[64:67]
  v_cvt_pk_bf16_f32 v104, v104, v105
  v_cvt_pk_bf16_f32 v105, v106, v107
  v_mfma_f32_16x16x32_bf16 v[68:71], v[156:159], v[52:55], v[68:71]
  v_cvt_pk_bf16_f32 v106, v108, v109
  s_waitcnt lgkmcnt(2)
  v_mfma_f32_16x16x32_bf16 v[72:75], v[160:163], v[40:43], v[72:75]
  ds_read_b128 v[52:55], v7 offset:45056
  v_cvt_pk_bf16_f32 v107, v110, v111
  v_mfma_f32_16x16x32_bf16 v[76:79], v[164:167], v[40:43], v[76:79]
  s_mov_b32 s38, 6144
  buffer_store_dwordx4 v[104:107], v17, s[16:19], s38 offen sc1
  v_mfma_f32_16x16x32_bf16 v[56:59], v[168:171], v[40:43], v[56:59]
  v_fma_f32 v112, v112, v20, v28
  v_fma_f32 v113, v113, v21, v29
  v_mfma_f32_16x16x32_bf16 v[60:63], v[172:175], v[40:43], v[60:63]
  v_fma_f32 v114, v114, v22, v30
  v_fma_f32 v115, v115, v23, v31
  v_mfma_f32_16x16x32_bf16 v[64:67], v[176:179], v[40:43], v[64:67]
  s_add_u32 m0, s36, 61440
  s_add_u32 s37, s87, 17408
  v_mfma_f32_16x16x32_bf16 v[68:71], v[180:183], v[40:43], v[68:71]
  buffer_load_dwordx4 v15, s[8:11], s37 offen nt lds
  s_waitcnt lgkmcnt(2)
  v_mfma_f32_16x16x32_bf16 v[72:75], v[184:187], v[44:47], v[72:75]
  ds_read_b128 v[40:43], v8 offset:16384
  v_mfma_f32_16x16x32_bf16 v[76:79], v[188:191], v[44:47], v[76:79]
  v_exp_f32 v36, v112
  v_mfma_f32_16x16x32_bf16 v[56:59], v[192:195], v[44:47], v[56:59]
  v_exp_f32 v37, v113
  v_mfma_f32_16x16x32_bf16 v[60:63], v[196:199], v[44:47], v[60:63]
  v_exp_f32 v38, v114
  v_mfma_f32_16x16x32_bf16 v[64:67], v[200:203], v[44:47], v[64:67]
  v_exp_f32 v39, v115
  v_mfma_f32_16x16x32_bf16 v[68:71], v[204:207], v[44:47], v[68:71]
  v_fma_f32 v36, v36, s54, s54
  s_waitcnt lgkmcnt(2)
  v_mfma_f32_16x16x32_bf16 v[72:75], v[208:211], v[48:51], v[72:75]
  ds_read_b128 v[44:47], v9 offset:16384
  v_fma_f32 v37, v37, s54, s54
  v_mfma_f32_16x16x32_bf16 v[76:79], v[212:215], v[48:51], v[76:79]
  v_fma_f32 v38, v38, s54, s54
  v_fma_f32 v39, v39, s54, s54
  v_mfma_f32_16x16x32_bf16 v[56:59], v[216:219], v[48:51], v[56:59]
  v_rcp_f32 v36, v36
  v_mfma_f32_16x16x32_bf16 v[60:63], v[220:223], v[48:51], v[60:63]
  v_rcp_f32 v37, v37
  v_mfma_f32_16x16x32_bf16 v[64:67], v[224:227], v[48:51], v[64:67]
  v_rcp_f32 v38, v38
  v_mfma_f32_16x16x32_bf16 v[68:71], v[228:231], v[48:51], v[68:71]
  s_waitcnt lgkmcnt(2)
  v_mfma_f32_16x16x32_bf16 v[72:75], v[232:235], v[52:55], v[72:75]
  ds_read_b128 v[48:51], v10 offset:16384
  v_mfma_f32_16x16x32_bf16 v[76:79], v[236:239], v[52:55], v[76:79]
  v_rcp_f32 v39, v39
  v_mfma_f32_16x16x32_bf16 v[56:59], v[240:243], v[52:55], v[56:59]
  v_mul_f32 v112, v112, v36
  v_mul_f32 v113, v113, v37
  v_mfma_f32_16x16x32_bf16 v[60:63], v[244:247], v[52:55], v[60:63]
  v_mul_f32 v114, v114, v38
  v_mul_f32 v115, v115, v39
  v_mfma_f32_16x16x32_bf16 v[64:67], v[248:251], v[52:55], v[64:67]
  v_fma_f32 v116, v116, v24, v32
  v_fma_f32 v117, v117, v25, v33
  v_mfma_f32_16x16x32_bf16 v[68:71], v[252:255], v[52:55], v[68:71]
  v_fma_f32 v118, v118, v26, v34
  s_waitcnt lgkmcnt(2)
  v_mfma_f32_16x16x32_bf16 v[80:83], a[0:3], v[40:43], 0
  ds_read_b128 v[52:55], v11 offset:16384
  s_add_u32 m0, s36, 65536
  v_mfma_f32_16x16x32_bf16 v[84:87], a[4:7], v[40:43], 0
  s_add_u32 s37, s84, 18432
  buffer_load_dwordx4 v15, s[8:11], s37 offen nt lds
  v_mfma_f32_16x16x32_bf16 v[72:75], a[8:11], v[40:43], v[72:75]
  v_fma_f32 v119, v119, v27, v35
  v_mfma_f32_16x16x32_bf16 v[76:79], a[12:15], v[40:43], v[76:79]
  v_exp_f32 v36, v116
  v_mfma_f32_16x16x32_bf16 v[56:59], a[16:19], v[40:43], v[56:59]
  v_exp_f32 v37, v117
  v_mfma_f32_16x16x32_bf16 v[60:63], a[20:23], v[40:43], v[60:63]
  s_waitcnt lgkmcnt(2)
  v_mfma_f32_16x16x32_bf16 v[80:83], a[24:27], v[44:47], v[80:83]
  ds_read_b128 v[40:43], v8 offset:20480
  v_mfma_f32_16x16x32_bf16 v[84:87], a[28:31], v[44:47], v[84:87]
  v_exp_f32 v38, v118
  v_mfma_f32_16x16x32_bf16 v[72:75], a[32:35], v[44:47], v[72:75]
  v_exp_f32 v39, v119
  v_mfma_f32_16x16x32_bf16 v[76:79], a[36:39], v[44:47], v[76:79]
  v_fma_f32 v36, v36, s54, s54
  v_fma_f32 v37, v37, s54, s54
  v_mfma_f32_16x16x32_bf16 v[56:59], a[40:43], v[44:47], v[56:59]
  v_fma_f32 v38, v38, s54, s54
  v_fma_f32 v39, v39, s54, s54
  v_mfma_f32_16x16x32_bf16 v[60:63], a[44:47], v[44:47], v[60:63]
  s_waitcnt lgkmcnt(2)
  v_mfma_f32_16x16x32_bf16 v[80:83], a[48:51], v[48:51], v[80:83]
  ds_read_b128 v[44:47], v9 offset:20480
  v_mfma_f32_16x16x32_bf16 v[84:87], a[52:55], v[48:51], v[84:87]
  v_rcp_f32 v36, v36
  v_mfma_f32_16x16x32_bf16 v[72:75], a[56:59], v[48:51], v[72:75]
  v_rcp_f32 v37, v37
  v_mfma_f32_16x16x32_bf16 v[76:79], a[60:63], v[48:51], v[76:79]
  v_rcp_f32 v38, v38
  v_mfma_f32_16x16x32_bf16 v[56:59], a[64:67], v[48:51], v[56:59]
  v_rcp_f32 v39, v39
  v_mfma_f32_16x16x32_bf16 v[60:63], a[68:71], v[48:51], v[60:63]
  v_mul_f32 v116, v116, v36
  s_waitcnt lgkmcnt(2)
  v_mfma_f32_16x16x32_bf16 v[80:83], a[72:75], v[52:55], v[80:83]
  ds_read_b128 v[48:51], v10 offset:20480
  v_mul_f32 v117, v117, v37
  v_mfma_f32_16x16x32_bf16 v[84:87], a[76:79], v[52:55], v[84:87]
  v_mul_f32 v118, v118, v38
  v_mul_f32 v119, v119, v39
  v_mfma_f32_16x16x32_bf16 v[72:75], a[80:83], v[52:55], v[72:75]
  v_cvt_pk_bf16_f32 v112, v112, v113
  v_cvt_pk_bf16_f32 v113, v114, v115
  v_mfma_f32_16x16x32_bf16 v[76:79], a[84:87], v[52:55], v[76:79]
  v_cvt_pk_bf16_f32 v114, v116, v117
  v_cvt_pk_bf16_f32 v115, v118, v119
  v_mfma_f32_16x16x32_bf16 v[56:59], a[88:91], v[52:55], v[56:59]
  s_mov_b32 s38, 7168
  buffer_store_dwordx4 v[112:115], v17, s[16:19], s38 offen sc1
  v_mfma_f32_16x16x32_bf16 v[60:63], a[92:95], v[52:55], v[60:63]
  v_mbcnt_lo_u32_b32 v12, -1, 0
  s_waitcnt lgkmcnt(2)
  v_mfma_f32_16x16x32_bf16 v[80:83], a[96:99], v[40:43], v[80:83]
  ds_read_b128 v[52:55], v11 offset:20480
  v_mbcnt_hi_u32_b32 v12, -1, v12
  v_mfma_f32_16x16x32_bf16 v[84:87], a[100:103], v[40:43], v[84:87]
  v_lshl_add_u32 v12, v12, 3, s52
  buffer_load_dword v13, v12, s[48:51], 0 offen
  v_mfma_f32_16x16x32_bf16 v[72:75], a[104:107], v[40:43], v[72:75]
  v_fma_f32 v120, v120, v20, v28
  v_fma_f32 v121, v121, v21, v29
  v_mfma_f32_16x16x32_bf16 v[76:79], a[108:111], v[40:43], v[76:79]
  v_fma_f32 v122, v122, v22, v30
  v_fma_f32 v123, v123, v23, v31
  v_mfma_f32_16x16x32_bf16 v[56:59], a[112:115], v[40:43], v[56:59]
  v_exp_f32 v36, v120
  v_mfma_f32_16x16x32_bf16 v[60:63], a[116:119], v[40:43], v[60:63]
  s_waitcnt lgkmcnt(2)
  v_mfma_f32_16x16x32_bf16 v[80:83], a[120:123], v[44:47], v[80:83]
  ds_read_b128 v[40:43], v8 offset:36864
  v_mfma_f32_16x16x32_bf16 v[84:87], a[124:127], v[44:47], v[84:87]
  v_exp_f32 v37, v121
  v_mfma_f32_16x16x32_bf16 v[72:75], a[128:131], v[44:47], v[72:75]
  v_exp_f32 v38, v122
  v_mfma_f32_16x16x32_bf16 v[76:79], a[132:135], v[44:47], v[76:79]
  v_exp_f32 v39, v123
  v_mfma_f32_16x16x32_bf16 v[56:59], a[136:139], v[44:47], v[56:59]
  v_fma_f32 v36, v36, s54, s54
  v_fma_f32 v37, v37, s54, s54
  v_mfma_f32_16x16x32_bf16 v[60:63], a[140:143], v[44:47], v[60:63]
  v_fma_f32 v38, v38, s54, s54
  s_waitcnt lgkmcnt(2)
  v_mfma_f32_16x16x32_bf16 v[80:83], a[144:147], v[48:51], v[80:83]
  ds_read_b128 v[44:47], v9 offset:36864
  v_fma_f32 v39, v39, s54, s54
  v_mfma_f32_16x16x32_bf16 v[84:87], a[148:151], v[48:51], v[84:87]
  v_rcp_f32 v36, v36
  v_mfma_f32_16x16x32_bf16 v[72:75], a[152:155], v[48:51], v[72:75]
  v_rcp_f32 v37, v37
  v_mfma_f32_16x16x32_bf16 v[76:79], a[156:159], v[48:51], v[76:79]
  v_rcp_f32 v38, v38
  v_mfma_f32_16x16x32_bf16 v[56:59], a[160:163], v[48:51], v[56:59]
  v_rcp_f32 v39, v39
  v_mfma_f32_16x16x32_bf16 v[60:63], a[164:167], v[48:51], v[60:63]
  v_mul_f32 v120, v120, v36
  s_waitcnt lgkmcnt(2)
  v_mfma_f32_16x16x32_bf16 v[80:83], a[168:171], v[52:55], v[80:83]
  ds_read_b128 v[48:51], v10 offset:36864
  v_mul_f32 v121, v121, v37
  v_mfma_f32_16x16x32_bf16 v[84:87], a[172:175], v[52:55], v[84:87]
  v_mul_f32 v122, v122, v38
  v_mul_f32 v123, v123, v39
  v_mfma_f32_16x16x32_bf16 v[72:75], a[176:179], v[52:55], v[72:75]
  v_fma_f32 v124, v124, v24, v32
  v_fma_f32 v125, v125, v25, v33
  v_mfma_f32_16x16x32_bf16 v[76:79], a[180:183], v[52:55], v[76:79]
  v_fma_f32 v126, v126, v26, v34
  v_fma_f32 v127, v127, v27, v35
  v_mfma_f32_16x16x32_bf16 v[56:59], a[184:187], v[52:55], v[56:59]
  v_exp_f32 v36, v124
  v_mfma_f32_16x16x32_bf16 v[60:63], a[188:191], v[52:55], v[60:63]
  s_waitcnt lgkmcnt(2)
  v_mfma_f32_16x16x32_bf16 v[80:83], a[192:195], v[40:43], v[80:83]
  ds_read_b128 v[52:55], v11 offset:36864
  v_mfma_f32_16x16x32_bf16 v[84:87], a[196:199], v[40:43], v[84:87]
  v_exp_f32 v37, v125
  v_mfma_f32_16x16x32_bf16 v[72:75], a[200:203], v[40:43], v[72:75]
  v_exp_f32 v38, v126
  v_mfma_f32_16x16x32_bf16 v[76:79], a[204:207], v[40:43], v[76:79]
  v_exp_f32 v39, v127
  v_mfma_f32_16x16x32_bf16 v[56:59], a[208:211], v[40:43], v[56:59]
  v_fma_f32 v36, v36, s54, s54
  v_fma_f32 v37, v37, s54, s54
  v_mfma_f32_16x16x32_bf16 v[60:63], a[212:215], v[40:43], v[60:63]
  v_fma_f32 v38, v38, s54, s54
  s_waitcnt lgkmcnt(2)
  v_mfma_f32_16x16x32_bf16 v[80:83], a[216:219], v[44:47], v[80:83]
  ds_read_b128 v[40:43], v8 offset:4096
  v_fma_f32 v39, v39, s54, s54
  v_mfma_f32_16x16x32_bf16 v[84:87], a[220:223], v[44:47], v[84:87]
  v_rcp_f32 v36, v36
  v_mfma_f32_16x16x32_bf16 v[72:75], a[224:227], v[44:47], v[72:75]
  v_rcp_f32 v37, v37
  v_mfma_f32_16x16x32_bf16 v[76:79], a[228:231], v[44:47], v[76:79]
  v_rcp_f32 v38, v38
  v_mfma_f32_16x16x32_bf16 v[56:59], a[232:235], v[44:47], v[56:59]
  v_rcp_f32 v39, v39
  v_mfma_f32_16x16x32_bf16 v[60:63], a[236:239], v[44:47], v[60:63]
  v_mul_f32 v124, v124, v36
  s_waitcnt lgkmcnt(2)
  v_mfma_f32_16x16x32_bf16 v[80:83], a[240:243], v[48:51], v[80:83]
  ds_read_b128 v[44:47], v9 offset:4096
  v_mul_f32 v125, v125, v37
  v_mfma_f32_16x16x32_bf16 v[84:87], a[244:247], v[48:51], v[84:87]
  v_mul_f32 v126, v126, v38
  v_mul_f32 v127, v127, v39
  v_mfma_f32_16x16x32_bf16 v[72:75], a[248:251], v[48:51], v[72:75]
  v_cvt_pk_bf16_f32 v120, v120, v121
  v_cvt_pk_bf16_f32 v121, v122, v123
  v_mfma_f32_16x16x32_bf16 v[76:79], a[252:255], v[48:51], v[76:79]
  v_cvt_pk_bf16_f32 v122, v124, v125
  v_cvt_pk_bf16_f32 v123, v126, v127
  v_mfma_f32_16x16x32_bf16 v[56:59], v[128:131], v[48:51], v[56:59]
  s_mov_b32 s38, 8192
  buffer_store_dwordx4 v[120:123], v17, s[16:19], s38 offen sc1
  v_mfma_f32_16x16x32_bf16 v[60:63], v[132:135], v[48:51], v[60:63]
  v_fma_f32 v64, v64, v20, v28
  s_waitcnt lgkmcnt(2)
  v_mfma_f32_16x16x32_bf16 v[80:83], v[136:139], v[52:55], v[80:83]
  ds_read_b128 v[48:51], v10 offset:4096
  v_fma_f32 v65, v65, v21, v29
  v_mfma_f32_16x16x32_bf16 v[84:87], v[140:143], v[52:55], v[84:87]
  v_fma_f32 v66, v66, v22, v30
  v_mfma_f32_16x16x32_bf16 v[72:75], v[144:147], v[52:55], v[72:75]
  v_fma_f32 v67, v67, v23, v31
  v_mfma_f32_16x16x32_bf16 v[76:79], v[148:151], v[52:55], v[76:79]
  v_exp_f32 v36, v64
  v_mfma_f32_16x16x32_bf16 v[56:59], v[152:155], v[52:55], v[56:59]
  v_exp_f32 v37, v65
  v_mfma_f32_16x16x32_bf16 v[60:63], v[156:159], v[52:55], v[60:63]
  s_waitcnt lgkmcnt(2)
  v_mfma_f32_16x16x32_bf16 v[80:83], v[160:163], v[40:43], v[80:83]
  ds_read_b128 v[52:55], v11 offset:4096
  v_mfma_f32_16x16x32_bf16 v[84:87], v[164:167], v[40:43], v[84:87]
  v_exp_f32 v38, v66
  v_mfma_f32_16x16x32_bf16 v[72:75], v[168:171], v[40:43], v[72:75]
  v_exp_f32 v39, v67
  v_mfma_f32_16x16x32_bf16 v[76:79], v[172:175], v[40:43], v[76:79]
  v_fma_f32 v36, v36, s54, s54
  v_mfma_f32_16x16x32_bf16 v[56:59], v[176:179], v[40:43], v[56:59]
  v_fma_f32 v37, v37, s54, s54
  v_mfma_f32_16x16x32_bf16 v[60:63], v[180:183], v[40:43], v[60:63]
  v_fma_f32 v38, v38, s54, s54
  s_waitcnt lgkmcnt(2)
  v_mfma_f32_16x16x32_bf16 v[80:83], v[184:187], v[44:47], v[80:83]
  ds_read_b128 v[40:43], v8 offset:8192
  v_mfma_f32_16x16x32_bf16 v[84:87], v[188:191], v[44:47], v[84:87]
  v_fma_f32 v39, v39, s54, s54
  v_mfma_f32_16x16x32_bf16 v[72:75], v[192:195], v[44:47], v[72:75]
  v_rcp_f32 v36, v36
  v_mfma_f32_16x16x32_bf16 v[76:79], v[196:199], v[44:47], v[76:79]
  v_rcp_f32 v37, v37
  v_mfma_f32_16x16x32_bf16 v[56:59], v[200:203], v[44:47], v[56:59]
  v_rcp_f32 v38, v38
  v_mfma_f32_16x16x32_bf16 v[60:63], v[204:207], v[44:47], v[60:63]
  s_waitcnt lgkmcnt(2)
  v_mfma_f32_16x16x32_bf16 v[80:83], v[208:211], v[48:51], v[80:83]
  ds_read_b128 v[44:47], v9 offset:8192
  v_mfma_f32_16x16x32_bf16 v[84:87], v[212:215], v[48:51], v[84:87]
  v_rcp_f32 v39, v39
  v_mfma_f32_16x16x32_bf16 v[72:75], v[216:219], v[48:51], v[72:75]
  v_mul_f32 v64, v64, v36
  v_mfma_f32_16x16x32_bf16 v[76:79], v[220:223], v[48:51], v[76:79]
  v_mul_f32 v65, v65, v37
  v_mfma_f32_16x16x32_bf16 v[56:59], v[224:227], v[48:51], v[56:59]
  v_mul_f32 v66, v66, v38
  v_mfma_f32_16x16x32_bf16 v[60:63], v[228:231], v[48:51], v[60:63]
  v_mul_f32 v67, v67, v39
  s_waitcnt lgkmcnt(2)
  v_mfma_f32_16x16x32_bf16 v[80:83], v[232:235], v[52:55], v[80:83]
  ds_read_b128 v[48:51], v10 offset:8192
  v_mfma_f32_16x16x32_bf16 v[84:87], v[236:239], v[52:55], v[84:87]
  v_fma_f32 v68, v68, v24, v32
  v_mfma_f32_16x16x32_bf16 v[72:75], v[240:243], v[52:55], v[72:75]
  v_fma_f32 v69, v69, v25, v33
  v_mfma_f32_16x16x32_bf16 v[76:79], v[244:247], v[52:55], v[76:79]
  v_fma_f32 v70, v70, v26, v34
  v_mfma_f32_16x16x32_bf16 v[56:59], v[248:251], v[52:55], v[56:59]
  v_fma_f32 v71, v71, v27, v35
  v_mfma_f32_16x16x32_bf16 v[60:63], v[252:255], v[52:55], v[60:63]
  s_waitcnt lgkmcnt(2)
  v_mfma_f32_16x16x32_bf16 v[88:91], a[0:3], v[40:43], 0
  ds_read_b128 v[52:55], v11 offset:8192
  v_mfma_f32_16x16x32_bf16 v[92:95], a[4:7], v[40:43], 0
  v_exp_f32 v36, v68
  v_mfma_f32_16x16x32_bf16 v[80:83], a[8:11], v[40:43], v[80:83]
  v_exp_f32 v37, v69
  v_mfma_f32_16x16x32_bf16 v[84:87], a[12:15], v[40:43], v[84:87]
  v_exp_f32 v38, v70
  v_mfma_f32_16x16x32_bf16 v[72:75], a[16:19], v[40:43], v[72:75]
  v_exp_f32 v39, v71
  v_mfma_f32_16x16x32_bf16 v[76:79], a[20:23], v[40:43], v[76:79]
  v_fma_f32 v36, v36, s54, s54
  s_waitcnt lgkmcnt(2)
  v_mfma_f32_16x16x32_bf16 v[88:91], a[24:27], v[44:47], v[88:91]
  ds_read_b128 v[40:43], v8 offset:12288
  v_fma_f32 v37, v37, s54, s54
  v_mfma_f32_16x16x32_bf16 v[92:95], a[28:31], v[44:47], v[92:95]
  v_fma_f32 v38, v38, s54, s54
  v_fma_f32 v39, v39, s54, s54
  v_mfma_f32_16x16x32_bf16 v[80:83], a[32:35], v[44:47], v[80:83]
  v_rcp_f32 v36, v36
  v_mfma_f32_16x16x32_bf16 v[84:87], a[36:39], v[44:47], v[84:87]
  v_rcp_f32 v37, v37
  v_mfma_f32_16x16x32_bf16 v[72:75], a[40:43], v[44:47], v[72:75]
  v_rcp_f32 v38, v38
  v_mfma_f32_16x16x32_bf16 v[76:79], a[44:47], v[44:47], v[76:79]
  s_waitcnt lgkmcnt(2)
  v_mfma_f32_16x16x32_bf16 v[88:91], a[48:51], v[48:51], v[88:91]
  ds_read_b128 v[44:47], v9 offset:12288
  v_mfma_f32_16x16x32_bf16 v[92:95], a[52:55], v[48:51], v[92:95]
  v_rcp_f32 v39, v39
  v_mfma_f32_16x16x32_bf16 v[80:83], a[56:59], v[48:51], v[80:83]
  v_mul_f32 v68, v68, v36
  v_mul_f32 v69, v69, v37
  v_mfma_f32_16x16x32_bf16 v[84:87], a[60:63], v[48:51], v[84:87]
  v_mul_f32 v70, v70, v38
  v_mul_f32 v71, v71, v39
  v_mfma_f32_16x16x32_bf16 v[72:75], a[64:67], v[48:51], v[72:75]
  v_cvt_pk_bf16_f32 v64, v64, v65
  v_cvt_pk_bf16_f32 v65, v66, v67
  v_mfma_f32_16x16x32_bf16 v[76:79], a[68:71], v[48:51], v[76:79]
  v_cvt_pk_bf16_f32 v66, v68, v69
  s_waitcnt lgkmcnt(2)
  v_mfma_f32_16x16x32_bf16 v[88:91], a[72:75], v[52:55], v[88:91]
  ds_read_b128 v[48:51], v10 offset:12288
  v_cvt_pk_bf16_f32 v67, v70, v71
  v_mfma_f32_16x16x32_bf16 v[92:95], a[76:79], v[52:55], v[92:95]
  s_mov_b32 s38, 9216
  buffer_store_dwordx4 v[64:67], v17, s[16:19], s38 offen sc1
  v_mfma_f32_16x16x32_bf16 v[80:83], a[80:83], v[52:55], v[80:83]
  v_fma_f32 v56, v56, v20, v28
  v_fma_f32 v57, v57, v21, v29
  v_mfma_f32_16x16x32_bf16 v[84:87], a[84:87], v[52:55], v[84:87]
  v_fma_f32 v58, v58, v22, v30
  v_mfma_f32_16x16x32_bf16 v[72:75], a[88:91], v[52:55], v[72:75]
  v_fma_f32 v59, v59, v23, v31
  v_mfma_f32_16x16x32_bf16 v[76:79], a[92:95], v[52:55], v[76:79]
  s_waitcnt lgkmcnt(2)
  v_mfma_f32_16x16x32_bf16 v[88:91], a[96:99], v[40:43], v[88:91]
  ds_read_b128 v[52:55], v11 offset:12288
  v_mfma_f32_16x16x32_bf16 v[92:95], a[100:103], v[40:43], v[92:95]
  v_exp_f32 v36, v56
  v_mfma_f32_16x16x32_bf16 v[80:83], a[104:107], v[40:43], v[80:83]
  v_exp_f32 v37, v57
  v_mfma_f32_16x16x32_bf16 v[84:87], a[108:111], v[40:43], v[84:87]
  v_exp_f32 v38, v58
  v_mfma_f32_16x16x32_bf16 v[72:75], a[112:115], v[40:43], v[72:75]
  v_exp_f32 v39, v59
  v_mfma_f32_16x16x32_bf16 v[76:79], a[116:119], v[40:43], v[76:79]
  v_fma_f32 v36, v36, s54, s54
  s_waitcnt lgkmcnt(2)
  v_mfma_f32_16x16x32_bf16 v[88:91], a[120:123], v[44:47], v[88:91]
  ds_read_b128 v[40:43], v8 offset:40960
  v_mfma_f32_16x16x32_bf16 v[92:95], a[124:127], v[44:47], v[92:95]
  v_fma_f32 v37, v37, s54, s54
  v_mfma_f32_16x16x32_bf16 v[80:83], a[128:131], v[44:47], v[80:83]
  v_fma_f32 v38, v38, s54, s54
  v_mfma_f32_16x16x32_bf16 v[84:87], a[132:135], v[44:47], v[84:87]
  v_fma_f32 v39, v39, s54, s54
  v_mfma_f32_16x16x32_bf16 v[72:75], a[136:139], v[44:47], v[72:75]
  v_rcp_f32 v36, v36
  v_mfma_f32_16x16x32_bf16 v[76:79], a[140:143], v[44:47], v[76:79]
  s_waitcnt lgkmcnt(2)
  v_mfma_f32_16x16x32_bf16 v[88:91], a[144:147], v[48:51], v[88:91]
  ds_read_b128 v[44:47], v9 offset:40960
  v_mfma_f32_16x16x32_bf16 v[92:95], a[148:151], v[48:51], v[92:95]
  v_rcp_f32 v37, v37
  v_mfma_f32_16x16x32_bf16 v[80:83], a[152:155], v[48:51], v[80:83]
  v_rcp_f32 v38, v38
  v_mfma_f32_16x16x32_bf16 v[84:87], a[156:159], v[48:51], v[84:87]
  v_rcp_f32 v39, v39
  v_mfma_f32_16x16x32_bf16 v[72:75], a[160:163], v[48:51], v[72:75]
  v_mul_f32 v56, v56, v36
  v_mfma_f32_16x16x32_bf16 v[76:79], a[164:167], v[48:51], v[76:79]
  v_mul_f32 v57, v57, v37
  s_waitcnt lgkmcnt(2)
  v_mfma_f32_16x16x32_bf16 v[88:91], a[168:171], v[52:55], v[88:91]
  ds_read_b128 v[48:51], v10 offset:40960
  v_mfma_f32_16x16x32_bf16 v[92:95], a[172:175], v[52:55], v[92:95]
  v_mul_f32 v58, v58, v38
  v_mfma_f32_16x16x32_bf16 v[80:83], a[176:179], v[52:55], v[80:83]
  v_mul_f32 v59, v59, v39
  v_mfma_f32_16x16x32_bf16 v[84:87], a[180:183], v[52:55], v[84:87]
  v_fma_f32 v60, v60, v24, v32
  v_mfma_f32_16x16x32_bf16 v[72:75], a[184:187], v[52:55], v[72:75]
  v_fma_f32 v61, v61, v25, v33
  v_mfma_f32_16x16x32_bf16 v[76:79], a[188:191], v[52:55], v[76:79]
  v_fma_f32 v62, v62, v26, v34
  s_waitcnt lgkmcnt(2)
  v_mfma_f32_16x16x32_bf16 v[88:91], a[192:195], v[40:43], v[88:91]
  ds_read_b128 v[52:55], v11 offset:40960
  v_mfma_f32_16x16x32_bf16 v[92:95], a[196:199], v[40:43], v[92:95]
  v_fma_f32 v63, v63, v27, v35
  v_mfma_f32_16x16x32_bf16 v[80:83], a[200:203], v[40:43], v[80:83]
  v_exp_f32 v36, v60
  v_mfma_f32_16x16x32_bf16 v[84:87], a[204:207], v[40:43], v[84:87]
  v_exp_f32 v37, v61
  v_mfma_f32_16x16x32_bf16 v[72:75], a[208:211], v[40:43], v[72:75]
  v_exp_f32 v38, v62
  v_mfma_f32_16x16x32_bf16 v[76:79], a[212:215], v[40:43], v[76:79]
  s_waitcnt lgkmcnt(2)
  v_mfma_f32_16x16x32_bf16 v[88:91], a[216:219], v[44:47], v[88:91]
  ds_read_b128 v[40:43], v8 offset:45056
  v_mfma_f32_16x16x32_bf16 v[92:95], a[220:223], v[44:47], v[92:95]
  v_exp_f32 v39, v63
  v_mfma_f32_16x16x32_bf16 v[80:83], a[224:227], v[44:47], v[80:83]
  v_fma_f32 v36, v36, s54, s54
  v_mfma_f32_16x16x32_bf16 v[84:87], a[228:231], v[44:47], v[84:87]
  v_fma_f32 v37, v37, s54, s54
  v_mfma_f32_16x16x32_bf16 v[72:75], a[232:235], v[44:47], v[72:75]
  v_fma_f32 v38, v38, s54, s54
  v_mfma_f32_16x16x32_bf16 v[76:79], a[236:239], v[44:47], v[76:79]
  v_fma_f32 v39, v39, s54, s54
  s_waitcnt lgkmcnt(2)
  v_mfma_f32_16x16x32_bf16 v[88:91], a[240:243], v[48:51], v[88:91]
  ds_read_b128 v[44:47], v9 offset:45056
  v_mfma_f32_16x16x32_bf16 v[92:95], a[244:247], v[48:51], v[92:95]
  v_rcp_f32 v36, v36
  v_mfma_f32_16x16x32_bf16 v[80:83], a[248:251], v[48:51], v[80:83]
  v_rcp_f32 v37, v37
  v_mfma_f32_16x16x32_bf16 v[84:87], a[252:255], v[48:51], v[84:87]
  v_rcp_f32 v38, v38
  v_mfma_f32_16x16x32_bf16 v[72:75], v[128:131], v[48:51], v[72:75]
  v_rcp_f32 v39, v39
  v_mfma_f32_16x16x32_bf16 v[76:79], v[132:135], v[48:51], v[76:79]
  v_mul_f32 v60, v60, v36
  s_waitcnt lgkmcnt(2)
  v_mfma_f32_16x16x32_bf16 v[88:91], v[136:139], v[52:55], v[88:91]
  ds_read_b128 v[48:51], v10 offset:45056
  v_mfma_f32_16x16x32_bf16 v[92:95], v[140:143], v[52:55], v[92:95]
  v_mul_f32 v61, v61, v37
  v_mfma_f32_16x16x32_bf16 v[80:83], v[144:147], v[52:55], v[80:83]
  v_mul_f32 v62, v62, v38
  v_mfma_f32_16x16x32_bf16 v[84:87], v[148:151], v[52:55], v[84:87]
  v_mul_f32 v63, v63, v39
  v_mfma_f32_16x16x32_bf16 v[72:75], v[152:155], v[52:55], v[72:75]
  v_cvt_pk_bf16_f32 v56, v56, v57
  v_mfma_f32_16x16x32_bf16 v[76:79], v[156:159], v[52:55], v[76:79]
  v_cvt_pk_bf16_f32 v57, v58, v59
  s_waitcnt lgkmcnt(2)
  v_mfma_f32_16x16x32_bf16 v[88:91], v[160:163], v[40:43], v[88:91]
  ds_read_b128 v[52:55], v11 offset:45056
  v_mfma_f32_16x16x32_bf16 v[92:95], v[164:167], v[40:43], v[92:95]
  v_cvt_pk_bf16_f32 v58, v60, v61
  v_mfma_f32_16x16x32_bf16 v[80:83], v[168:171], v[40:43], v[80:83]
  v_cvt_pk_bf16_f32 v59, v62, v63
  s_mov_b32 s38, 10240
  v_mfma_f32_16x16x32_bf16 v[84:87], v[172:175], v[40:43], v[84:87]
  buffer_store_dwordx4 v[56:59], v17, s[16:19], s38 offen sc1
  v_mfma_f32_16x16x32_bf16 v[72:75], v[176:179], v[40:43], v[72:75]
  v_mfma_f32_16x16x32_bf16 v[76:79], v[180:183], v[40:43], v[76:79]
  s_waitcnt lgkmcnt(2)
  v_mfma_f32_16x16x32_bf16 v[88:91], v[184:187], v[44:47], v[88:91]
  ds_read_b128 v[40:43], v8 offset:49152
  v_mfma_f32_16x16x32_bf16 v[92:95], v[188:191], v[44:47], v[92:95]
  v_mfma_f32_16x16x32_bf16 v[80:83], v[192:195], v[44:47], v[80:83]
  v_mfma_f32_16x16x32_bf16 v[84:87], v[196:199], v[44:47], v[84:87]
  v_mfma_f32_16x16x32_bf16 v[72:75], v[200:203], v[44:47], v[72:75]
  v_mfma_f32_16x16x32_bf16 v[76:79], v[204:207], v[44:47], v[76:79]
  s_waitcnt lgkmcnt(2)
  v_mfma_f32_16x16x32_bf16 v[88:91], v[208:211], v[48:51], v[88:91]
  ds_read_b128 v[44:47], v9 offset:49152
  v_mfma_f32_16x16x32_bf16 v[92:95], v[212:215], v[48:51], v[92:95]
  v_mfma_f32_16x16x32_bf16 v[80:83], v[216:219], v[48:51], v[80:83]
  v_mfma_f32_16x16x32_bf16 v[84:87], v[220:223], v[48:51], v[84:87]
  v_mfma_f32_16x16x32_bf16 v[72:75], v[224:227], v[48:51], v[72:75]
  v_mfma_f32_16x16x32_bf16 v[76:79], v[228:231], v[48:51], v[76:79]
  s_waitcnt lgkmcnt(2)
  v_mfma_f32_16x16x32_bf16 v[88:91], v[232:235], v[52:55], v[88:91]
  ds_read_b128 v[48:51], v10 offset:49152
  v_mfma_f32_16x16x32_bf16 v[92:95], v[236:239], v[52:55], v[92:95]
  v_mfma_f32_16x16x32_bf16 v[80:83], v[240:243], v[52:55], v[80:83]
  v_mfma_f32_16x16x32_bf16 v[84:87], v[244:247], v[52:55], v[84:87]
  v_mfma_f32_16x16x32_bf16 v[72:75], v[248:251], v[52:55], v[72:75]
  v_mfma_f32_16x16x32_bf16 v[76:79], v[252:255], v[52:55], v[76:79]
  s_waitcnt lgkmcnt(2)
  v_mfma_f32_16x16x32_bf16 v[96:99], a[0:3], v[40:43], 0
  ds_read_b128 v[52:55], v11 offset:49152
  v_mfma_f32_16x16x32_bf16 v[100:103], a[4:7], v[40:43], 0
  v_mfma_f32_16x16x32_bf16 v[88:91], a[8:11], v[40:43], v[88:91]
  v_mfma_f32_16x16x32_bf16 v[92:95], a[12:15], v[40:43], v[92:95]
  v_mfma_f32_16x16x32_bf16 v[80:83], a[16:19], v[40:43], v[80:83]
  v_mfma_f32_16x16x32_bf16 v[84:87], a[20:23], v[40:43], v[84:87]
  s_waitcnt lgkmcnt(2)
  v_mfma_f32_16x16x32_bf16 v[96:99], a[24:27], v[44:47], v[96:99]
  ds_read_b128 v[40:43], v4 offset:20480
  v_fma_f32 v72, v72, v20, v28
  v_mfma_f32_16x16x32_bf16 v[100:103], a[28:31], v[44:47], v[100:103]
  v_fma_f32 v73, v73, v21, v29
  v_mfma_f32_16x16x32_bf16 v[88:91], a[32:35], v[44:47], v[88:91]
  v_fma_f32 v74, v74, v22, v30
  v_mfma_f32_16x16x32_bf16 v[92:95], a[36:39], v[44:47], v[92:95]
  v_fma_f32 v75, v75, v23, v31
  v_mfma_f32_16x16x32_bf16 v[80:83], a[40:43], v[44:47], v[80:83]
  v_exp_f32 v36, v72
  v_mfma_f32_16x16x32_bf16 v[84:87], a[44:47], v[44:47], v[84:87]
  s_waitcnt lgkmcnt(2)
  v_mfma_f32_16x16x32_bf16 v[96:99], a[48:51], v[48:51], v[96:99]
  ds_read_b128 v[44:47], v5 offset:20480
  v_mfma_f32_16x16x32_bf16 v[100:103], a[52:55], v[48:51], v[100:103]
  v_exp_f32 v37, v73
  v_mfma_f32_16x16x32_bf16 v[88:91], a[56:59], v[48:51], v[88:91]
  v_exp_f32 v38, v74
  v_mfma_f32_16x16x32_bf16 v[92:95], a[60:63], v[48:51], v[92:95]
  v_exp_f32 v39, v75
  v_mfma_f32_16x16x32_bf16 v[80:83], a[64:67], v[48:51], v[80:83]
  v_fma_f32 v36, v36, s54, s54
  v_mfma_f32_16x16x32_bf16 v[84:87], a[68:71], v[48:51], v[84:87]
  v_fma_f32 v37, v37, s54, s54
  s_waitcnt lgkmcnt(2)
  v_mfma_f32_16x16x32_bf16 v[96:99], a[72:75], v[52:55], v[96:99]
  ds_read_b128 v[48:51], v6 offset:20480
  v_mfma_f32_16x16x32_bf16 v[100:103], a[76:79], v[52:55], v[100:103]
  v_fma_f32 v38, v38, s54, s54
  v_mfma_f32_16x16x32_bf16 v[88:91], a[80:83], v[52:55], v[88:91]
  v_fma_f32 v39, v39, s54, s54
  v_mfma_f32_16x16x32_bf16 v[92:95], a[84:87], v[52:55], v[92:95]
  v_rcp_f32 v36, v36
  v_mfma_f32_16x16x32_bf16 v[80:83], a[88:91], v[52:55], v[80:83]
  v_rcp_f32 v37, v37
  v_mfma_f32_16x16x32_bf16 v[84:87], a[92:95], v[52:55], v[84:87]
  s_waitcnt lgkmcnt(2)
  v_mfma_f32_16x16x32_bf16 v[96:99], a[96:99], v[40:43], v[96:99]
  ds_read_b128 v[52:55], v7 offset:20480
  v_mfma_f32_16x16x32_bf16 v[100:103], a[100:103], v[40:43], v[100:103]
  v_rcp_f32 v38, v38
  v_mfma_f32_16x16x32_bf16 v[88:91], a[104:107], v[40:43], v[88:91]
  v_rcp_f32 v39, v39
  v_mfma_f32_16x16x32_bf16 v[92:95], a[108:111], v[40:43], v[92:95]
  v_mul_f32 v72, v72, v36
  v_mfma_f32_16x16x32_bf16 v[80:83], a[112:115], v[40:43], v[80:83]
  v_mul_f32 v73, v73, v37
  v_mfma_f32_16x16x32_bf16 v[84:87], a[116:119], v[40:43], v[84:87]
  v_mul_f32 v74, v74, v38
  s_waitcnt lgkmcnt(2)
  v_mfma_f32_16x16x32_bf16 v[96:99], a[120:123], v[44:47], v[96:99]
  ds_read_b128 v[40:43], v4 offset:12288
  v_mfma_f32_16x16x32_bf16 v[100:103], a[124:127], v[44:47], v[100:103]
  v_mul_f32 v75, v75, v39
  v_mfma_f32_16x16x32_bf16 v[88:91], a[128:131], v[44:47], v[88:91]
  v_fma_f32 v76, v76, v24, v32
  v_mfma_f32_16x16x32_bf16 v[92:95], a[132:135], v[44:47], v[92:95]
  v_fma_f32 v77, v77, v25, v33
  v_mfma_f32_16x16x32_bf16 v[80:83], a[136:139], v[44:47], v[80:83]
  v_fma_f32 v78, v78, v26, v34
  v_mfma_f32_16x16x32_bf16 v[84:87], a[140:143], v[44:47], v[84:87]
  v_fma_f32 v79, v79, v27, v35
  s_waitcnt vmcnt(14)
  s_barrier
  s_waitcnt lgkmcnt(2)
  v_mfma_f32_16x16x32_bf16 v[96:99], a[144:147], v[48:51], v[96:99]
  ds_read_b128 v[44:47], v5 offset:12288
  s_add_u32 m0, s36, 16384
  v_mfma_f32_16x16x32_bf16 v[100:103], a[148:151], v[48:51], v[100:103]
  s_add_u32 s37, s85, 18432
  buffer_load_dwordx4 v15, s[8:11], s37 offen nt lds
  v_mfma_f32_16x16x32_bf16 v[88:91], a[152:155], v[48:51], v[88:91]
  v_exp_f32 v36, v76
  v_mfma_f32_16x16x32_bf16 v[92:95], a[156:159], v[48:51], v[92:95]
  v_exp_f32 v37, v77
  v_mfma_f32_16x16x32_bf16 v[80:83], a[160:163], v[48:51], v[80:83]
  v_exp_f32 v38, v78
  v_mfma_f32_16x16x32_bf16 v[84:87], a[164:167], v[48:51], v[84:87]
  s_waitcnt lgkmcnt(2)
  v_mfma_f32_16x16x32_bf16 v[96:99], a[168:171], v[52:55], v[96:99]
  ds_read_b128 v[48:51], v6 offset:12288
  v_mfma_f32_16x16x32_bf16 v[100:103], a[172:175], v[52:55], v[100:103]
  v_exp_f32 v39, v79
  v_mfma_f32_16x16x32_bf16 v[88:91], a[176:179], v[52:55], v[88:91]
  v_fma_f32 v36, v36, s54, s54
  v_mfma_f32_16x16x32_bf16 v[92:95], a[180:183], v[52:55], v[92:95]
  v_fma_f32 v37, v37, s54, s54
  v_mfma_f32_16x16x32_bf16 v[80:83], a[184:187], v[52:55], v[80:83]
  v_fma_f32 v38, v38, s54, s54
  v_mfma_f32_16x16x32_bf16 v[84:87], a[188:191], v[52:55], v[84:87]
  v_fma_f32 v39, v39, s54, s54
  s_waitcnt lgkmcnt(2)
  v_mfma_f32_16x16x32_bf16 v[96:99], a[192:195], v[40:43], v[96:99]
  ds_read_b128 v[52:55], v7 offset:12288
  v_mfma_f32_16x16x32_bf16 v[100:103], a[196:199], v[40:43], v[100:103]
  v_rcp_f32 v36, v36
  v_mfma_f32_16x16x32_bf16 v[88:91], a[200:203], v[40:43], v[88:91]
  v_rcp_f32 v37, v37
  v_mfma_f32_16x16x32_bf16 v[92:95], a[204:207], v[40:43], v[92:95]
  v_rcp_f32 v38, v38
  v_mfma_f32_16x16x32_bf16 v[80:83], a[208:211], v[40:43], v[80:83]
  v_rcp_f32 v39, v39
  v_mfma_f32_16x16x32_bf16 v[84:87], a[212:215], v[40:43], v[84:87]
  v_mul_f32 v76, v76, v36
  s_waitcnt lgkmcnt(2)
  v_mfma_f32_16x16x32_bf16 v[96:99], a[216:219], v[44:47], v[96:99]
  ds_read_b128 v[40:43], v4 offset:49152
  v_mfma_f32_16x16x32_bf16 v[100:103], a[220:223], v[44:47], v[100:103]
  v_mul_f32 v77, v77, v37
  v_mfma_f32_16x16x32_bf16 v[88:91], a[224:227], v[44:47], v[88:91]
  s_add_u32 m0, s36, 98304
  s_add_u32 s37, s86, 18432
  v_mfma_f32_16x16x32_bf16 v[92:95], a[228:231], v[44:47], v[92:95]
  buffer_load_dwordx4 v15, s[8:11], s37 offen nt lds
  v_mfma_f32_16x16x32_bf16 v[80:83], a[232:235], v[44:47], v[80:83]
  v_mul_f32 v78, v78, v38
  v_mfma_f32_16x16x32_bf16 v[84:87], a[236:239], v[44:47], v[84:87]
  v_mul_f32 v79, v79, v39
  s_waitcnt lgkmcnt(2)
  v_mfma_f32_16x16x32_bf16 v[96:99], a[240:243], v[48:51], v[96:99]
  ds_read_b128 v[44:47], v5 offset:49152
  v_mfma_f32_16x16x32_bf16 v[100:103], a[244:247], v[48:51], v[100:103]
  v_cvt_pk_bf16_f32 v72, v72, v73
  v_mfma_f32_16x16x32_bf16 v[88:91], a[248:251], v[48:51], v[88:91]
  v_cvt_pk_bf16_f32 v73, v74, v75
  v_mfma_f32_16x16x32_bf16 v[92:95], a[252:255], v[48:51], v[92:95]
  v_cvt_pk_bf16_f32 v74, v76, v77
  v_mfma_f32_16x16x32_bf16 v[80:83], v[128:131], v[48:51], v[80:83]
  v_cvt_pk_bf16_f32 v75, v78, v79
  s_mov_b32 s38, 11264
  v_mfma_f32_16x16x32_bf16 v[84:87], v[132:135], v[48:51], v[84:87]
  buffer_store_dwordx4 v[72:75], v17, s[16:19], s38 offen sc1
  s_waitcnt lgkmcnt(2)
  v_mfma_f32_16x16x32_bf16 v[96:99], v[136:139], v[52:55], v[96:99]
  ds_read_b128 v[48:51], v6 offset:49152
  v_mfma_f32_16x16x32_bf16 v[100:103], v[140:143], v[52:55], v[100:103]
  v_mfma_f32_16x16x32_bf16 v[88:91], v[144:147], v[52:55], v[88:91]
  v_mfma_f32_16x16x32_bf16 v[92:95], v[148:151], v[52:55], v[92:95]
  v_mfma_f32_16x16x32_bf16 v[80:83], v[152:155], v[52:55], v[80:83]
  v_mfma_f32_16x16x32_bf16 v[84:87], v[156:159], v[52:55], v[84:87]
  s_waitcnt lgkmcnt(2)
  v_mfma_f32_16x16x32_bf16 v[96:99], v[160:163], v[40:43], v[96:99]
  ds_read_b128 v[52:55], v7 offset:49152
  v_mfma_f32_16x16x32_bf16 v[100:103], v[164:167], v[40:43], v[100:103]
  v_mfma_f32_16x16x32_bf16 v[88:91], v[168:171], v[40:43], v[88:91]
  v_mfma_f32_16x16x32_bf16 v[92:95], v[172:175], v[40:43], v[92:95]
  v_mfma_f32_16x16x32_bf16 v[80:83], v[176:179], v[40:43], v[80:83]
  s_add_u32 m0, s36, 45056
  s_add_u32 s37, s87, 18432
  v_mfma_f32_16x16x32_bf16 v[84:87], v[180:183], v[40:43], v[84:87]
  buffer_load_dwordx4 v15, s[8:11], s37 offen nt lds
  s_waitcnt lgkmcnt(2)
  v_mfma_f32_16x16x32_bf16 v[96:99], v[184:187], v[44:47], v[96:99]
  ds_read_b128 v[40:43], v4 offset:24576
  v_mfma_f32_16x16x32_bf16 v[100:103], v[188:191], v[44:47], v[100:103]
  v_mfma_f32_16x16x32_bf16 v[88:91], v[192:195], v[44:47], v[88:91]
  v_mfma_f32_16x16x32_bf16 v[92:95], v[196:199], v[44:47], v[92:95]
  v_mfma_f32_16x16x32_bf16 v[80:83], v[200:203], v[44:47], v[80:83]
  v_mfma_f32_16x16x32_bf16 v[84:87], v[204:207], v[44:47], v[84:87]
  s_waitcnt lgkmcnt(2)
  v_mfma_f32_16x16x32_bf16 v[96:99], v[208:211], v[48:51], v[96:99]
  ds_read_b128 v[44:47], v5 offset:24576
  v_mfma_f32_16x16x32_bf16 v[100:103], v[212:215], v[48:51], v[100:103]
  v_mfma_f32_16x16x32_bf16 v[88:91], v[216:219], v[48:51], v[88:91]
  v_mfma_f32_16x16x32_bf16 v[92:95], v[220:223], v[48:51], v[92:95]
  v_mfma_f32_16x16x32_bf16 v[80:83], v[224:227], v[48:51], v[80:83]
  v_mfma_f32_16x16x32_bf16 v[84:87], v[228:231], v[48:51], v[84:87]
  s_waitcnt lgkmcnt(2)
  v_mfma_f32_16x16x32_bf16 v[96:99], v[232:235], v[52:55], v[96:99]
  ds_read_b128 v[48:51], v6 offset:24576
  v_mfma_f32_16x16x32_bf16 v[100:103], v[236:239], v[52:55], v[100:103]
  v_mfma_f32_16x16x32_bf16 v[88:91], v[240:243], v[52:55], v[88:91]
  v_mfma_f32_16x16x32_bf16 v[92:95], v[244:247], v[52:55], v[92:95]
  v_mfma_f32_16x16x32_bf16 v[80:83], v[248:251], v[52:55], v[80:83]
  v_mfma_f32_16x16x32_bf16 v[84:87], v[252:255], v[52:55], v[84:87]
  s_waitcnt lgkmcnt(2)
  v_mfma_f32_16x16x32_bf16 v[104:107], a[0:3], v[40:43], 0
  ds_read_b128 v[52:55], v7 offset:24576
  s_add_u32 m0, s36, 81920
  v_mfma_f32_16x16x32_bf16 v[108:111], a[4:7], v[40:43], 0
  s_add_u32 s37, s84, 19456
  buffer_load_dwordx4 v15, s[8:11], s37 offen nt lds
  v_mfma_f32_16x16x32_bf16 v[96:99], a[8:11], v[40:43], v[96:99]
  v_mfma_f32_16x16x32_bf16 v[100:103], a[12:15], v[40:43], v[100:103]
  v_mfma_f32_16x16x32_bf16 v[88:91], a[16:19], v[40:43], v[88:91]
  v_fma_f32 v80, v80, v20, v28
  v_fma_f32 v81, v81, v21, v29
  v_mfma_f32_16x16x32_bf16 v[92:95], a[20:23], v[40:43], v[92:95]
  v_fma_f32 v82, v82, v22, v30
  s_waitcnt lgkmcnt(2)
  v_mfma_f32_16x16x32_bf16 v[104:107], a[24:27], v[44:47], v[104:107]
  ds_read_b128 v[40:43], v4 offset:28672
  v_mfma_f32_16x16x32_bf16 v[108:111], a[28:31], v[44:47], v[108:111]
  v_fma_f32 v83, v83, v23, v31
  v_mfma_f32_16x16x32_bf16 v[96:99], a[32:35], v[44:47], v[96:99]
  v_exp_f32 v36, v80
  v_mfma_f32_16x16x32_bf16 v[100:103], a[36:39], v[44:47], v[100:103]
  v_exp_f32 v37, v81
  v_mfma_f32_16x16x32_bf16 v[88:91], a[40:43], v[44:47], v[88:91]
  v_exp_f32 v38, v82
  v_mfma_f32_16x16x32_bf16 v[92:95], a[44:47], v[44:47], v[92:95]
  s_waitcnt lgkmcnt(2)
  v_mfma_f32_16x16x32_bf16 v[104:107], a[48:51], v[48:51], v[104:107]
  ds_read_b128 v[44:47], v5 offset:28672
  v_mfma_f32_16x16x32_bf16 v[108:111], a[52:55], v[48:51], v[108:111]
  v_exp_f32 v39, v83
  v_mfma_f32_16x16x32_bf16 v[96:99], a[56:59], v[48:51], v[96:99]
  v_fma_f32 v36, v36, s54, s54
  v_mfma_f32_16x16x32_bf16 v[100:103], a[60:63], v[48:51], v[100:103]
  v_fma_f32 v37, v37, s54, s54
  v_mfma_f32_16x16x32_bf16 v[88:91], a[64:67], v[48:51], v[88:91]
  v_fma_f32 v38, v38, s54, s54
  v_mfma_f32_16x16x32_bf16 v[92:95], a[68:71], v[48:51], v[92:95]
  v_fma_f32 v39, v39, s54, s54
  s_waitcnt lgkmcnt(2)
  v_mfma_f32_16x16x32_bf16 v[104:107], a[72:75], v[52:55], v[104:107]
  ds_read_b128 v[48:51], v6 offset:28672
  v_mfma_f32_16x16x32_bf16 v[108:111], a[76:79], v[52:55], v[108:111]
  v_rcp_f32 v36, v36
  v_mfma_f32_16x16x32_bf16 v[96:99], a[80:83], v[52:55], v[96:99]
  s_add_u32 m0, s36, 86016
  s_add_u32 s37, s85, 19456
  v_mfma_f32_16x16x32_bf16 v[100:103], a[84:87], v[52:55], v[100:103]
  buffer_load_dwordx4 v15, s[8:11], s37 offen nt lds
  v_mfma_f32_16x16x32_bf16 v[88:91], a[88:91], v[52:55], v[88:91]
  v_rcp_f32 v37, v37
  v_mfma_f32_16x16x32_bf16 v[92:95], a[92:95], v[52:55], v[92:95]
  s_waitcnt lgkmcnt(2)
  v_mfma_f32_16x16x32_bf16 v[104:107], a[96:99], v[40:43], v[104:107]
  ds_read_b128 v[52:55], v7 offset:28672
  v_mfma_f32_16x16x32_bf16 v[108:111], a[100:103], v[40:43], v[108:111]
  v_rcp_f32 v38, v38
  v_mfma_f32_16x16x32_bf16 v[96:99], a[104:107], v[40:43], v[96:99]
  v_rcp_f32 v39, v39
  v_mfma_f32_16x16x32_bf16 v[100:103], a[108:111], v[40:43], v[100:103]
  v_mul_f32 v80, v80, v36
  v_mfma_f32_16x16x32_bf16 v[88:91], a[112:115], v[40:43], v[88:91]
  v_mul_f32 v81, v81, v37
  v_mfma_f32_16x16x32_bf16 v[92:95], a[116:119], v[40:43], v[92:95]
  v_mul_f32 v82, v82, v38
  s_waitcnt lgkmcnt(2)
  v_mfma_f32_16x16x32_bf16 v[104:107], a[120:123], v[44:47], v[104:107]
  ds_read_b128 v[40:43], v8 offset:53248
  v_mfma_f32_16x16x32_bf16 v[108:111], a[124:127], v[44:47], v[108:111]
  v_mul_f32 v83, v83, v39
  v_mfma_f32_16x16x32_bf16 v[96:99], a[128:131], v[44:47], v[96:99]
  v_fma_f32 v84, v84, v24, v32
  v_mfma_f32_16x16x32_bf16 v[100:103], a[132:135], v[44:47], v[100:103]
  v_fma_f32 v85, v85, v25, v33
  v_mfma_f32_16x16x32_bf16 v[88:91], a[136:139], v[44:47], v[88:91]
  v_fma_f32 v86, v86, v26, v34
  v_mfma_f32_16x16x32_bf16 v[92:95], a[140:143], v[44:47], v[92:95]
  v_fma_f32 v87, v87, v27, v35
  s_waitcnt lgkmcnt(2)
  v_mfma_f32_16x16x32_bf16 v[104:107], a[144:147], v[48:51], v[104:107]
  ds_read_b128 v[44:47], v9 offset:53248
  v_mfma_f32_16x16x32_bf16 v[108:111], a[148:151], v[48:51], v[108:111]
  v_exp_f32 v36, v84
  v_mfma_f32_16x16x32_bf16 v[96:99], a[152:155], v[48:51], v[96:99]
  v_exp_f32 v37, v85
  v_mfma_f32_16x16x32_bf16 v[100:103], a[156:159], v[48:51], v[100:103]
  v_exp_f32 v38, v86
  v_mfma_f32_16x16x32_bf16 v[88:91], a[160:163], v[48:51], v[88:91]
  s_add_u32 m0, s36, 102400
  s_add_u32 s37, s86, 19456
  v_mfma_f32_16x16x32_bf16 v[92:95], a[164:167], v[48:51], v[92:95]
  buffer_load_dwordx4 v15, s[8:11], s37 offen nt lds
  s_waitcnt lgkmcnt(2)
  v_mfma_f32_16x16x32_bf16 v[104:107], a[168:171], v[52:55], v[104:107]
  ds_read_b128 v[48:51], v10 offset:53248
  v_mfma_f32_16x16x32_bf16 v[108:111], a[172:175], v[52:55], v[108:111]
  v_exp_f32 v39, v87
  v_mfma_f32_16x16x32_bf16 v[96:99], a[176:179], v[52:55], v[96:99]
  v_fma_f32 v36, v36, s54, s54
  v_mfma_f32_16x16x32_bf16 v[100:103], a[180:183], v[52:55], v[100:103]
  v_fma_f32 v37, v37, s54, s54
  v_mfma_f32_16x16x32_bf16 v[88:91], a[184:187], v[52:55], v[88:91]
  v_fma_f32 v38, v38, s54, s54
  v_mfma_f32_16x16x32_bf16 v[92:95], a[188:191], v[52:55], v[92:95]
  v_fma_f32 v39, v39, s54, s54
  s_waitcnt lgkmcnt(2)
  v_mfma_f32_16x16x32_bf16 v[104:107], a[192:195], v[40:43], v[104:107]
  ds_read_b128 v[52:55], v11 offset:53248
  v_mfma_f32_16x16x32_bf16 v[108:111], a[196:199], v[40:43], v[108:111]
  v_rcp_f32 v36, v36
  v_mfma_f32_16x16x32_bf16 v[96:99], a[200:203], v[40:43], v[96:99]
  v_rcp_f32 v37, v37
  v_mfma_f32_16x16x32_bf16 v[100:103], a[204:207], v[40:43], v[100:103]
  v_rcp_f32 v38, v38
  v_mfma_f32_16x16x32_bf16 v[88:91], a[208:211], v[40:43], v[88:91]
  v_rcp_f32 v39, v39
  v_mfma_f32_16x16x32_bf16 v[92:95], a[212:215], v[40:43], v[92:95]
  v_mul_f32 v84, v84, v36
  s_waitcnt lgkmcnt(2)
  v_mfma_f32_16x16x32_bf16 v[104:107], a[216:219], v[44:47], v[104:107]
  ds_read_b128 v[40:43], v8 offset:24576
  v_mfma_f32_16x16x32_bf16 v[108:111], a[220:223], v[44:47], v[108:111]
  v_mul_f32 v85, v85, v37
  v_mfma_f32_16x16x32_bf16 v[96:99], a[224:227], v[44:47], v[96:99]
  v_mul_f32 v86, v86, v38
  v_mfma_f32_16x16x32_bf16 v[100:103], a[228:231], v[44:47], v[100:103]
  v_mul_f32 v87, v87, v39
  v_mfma_f32_16x16x32_bf16 v[88:91], a[232:235], v[44:47], v[88:91]
  v_cvt_pk_bf16_f32 v80, v80, v81
  v_mfma_f32_16x16x32_bf16 v[92:95], a[236:239], v[44:47], v[92:95]
  v_cvt_pk_bf16_f32 v81, v82, v83
  s_waitcnt lgkmcnt(2)
  v_mfma_f32_16x16x32_bf16 v[104:107], a[240:243], v[48:51], v[104:107]
  ds_read_b128 v[44:47], v9 offset:24576
  s_add_u32 m0, s36, 69632
  v_mfma_f32_16x16x32_bf16 v[108:111], a[244:247], v[48:51], v[108:111]
  s_add_u32 s37, s87, 19456
  buffer_load_dwordx4 v15, s[8:11], s37 offen nt lds
  v_mfma_f32_16x16x32_bf16 v[96:99], a[248:251], v[48:51], v[96:99]
  v_cvt_pk_bf16_f32 v82, v84, v85
  v_mfma_f32_16x16x32_bf16 v[100:103], a[252:255], v[48:51], v[100:103]
  v_cvt_pk_bf16_f32 v83, v86, v87
  s_mov_b32 s38, 12288
  v_mfma_f32_16x16x32_bf16 v[88:91], v[128:131], v[48:51], v[88:91]
  buffer_store_dwordx4 v[80:83], v17, s[16:19], s38 offen sc1
  v_mfma_f32_16x16x32_bf16 v[92:95], v[132:135], v[48:51], v[92:95]
  v_mbcnt_lo_u32_b32 v12, -1, 0
  s_waitcnt lgkmcnt(2)
  v_mfma_f32_16x16x32_bf16 v[104:107], v[136:139], v[52:55], v[104:107]
  ds_read_b128 v[48:51], v10 offset:24576
  v_mfma_f32_16x16x32_bf16 v[108:111], v[140:143], v[52:55], v[108:111]
  v_mbcnt_hi_u32_b32 v12, -1, v12
  v_mfma_f32_16x16x32_bf16 v[96:99], v[144:147], v[52:55], v[96:99]
  v_lshl_add_u32 v12, v12, 3, s52
  v_mfma_f32_16x16x32_bf16 v[100:103], v[148:151], v[52:55], v[100:103]
  buffer_load_dword v13, v12, s[48:51], 0 offen
  v_mfma_f32_16x16x32_bf16 v[88:91], v[152:155], v[52:55], v[88:91]
  v_mfma_f32_16x16x32_bf16 v[92:95], v[156:159], v[52:55], v[92:95]
  s_waitcnt lgkmcnt(2)
  v_mfma_f32_16x16x32_bf16 v[104:107], v[160:163], v[40:43], v[104:107]
  ds_read_b128 v[52:55], v11 offset:24576
  v_mfma_f32_16x16x32_bf16 v[108:111], v[164:167], v[40:43], v[108:111]
  v_mfma_f32_16x16x32_bf16 v[96:99], v[168:171], v[40:43], v[96:99]
  v_mfma_f32_16x16x32_bf16 v[100:103], v[172:175], v[40:43], v[100:103]
  v_mfma_f32_16x16x32_bf16 v[88:91], v[176:179], v[40:43], v[88:91]
  v_mfma_f32_16x16x32_bf16 v[92:95], v[180:183], v[40:43], v[92:95]
  s_waitcnt lgkmcnt(2)
  v_mfma_f32_16x16x32_bf16 v[104:107], v[184:187], v[44:47], v[104:107]
  ds_read_b128 v[40:43], v8 offset:28672
  v_mfma_f32_16x16x32_bf16 v[108:111], v[188:191], v[44:47], v[108:111]
  v_mfma_f32_16x16x32_bf16 v[96:99], v[192:195], v[44:47], v[96:99]
  s_add_u32 m0, s36, 73728
  s_add_u32 s37, s84, 20480
  v_mfma_f32_16x16x32_bf16 v[100:103], v[196:199], v[44:47], v[100:103]
  buffer_load_dwordx4 v15, s[8:11], s37 offen nt lds
  v_mfma_f32_16x16x32_bf16 v[88:91], v[200:203], v[44:47], v[88:91]
  v_mfma_f32_16x16x32_bf16 v[92:95], v[204:207], v[44:47], v[92:95]
  s_waitcnt lgkmcnt(2)
  v_mfma_f32_16x16x32_bf16 v[104:107], v[208:211], v[48:51], v[104:107]
  ds_read_b128 v[44:47], v9 offset:28672
  v_mfma_f32_16x16x32_bf16 v[108:111], v[212:215], v[48:51], v[108:111]
  v_mfma_f32_16x16x32_bf16 v[96:99], v[216:219], v[48:51], v[96:99]
  v_mfma_f32_16x16x32_bf16 v[100:103], v[220:223], v[48:51], v[100:103]
  v_mfma_f32_16x16x32_bf16 v[88:91], v[224:227], v[48:51], v[88:91]
  v_mfma_f32_16x16x32_bf16 v[92:95], v[228:231], v[48:51], v[92:95]
  s_waitcnt lgkmcnt(2)
  v_mfma_f32_16x16x32_bf16 v[104:107], v[232:235], v[52:55], v[104:107]
  ds_read_b128 v[48:51], v10 offset:28672
  v_mfma_f32_16x16x32_bf16 v[108:111], v[236:239], v[52:55], v[108:111]
  v_mfma_f32_16x16x32_bf16 v[96:99], v[240:243], v[52:55], v[96:99]
  v_mfma_f32_16x16x32_bf16 v[100:103], v[244:247], v[52:55], v[100:103]
  v_mfma_f32_16x16x32_bf16 v[88:91], v[248:251], v[52:55], v[88:91]
  v_mfma_f32_16x16x32_bf16 v[92:95], v[252:255], v[52:55], v[92:95]
  s_waitcnt lgkmcnt(2)
  v_mfma_f32_16x16x32_bf16 v[112:115], a[0:3], v[40:43], 0
  ds_read_b128 v[52:55], v11 offset:28672
  v_mfma_f32_16x16x32_bf16 v[116:119], a[4:7], v[40:43], 0
  v_mfma_f32_16x16x32_bf16 v[104:107], a[8:11], v[40:43], v[104:107]
  v_mfma_f32_16x16x32_bf16 v[108:111], a[12:15], v[40:43], v[108:111]
  v_mfma_f32_16x16x32_bf16 v[96:99], a[16:19], v[40:43], v[96:99]
  s_add_u32 m0, s36, 77824
  s_add_u32 s37, s85, 20480
  v_mfma_f32_16x16x32_bf16 v[100:103], a[20:23], v[40:43], v[100:103]
  buffer_load_dwordx4 v15, s[8:11], s37 offen nt lds
  s_waitcnt lgkmcnt(2)
  v_mfma_f32_16x16x32_bf16 v[112:115], a[24:27], v[44:47], v[112:115]
  ds_read_b128 v[40:43], v4 offset:0
  v_fma_f32 v88, v88, v20, v28
  v_mfma_f32_16x16x32_bf16 v[116:119], a[28:31], v[44:47], v[116:119]
  v_fma_f32 v89, v89, v21, v29
  v_mfma_f32_16x16x32_bf16 v[104:107], a[32:35], v[44:47], v[104:107]
  v_fma_f32 v90, v90, v22, v30
  v_mfma_f32_16x16x32_bf16 v[108:111], a[36:39], v[44:47], v[108:111]
  v_fma_f32 v91, v91, v23, v31
  v_mfma_f32_16x16x32_bf16 v[96:99], a[40:43], v[44:47], v[96:99]
  v_exp_f32 v36, v88
  v_mfma_f32_16x16x32_bf16 v[100:103], a[44:47], v[44:47], v[100:103]
  s_waitcnt lgkmcnt(2)
  v_mfma_f32_16x16x32_bf16 v[112:115], a[48:51], v[48:51], v[112:115]
  ds_read_b128 v[44:47], v5 offset:0
  v_mfma_f32_16x16x32_bf16 v[116:119], a[52:55], v[48:51], v[116:119]
  v_exp_f32 v37, v89
  v_mfma_f32_16x16x32_bf16 v[104:107], a[56:59], v[48:51], v[104:107]
  v_exp_f32 v38, v90
  v_mfma_f32_16x16x32_bf16 v[108:111], a[60:63], v[48:51], v[108:111]
  v_exp_f32 v39, v91
  v_mfma_f32_16x16x32_bf16 v[96:99], a[64:67], v[48:51], v[96:99]
  v_fma_f32 v36, v36, s54, s54
  v_mfma_f32_16x16x32_bf16 v[100:103], a[68:71], v[48:51], v[100:103]
  v_fma_f32 v37, v37, s54, s54
  s_waitcnt lgkmcnt(2)
  v_mfma_f32_16x16x32_bf16 v[112:115], a[72:75], v[52:55], v[112:115]
  ds_read_b128 v[48:51], v6 offset:0
  v_mfma_f32_16x16x32_bf16 v[116:119], a[76:79], v[52:55], v[116:119]
  v_fma_f32 v38, v38, s54, s54
  v_mfma_f32_16x16x32_bf16 v[104:107], a[80:83], v[52:55], v[104:107]
  v_fma_f32 v39, v39, s54, s54
  v_mfma_f32_16x16x32_bf16 v[108:111], a[84:87], v[52:55], v[108:111]
  v_rcp_f32 v36, v36
  v_mfma_f32_16x16x32_bf16 v[96:99], a[88:91], v[52:55], v[96:99]
  v_rcp_f32 v37, v37
  v_mfma_f32_16x16x32_bf16 v[100:103], a[92:95], v[52:55], v[100:103]
  s_waitcnt lgkmcnt(2)
  v_mfma_f32_16x16x32_bf16 v[112:115], a[96:99], v[40:43], v[112:115]
  ds_read_b128 v[52:55], v7 offset:0
  s_add_u32 m0, s36, 106496
  v_mfma_f32_16x16x32_bf16 v[116:119], a[100:103], v[40:43], v[116:119]
  s_add_u32 s37, s86, 20480
  buffer_load_dwordx4 v15, s[8:11], s37 offen nt lds
  v_mfma_f32_16x16x32_bf16 v[104:107], a[104:107], v[40:43], v[104:107]
  v_rcp_f32 v38, v38
  v_mfma_f32_16x16x32_bf16 v[108:111], a[108:111], v[40:43], v[108:111]
  v_rcp_f32 v39, v39
  v_mfma_f32_16x16x32_bf16 v[96:99], a[112:115], v[40:43], v[96:99]
  v_mul_f32 v88, v88, v36
  v_mfma_f32_16x16x32_bf16 v[100:103], a[116:119], v[40:43], v[100:103]
  v_mul_f32 v89, v89, v37
  s_waitcnt lgkmcnt(2)
  v_mfma_f32_16x16x32_bf16 v[112:115], a[120:123], v[44:47], v[112:115]
  ds_read_b128 v[40:43], v4 offset:4096
  v_mfma_f32_16x16x32_bf16 v[116:119], a[124:127], v[44:47], v[116:119]
  v_mul_f32 v90, v90, v38
  v_mfma_f32_16x16x32_bf16 v[104:107], a[128:131], v[44:47], v[104:107]
  v_mul_f32 v91, v91, v39
  v_mfma_f32_16x16x32_bf16 v[108:111], a[132:135], v[44:47], v[108:111]
  v_fma_f32 v92, v92, v24, v32
  v_mfma_f32_16x16x32_bf16 v[96:99], a[136:139], v[44:47], v[96:99]
  v_fma_f32 v93, v93, v25, v33
  v_mfma_f32_16x16x32_bf16 v[100:103], a[140:143], v[44:47], v[100:103]
  v_fma_f32 v94, v94, v26, v34
  s_waitcnt lgkmcnt(2)
  v_mfma_f32_16x16x32_bf16 v[112:115], a[144:147], v[48:51], v[112:115]
  ds_read_b128 v[44:47], v5 offset:4096
  v_mfma_f32_16x16x32_bf16 v[116:119], a[148:151], v[48:51], v[116:119]
  v_fma_f32 v95, v95, v27, v35
  v_mfma_f32_16x16x32_bf16 v[104:107], a[152:155], v[48:51], v[104:107]
  v_exp_f32 v36, v92
  v_mfma_f32_16x16x32_bf16 v[108:111], a[156:159], v[48:51], v[108:111]
  v_exp_f32 v37, v93
  v_mfma_f32_16x16x32_bf16 v[96:99], a[160:163], v[48:51], v[96:99]
  v_exp_f32 v38, v94
  v_mfma_f32_16x16x32_bf16 v[100:103], a[164:167], v[48:51], v[100:103]
  s_waitcnt lgkmcnt(2)
  v_mfma_f32_16x16x32_bf16 v[112:115], a[168:171], v[52:55], v[112:115]
  ds_read_b128 v[48:51], v6 offset:4096
  v_mfma_f32_16x16x32_bf16 v[116:119], a[172:175], v[52:55], v[116:119]
  v_exp_f32 v39, v95
  v_mfma_f32_16x16x32_bf16 v[104:107], a[176:179], v[52:55], v[104:107]
  s_add_u32 m0, s36, 110592
  s_add_u32 s37, s87, 20480
  v_mfma_f32_16x16x32_bf16 v[108:111], a[180:183], v[52:55], v[108:111]
  buffer_load_dwordx4 v15, s[8:11], s37 offen nt lds
  v_mfma_f32_16x16x32_bf16 v[96:99], a[184:187], v[52:55], v[96:99]
  v_fma_f32 v36, v36, s54, s54
  v_mfma_f32_16x16x32_bf16 v[100:103], a[188:191], v[52:55], v[100:103]
  v_fma_f32 v37, v37, s54, s54
  s_waitcnt lgkmcnt(2)
  v_mfma_f32_16x16x32_bf16 v[112:115], a[192:195], v[40:43], v[112:115]
  ds_read_b128 v[52:55], v7 offset:4096
  v_mfma_f32_16x16x32_bf16 v[116:119], a[196:199], v[40:43], v[116:119]
  v_fma_f32 v38, v38, s54, s54
  v_mfma_f32_16x16x32_bf16 v[104:107], a[200:203], v[40:43], v[104:107]
  v_fma_f32 v39, v39, s54, s54
  v_mfma_f32_16x16x32_bf16 v[108:111], a[204:207], v[40:43], v[108:111]
  v_rcp_f32 v36, v36
  v_mfma_f32_16x16x32_bf16 v[96:99], a[208:211], v[40:43], v[96:99]
  v_rcp_f32 v37, v37
  v_mfma_f32_16x16x32_bf16 v[100:103], a[212:215], v[40:43], v[100:103]
  s_waitcnt lgkmcnt(2)
  v_mfma_f32_16x16x32_bf16 v[112:115], a[216:219], v[44:47], v[112:115]
  ds_read_b128 v[40:43], v4 offset:8192
  v_mfma_f32_16x16x32_bf16 v[116:119], a[220:223], v[44:47], v[116:119]
  v_rcp_f32 v38, v38
  v_mfma_f32_16x16x32_bf16 v[104:107], a[224:227], v[44:47], v[104:107]
  v_rcp_f32 v39, v39
  v_mfma_f32_16x16x32_bf16 v[108:111], a[228:231], v[44:47], v[108:111]
  v_mul_f32 v92, v92, v36
  v_mfma_f32_16x16x32_bf16 v[96:99], a[232:235], v[44:47], v[96:99]
  v_mul_f32 v93, v93, v37
  v_mfma_f32_16x16x32_bf16 v[100:103], a[236:239], v[44:47], v[100:103]
  v_mul_f32 v94, v94, v38
  s_waitcnt lgkmcnt(2)
  v_mfma_f32_16x16x32_bf16 v[112:115], a[240:243], v[48:51], v[112:115]
  ds_read_b128 v[44:47], v5 offset:8192
  v_mfma_f32_16x16x32_bf16 v[116:119], a[244:247], v[48:51], v[116:119]
  v_mul_f32 v95, v95, v39
  v_mfma_f32_16x16x32_bf16 v[104:107], a[248:251], v[48:51], v[104:107]
  v_cvt_pk_bf16_f32 v88, v88, v89
  v_mfma_f32_16x16x32_bf16 v[108:111], a[252:255], v[48:51], v[108:111]
  v_cvt_pk_bf16_f32 v89, v90, v91
  v_mfma_f32_16x16x32_bf16 v[96:99], v[128:131], v[48:51], v[96:99]
  s_add_u32 m0, s36, 114688
  s_add_u32 s37, s84, 21504
  v_mfma_f32_16x16x32_bf16 v[100:103], v[132:135], v[48:51], v[100:103]
  buffer_load_dwordx4 v15, s[8:11], s37 offen nt lds
  s_waitcnt lgkmcnt(2)
  v_mfma_f32_16x16x32_bf16 v[112:115], v[136:139], v[52:55], v[112:115]
  ds_read_b128 v[48:51], v6 offset:8192
  v_mfma_f32_16x16x32_bf16 v[116:119], v[140:143], v[52:55], v[116:119]
  v_cvt_pk_bf16_f32 v90, v92, v93
  v_mfma_f32_16x16x32_bf16 v[104:107], v[144:147], v[52:55], v[104:107]
  v_cvt_pk_bf16_f32 v91, v94, v95
  s_mov_b32 s38, 13312
  v_mfma_f32_16x16x32_bf16 v[108:111], v[148:151], v[52:55], v[108:111]
  buffer_store_dwordx4 v[88:91], v17, s[16:19], s38 offen sc1
  v_mfma_f32_16x16x32_bf16 v[96:99], v[152:155], v[52:55], v[96:99]
  v_mfma_f32_16x16x32_bf16 v[100:103], v[156:159], v[52:55], v[100:103]
  s_waitcnt lgkmcnt(2)
  v_mfma_f32_16x16x32_bf16 v[112:115], v[160:163], v[40:43], v[112:115]
  ds_read_b128 v[52:55], v7 offset:8192
  v_mfma_f32_16x16x32_bf16 v[116:119], v[164:167], v[40:43], v[116:119]
  v_mfma_f32_16x16x32_bf16 v[104:107], v[168:171], v[40:43], v[104:107]
  v_mfma_f32_16x16x32_bf16 v[108:111], v[172:175], v[40:43], v[108:111]
  v_mfma_f32_16x16x32_bf16 v[96:99], v[176:179], v[40:43], v[96:99]
  v_mfma_f32_16x16x32_bf16 v[100:103], v[180:183], v[40:43], v[100:103]
  s_waitcnt lgkmcnt(2)
  v_mfma_f32_16x16x32_bf16 v[112:115], v[184:187], v[44:47], v[112:115]
  ds_read_b128 v[40:43], v4 offset:53248
  v_mfma_f32_16x16x32_bf16 v[116:119], v[188:191], v[44:47], v[116:119]
  v_mfma_f32_16x16x32_bf16 v[104:107], v[192:195], v[44:47], v[104:107]
  v_mfma_f32_16x16x32_bf16 v[108:111], v[196:199], v[44:47], v[108:111]
  v_mfma_f32_16x16x32_bf16 v[96:99], v[200:203], v[44:47], v[96:99]
  v_mfma_f32_16x16x32_bf16 v[100:103], v[204:207], v[44:47], v[100:103]
  s_waitcnt lgkmcnt(2)
  v_mfma_f32_16x16x32_bf16 v[112:115], v[208:211], v[48:51], v[112:115]
  ds_read_b128 v[44:47], v5 offset:53248
  v_mfma_f32_16x16x32_bf16 v[116:119], v[212:215], v[48:51], v[116:119]
  v_mfma_f32_16x16x32_bf16 v[104:107], v[216:219], v[48:51], v[104:107]
  v_mfma_f32_16x16x32_bf16 v[108:111], v[220:223], v[48:51], v[108:111]
  v_mfma_f32_16x16x32_bf16 v[96:99], v[224:227], v[48:51], v[96:99]
  v_mfma_f32_16x16x32_bf16 v[100:103], v[228:231], v[48:51], v[100:103]
  s_waitcnt lgkmcnt(2)
  v_mfma_f32_16x16x32_bf16 v[112:115], v[232:235], v[52:55], v[112:115]
  ds_read_b128 v[48:51], v6 offset:53248
  v_mfma_f32_16x16x32_bf16 v[116:119], v[236:239], v[52:55], v[116:119]
  v_mfma_f32_16x16x32_bf16 v[104:107], v[240:243], v[52:55], v[104:107]
  v_mfma_f32_16x16x32_bf16 v[108:111], v[244:247], v[52:55], v[108:111]
  v_mfma_f32_16x16x32_bf16 v[96:99], v[248:251], v[52:55], v[96:99]
  v_mfma_f32_16x16x32_bf16 v[100:103], v[252:255], v[52:55], v[100:103]
  s_waitcnt lgkmcnt(2)
  v_mfma_f32_16x16x32_bf16 v[120:123], a[0:3], v[40:43], 0
  ds_read_b128 v[52:55], v7 offset:53248
  v_mfma_f32_16x16x32_bf16 v[124:127], a[4:7], v[40:43], 0
  v_mfma_f32_16x16x32_bf16 v[112:115], a[8:11], v[40:43], v[112:115]
  v_mfma_f32_16x16x32_bf16 v[116:119], a[12:15], v[40:43], v[116:119]
  v_mfma_f32_16x16x32_bf16 v[104:107], a[16:19], v[40:43], v[104:107]
  v_mfma_f32_16x16x32_bf16 v[108:111], a[20:23], v[40:43], v[108:111]
  s_waitcnt lgkmcnt(2)
  v_mfma_f32_16x16x32_bf16 v[120:123], a[24:27], v[44:47], v[120:123]
  ds_read_b128 v[40:43], v4 offset:57344
  v_fma_f32 v96, v96, v20, v28
  v_mfma_f32_16x16x32_bf16 v[124:127], a[28:31], v[44:47], v[124:127]
  v_fma_f32 v97, v97, v21, v29
  v_mfma_f32_16x16x32_bf16 v[112:115], a[32:35], v[44:47], v[112:115]
  v_fma_f32 v98, v98, v22, v30
  v_mfma_f32_16x16x32_bf16 v[116:119], a[36:39], v[44:47], v[116:119]
  v_fma_f32 v99, v99, v23, v31
  v_mfma_f32_16x16x32_bf16 v[104:107], a[40:43], v[44:47], v[104:107]
  v_exp_f32 v36, v96
  v_mfma_f32_16x16x32_bf16 v[108:111], a[44:47], v[44:47], v[108:111]
  s_waitcnt lgkmcnt(2)
  v_mfma_f32_16x16x32_bf16 v[120:123], a[48:51], v[48:51], v[120:123]
  ds_read_b128 v[44:47], v5 offset:57344
  v_mfma_f32_16x16x32_bf16 v[124:127], a[52:55], v[48:51], v[124:127]
  v_exp_f32 v37, v97
  v_mfma_f32_16x16x32_bf16 v[112:115], a[56:59], v[48:51], v[112:115]
  v_exp_f32 v38, v98
  v_mfma_f32_16x16x32_bf16 v[116:119], a[60:63], v[48:51], v[116:119]
  v_exp_f32 v39, v99
  v_mfma_f32_16x16x32_bf16 v[104:107], a[64:67], v[48:51], v[104:107]
  v_fma_f32 v36, v36, s54, s54
  v_mfma_f32_16x16x32_bf16 v[108:111], a[68:71], v[48:51], v[108:111]
  v_fma_f32 v37, v37, s54, s54
  s_waitcnt lgkmcnt(2)
  v_mfma_f32_16x16x32_bf16 v[120:123], a[72:75], v[52:55], v[120:123]
  ds_read_b128 v[48:51], v6 offset:57344
  v_mfma_f32_16x16x32_bf16 v[124:127], a[76:79], v[52:55], v[124:127]
  v_fma_f32 v38, v38, s54, s54
  v_mfma_f32_16x16x32_bf16 v[112:115], a[80:83], v[52:55], v[112:115]
  v_fma_f32 v39, v39, s54, s54
  v_mfma_f32_16x16x32_bf16 v[116:119], a[84:87], v[52:55], v[116:119]
  v_rcp_f32 v36, v36
  v_mfma_f32_16x16x32_bf16 v[104:107], a[88:91], v[52:55], v[104:107]
  v_rcp_f32 v37, v37
  v_mfma_f32_16x16x32_bf16 v[108:111], a[92:95], v[52:55], v[108:111]
  s_waitcnt lgkmcnt(2)
  v_mfma_f32_16x16x32_bf16 v[120:123], a[96:99], v[40:43], v[120:123]
  ds_read_b128 v[52:55], v7 offset:57344
  v_mfma_f32_16x16x32_bf16 v[124:127], a[100:103], v[40:43], v[124:127]
  v_rcp_f32 v38, v38
  v_mfma_f32_16x16x32_bf16 v[112:115], a[104:107], v[40:43], v[112:115]
  v_rcp_f32 v39, v39
  v_mfma_f32_16x16x32_bf16 v[116:119], a[108:111], v[40:43], v[116:119]
  v_mul_f32 v96, v96, v36
  v_mfma_f32_16x16x32_bf16 v[104:107], a[112:115], v[40:43], v[104:107]
  v_mul_f32 v97, v97, v37
  v_mfma_f32_16x16x32_bf16 v[108:111], a[116:119], v[40:43], v[108:111]
  v_mul_f32 v98, v98, v38
  s_waitcnt lgkmcnt(2)
  v_mfma_f32_16x16x32_bf16 v[120:123], a[120:123], v[44:47], v[120:123]
  ds_read_b128 v[40:43], v8 offset:57344
  v_mfma_f32_16x16x32_bf16 v[124:127], a[124:127], v[44:47], v[124:127]
  v_mul_f32 v99, v99, v39
  v_mfma_f32_16x16x32_bf16 v[112:115], a[128:131], v[44:47], v[112:115]
  v_fma_f32 v100, v100, v24, v32
  v_mfma_f32_16x16x32_bf16 v[116:119], a[132:135], v[44:47], v[116:119]
  v_fma_f32 v101, v101, v25, v33
  v_mfma_f32_16x16x32_bf16 v[104:107], a[136:139], v[44:47], v[104:107]
  v_fma_f32 v102, v102, v26, v34
  v_mfma_f32_16x16x32_bf16 v[108:111], a[140:143], v[44:47], v[108:111]
  v_fma_f32 v103, v103, v27, v35
  s_waitcnt vmcnt(9)
  s_barrier
  s_waitcnt lgkmcnt(2)
  v_mfma_f32_16x16x32_bf16 v[120:123], a[144:147], v[48:51], v[120:123]
  ds_read_b128 v[44:47], v9 offset:57344
  s_add_u32 m0, s36, 20480
  v_mfma_f32_16x16x32_bf16 v[124:127], a[148:151], v[48:51], v[124:127]
  s_add_u32 s37, s85, 21504
  buffer_load_dwordx4 v15, s[8:11], s37 offen nt lds
  v_mfma_f32_16x16x32_bf16 v[112:115], a[152:155], v[48:51], v[112:115]
  v_exp_f32 v36, v100
  v_mfma_f32_16x16x32_bf16 v[116:119], a[156:159], v[48:51], v[116:119]
  v_exp_f32 v37, v101
  v_mfma_f32_16x16x32_bf16 v[104:107], a[160:163], v[48:51], v[104:107]
  v_exp_f32 v38, v102
  v_mfma_f32_16x16x32_bf16 v[108:111], a[164:167], v[48:51], v[108:111]
  s_waitcnt lgkmcnt(2)
  v_mfma_f32_16x16x32_bf16 v[120:123], a[168:171], v[52:55], v[120:123]
  ds_read_b128 v[48:51], v10 offset:57344
  v_mfma_f32_16x16x32_bf16 v[124:127], a[172:175], v[52:55], v[124:127]
  v_exp_f32 v39, v103
  v_mfma_f32_16x16x32_bf16 v[112:115], a[176:179], v[52:55], v[112:115]
  v_fma_f32 v36, v36, s54, s54
  v_mfma_f32_16x16x32_bf16 v[116:119], a[180:183], v[52:55], v[116:119]
  v_fma_f32 v37, v37, s54, s54
  v_mfma_f32_16x16x32_bf16 v[104:107], a[184:187], v[52:55], v[104:107]
  v_fma_f32 v38, v38, s54, s54
  v_mfma_f32_16x16x32_bf16 v[108:111], a[188:191], v[52:55], v[108:111]
  v_fma_f32 v39, v39, s54, s54
  s_waitcnt lgkmcnt(2)
  v_mfma_f32_16x16x32_bf16 v[120:123], a[192:195], v[40:43], v[120:123]
  ds_read_b128 v[52:55], v11 offset:57344
  v_mfma_f32_16x16x32_bf16 v[124:127], a[196:199], v[40:43], v[124:127]
  v_rcp_f32 v36, v36
  v_mfma_f32_16x16x32_bf16 v[112:115], a[200:203], v[40:43], v[112:115]
  v_rcp_f32 v37, v37
  v_mfma_f32_16x16x32_bf16 v[116:119], a[204:207], v[40:43], v[116:119]
  v_rcp_f32 v38, v38
  v_mfma_f32_16x16x32_bf16 v[104:107], a[208:211], v[40:43], v[104:107]
  v_rcp_f32 v39, v39
  v_mfma_f32_16x16x32_bf16 v[108:111], a[212:215], v[40:43], v[108:111]
  v_mul_f32 v100, v100, v36
  s_waitcnt lgkmcnt(2)
  v_mfma_f32_16x16x32_bf16 v[120:123], a[216:219], v[44:47], v[120:123]
  ds_read_b128 v[40:43], v8 offset:61440
  v_mfma_f32_16x16x32_bf16 v[124:127], a[220:223], v[44:47], v[124:127]
  v_mul_f32 v101, v101, v37
  v_mfma_f32_16x16x32_bf16 v[112:115], a[224:227], v[44:47], v[112:115]
  s_add_u32 m0, s36, 12288
  s_add_u32 s37, s86, 21504
  v_mfma_f32_16x16x32_bf16 v[116:119], a[228:231], v[44:47], v[116:119]
  buffer_load_dwordx4 v15, s[8:11], s37 offen nt lds
  v_mfma_f32_16x16x32_bf16 v[104:107], a[232:235], v[44:47], v[104:107]
  v_mul_f32 v102, v102, v38
  v_mfma_f32_16x16x32_bf16 v[108:111], a[236:239], v[44:47], v[108:111]
  v_mul_f32 v103, v103, v39
  s_waitcnt lgkmcnt(2)
  v_mfma_f32_16x16x32_bf16 v[120:123], a[240:243], v[48:51], v[120:123]
  ds_read_b128 v[44:47], v9 offset:61440
  v_mfma_f32_16x16x32_bf16 v[124:127], a[244:247], v[48:51], v[124:127]
  v_cvt_pk_bf16_f32 v96, v96, v97
  v_mfma_f32_16x16x32_bf16 v[112:115], a[248:251], v[48:51], v[112:115]
  v_cvt_pk_bf16_f32 v97, v98, v99
  v_mfma_f32_16x16x32_bf16 v[116:119], a[252:255], v[48:51], v[116:119]
  v_cvt_pk_bf16_f32 v98, v100, v101
  v_mfma_f32_16x16x32_bf16 v[104:107], v[128:131], v[48:51], v[104:107]
  v_cvt_pk_bf16_f32 v99, v102, v103
  s_mov_b32 s38, 14336
  v_mfma_f32_16x16x32_bf16 v[108:111], v[132:135], v[48:51], v[108:111]
  buffer_store_dwordx4 v[96:99], v17, s[16:19], s38 offen sc1
  s_waitcnt lgkmcnt(2)
  v_mfma_f32_16x16x32_bf16 v[120:123], v[136:139], v[52:55], v[120:123]
  ds_read_b128 v[48:51], v10 offset:61440
  v_mfma_f32_16x16x32_bf16 v[124:127], v[140:143], v[52:55], v[124:127]
  v_mfma_f32_16x16x32_bf16 v[112:115], v[144:147], v[52:55], v[112:115]
  v_mfma_f32_16x16x32_bf16 v[116:119], v[148:151], v[52:55], v[116:119]
  v_mfma_f32_16x16x32_bf16 v[104:107], v[152:155], v[52:55], v[104:107]
  v_mfma_f32_16x16x32_bf16 v[108:111], v[156:159], v[52:55], v[108:111]
  s_waitcnt lgkmcnt(2)
  v_mfma_f32_16x16x32_bf16 v[120:123], v[160:163], v[40:43], v[120:123]
  ds_read_b128 v[52:55], v11 offset:61440
  v_mfma_f32_16x16x32_bf16 v[124:127], v[164:167], v[40:43], v[124:127]
  v_mfma_f32_16x16x32_bf16 v[112:115], v[168:171], v[40:43], v[112:115]
  v_mfma_f32_16x16x32_bf16 v[116:119], v[172:175], v[40:43], v[116:119]
  v_mfma_f32_16x16x32_bf16 v[104:107], v[176:179], v[40:43], v[104:107]
  s_add_u32 m0, s36, 49152
  s_add_u32 s37, s87, 21504
  v_mfma_f32_16x16x32_bf16 v[108:111], v[180:183], v[40:43], v[108:111]
  buffer_load_dwordx4 v15, s[8:11], s37 offen nt lds
  s_waitcnt lgkmcnt(2)
  v_mfma_f32_16x16x32_bf16 v[120:123], v[184:187], v[44:47], v[120:123]
  ds_read_b128 v[40:43], v4 offset:32768
  v_mfma_f32_16x16x32_bf16 v[124:127], v[188:191], v[44:47], v[124:127]
  v_mfma_f32_16x16x32_bf16 v[112:115], v[192:195], v[44:47], v[112:115]
  v_mfma_f32_16x16x32_bf16 v[116:119], v[196:199], v[44:47], v[116:119]
  v_mfma_f32_16x16x32_bf16 v[104:107], v[200:203], v[44:47], v[104:107]
  v_mfma_f32_16x16x32_bf16 v[108:111], v[204:207], v[44:47], v[108:111]
  s_waitcnt lgkmcnt(2)
  v_mfma_f32_16x16x32_bf16 v[120:123], v[208:211], v[48:51], v[120:123]
  ds_read_b128 v[44:47], v5 offset:32768
  v_mfma_f32_16x16x32_bf16 v[124:127], v[212:215], v[48:51], v[124:127]
  v_mfma_f32_16x16x32_bf16 v[112:115], v[216:219], v[48:51], v[112:115]
  v_mfma_f32_16x16x32_bf16 v[116:119], v[220:223], v[48:51], v[116:119]
  v_mfma_f32_16x16x32_bf16 v[104:107], v[224:227], v[48:51], v[104:107]
  v_mfma_f32_16x16x32_bf16 v[108:111], v[228:231], v[48:51], v[108:111]
  s_waitcnt lgkmcnt(2)
  v_mfma_f32_16x16x32_bf16 v[120:123], v[232:235], v[52:55], v[120:123]
  ds_read_b128 v[48:51], v6 offset:32768
  v_mfma_f32_16x16x32_bf16 v[124:127], v[236:239], v[52:55], v[124:127]
  v_mfma_f32_16x16x32_bf16 v[112:115], v[240:243], v[52:55], v[112:115]
  v_mfma_f32_16x16x32_bf16 v[116:119], v[244:247], v[52:55], v[116:119]
  v_mfma_f32_16x16x32_bf16 v[104:107], v[248:251], v[52:55], v[104:107]
  v_mfma_f32_16x16x32_bf16 v[108:111], v[252:255], v[52:55], v[108:111]
  s_waitcnt lgkmcnt(2)
  v_mfma_f32_16x16x32_bf16 v[64:67], a[0:3], v[40:43], 0
  ds_read_b128 v[52:55], v7 offset:32768
  s_add_u32 m0, s36, 24576
  v_mfma_f32_16x16x32_bf16 v[68:71], a[4:7], v[40:43], 0
  s_add_u32 s37, s84, 22528
  buffer_load_dwordx4 v15, s[8:11], s37 offen nt lds
  v_mfma_f32_16x16x32_bf16 v[120:123], a[8:11], v[40:43], v[120:123]
  v_mfma_f32_16x16x32_bf16 v[124:127], a[12:15], v[40:43], v[124:127]
  v_mfma_f32_16x16x32_bf16 v[112:115], a[16:19], v[40:43], v[112:115]
  v_fma_f32 v104, v104, v20, v28
  v_fma_f32 v105, v105, v21, v29
  v_mfma_f32_16x16x32_bf16 v[116:119], a[20:23], v[40:43], v[116:119]
  v_fma_f32 v106, v106, v22, v30
  s_waitcnt lgkmcnt(2)
  v_mfma_f32_16x16x32_bf16 v[64:67], a[24:27], v[44:47], v[64:67]
  ds_read_b128 v[40:43], v4 offset:36864
  v_mfma_f32_16x16x32_bf16 v[68:71], a[28:31], v[44:47], v[68:71]
  v_fma_f32 v107, v107, v23, v31
  v_mfma_f32_16x16x32_bf16 v[120:123], a[32:35], v[44:47], v[120:123]
  v_exp_f32 v36, v104
  v_mfma_f32_16x16x32_bf16 v[124:127], a[36:39], v[44:47], v[124:127]
  v_exp_f32 v37, v105
  v_mfma_f32_16x16x32_bf16 v[112:115], a[40:43], v[44:47], v[112:115]
  v_exp_f32 v38, v106
  v_mfma_f32_16x16x32_bf16 v[116:119], a[44:47], v[44:47], v[116:119]
  s_waitcnt lgkmcnt(2)
  v_mfma_f32_16x16x32_bf16 v[64:67], a[48:51], v[48:51], v[64:67]
  ds_read_b128 v[44:47], v5 offset:36864
  v_mfma_f32_16x16x32_bf16 v[68:71], a[52:55], v[48:51], v[68:71]
  v_exp_f32 v39, v107
  v_mfma_f32_16x16x32_bf16 v[120:123], a[56:59], v[48:51], v[120:123]
  v_fma_f32 v36, v36, s54, s54
  v_mfma_f32_16x16x32_bf16 v[124:127], a[60:63], v[48:51], v[124:127]
  v_fma_f32 v37, v37, s54, s54
  v_mfma_f32_16x16x32_bf16 v[112:115], a[64:67], v[48:51], v[112:115]
  v_fma_f32 v38, v38, s54, s54
  v_mfma_f32_16x16x32_bf16 v[116:119], a[68:71], v[48:51], v[116:119]
  v_fma_f32 v39, v39, s54, s54
  s_waitcnt lgkmcnt(2)
  v_mfma_f32_16x16x32_bf16 v[64:67], a[72:75], v[52:55], v[64:67]
  ds_read_b128 v[48:51], v6 offset:36864
  v_mfma_f32_16x16x32_bf16 v[68:71], a[76:79], v[52:55], v[68:71]
  v_rcp_f32 v36, v36
  v_mfma_f32_16x16x32_bf16 v[120:123], a[80:83], v[52:55], v[120:123]
  s_add_u32 m0, s36, 28672
  s_add_u32 s37, s85, 22528
  v_mfma_f32_16x16x32_bf16 v[124:127], a[84:87], v[52:55], v[124:127]
  buffer_load_dwordx4 v15, s[8:11], s37 offen nt lds
  v_mfma_f32_16x16x32_bf16 v[112:115], a[88:91], v[52:55], v[112:115]
  v_rcp_f32 v37, v37
  v_mfma_f32_16x16x32_bf16 v[116:119], a[92:95], v[52:55], v[116:119]
  s_waitcnt lgkmcnt(2)
  v_mfma_f32_16x16x32_bf16 v[64:67], a[96:99], v[40:43], v[64:67]
  ds_read_b128 v[52:55], v7 offset:36864
  v_mfma_f32_16x16x32_bf16 v[68:71], a[100:103], v[40:43], v[68:71]
  v_rcp_f32 v38, v38
  v_mfma_f32_16x16x32_bf16 v[120:123], a[104:107], v[40:43], v[120:123]
  v_rcp_f32 v39, v39
  v_mfma_f32_16x16x32_bf16 v[124:127], a[108:111], v[40:43], v[124:127]
  v_mul_f32 v104, v104, v36
  v_mfma_f32_16x16x32_bf16 v[112:115], a[112:115], v[40:43], v[112:115]
  v_mul_f32 v105, v105, v37
  v_mfma_f32_16x16x32_bf16 v[116:119], a[116:119], v[40:43], v[116:119]
  v_mul_f32 v106, v106, v38
  s_waitcnt lgkmcnt(2)
  v_mfma_f32_16x16x32_bf16 v[64:67], a[120:123], v[44:47], v[64:67]
  ds_read_b128 v[40:43], v4 offset:40960
  v_mfma_f32_16x16x32_bf16 v[68:71], a[124:127], v[44:47], v[68:71]
  v_mul_f32 v107, v107, v39
  v_mfma_f32_16x16x32_bf16 v[120:123], a[128:131], v[44:47], v[120:123]
  v_fma_f32 v108, v108, v24, v32
  v_mfma_f32_16x16x32_bf16 v[124:127], a[132:135], v[44:47], v[124:127]
  v_fma_f32 v109, v109, v25, v33
  v_mfma_f32_16x16x32_bf16 v[112:115], a[136:139], v[44:47], v[112:115]
  v_fma_f32 v110, v110, v26, v34
  v_mfma_f32_16x16x32_bf16 v[116:119], a[140:143], v[44:47], v[116:119]
  v_fma_f32 v111, v111, v27, v35
  s_waitcnt lgkmcnt(2)
  v_mfma_f32_16x16x32_bf16 v[64:67], a[144:147], v[48:51], v[64:67]
  ds_read_b128 v[44:47], v5 offset:40960
  v_mfma_f32_16x16x32_bf16 v[68:71], a[148:151], v[48:51], v[68:71]
  v_exp_f32 v36, v108
  v_mfma_f32_16x16x32_bf16 v[120:123], a[152:155], v[48:51], v[120:123]
  v_exp_f32 v37, v109
  v_mfma_f32_16x16x32_bf16 v[124:127], a[156:159], v[48:51], v[124:127]
  v_exp_f32 v38, v110
  v_mfma_f32_16x16x32_bf16 v[112:115], a[160:163], v[48:51], v[112:115]
  s_add_u32 m0, s36, 118784
  s_add_u32 s37, s86, 22528
  v_mfma_f32_16x16x32_bf16 v[116:119], a[164:167], v[48:51], v[116:119]
  buffer_load_dwordx4 v15, s[8:11], s37 offen nt lds
  s_waitcnt lgkmcnt(2)
  v_mfma_f32_16x16x32_bf16 v[64:67], a[168:171], v[52:55], v[64:67]
  ds_read_b128 v[48:51], v6 offset:40960
  v_mfma_f32_16x16x32_bf16 v[68:71], a[172:175], v[52:55], v[68:71]
  v_exp_f32 v39, v111
  v_mfma_f32_16x16x32_bf16 v[120:123], a[176:179], v[52:55], v[120:123]
  v_fma_f32 v36, v36, s54, s54
  v_mfma_f32_16x16x32_bf16 v[124:127], a[180:183], v[52:55], v[124:127]
  v_fma_f32 v37, v37, s54, s54
  v_mfma_f32_16x16x32_bf16 v[112:115], a[184:187], v[52:55], v[112:115]
  v_fma_f32 v38, v38, s54, s54
  v_mfma_f32_16x16x32_bf16 v[116:119], a[188:191], v[52:55], v[116:119]
  v_fma_f32 v39, v39, s54, s54
  s_waitcnt lgkmcnt(2)
  v_mfma_f32_16x16x32_bf16 v[64:67], a[192:195], v[40:43], v[64:67]
  ds_read_b128 v[52:55], v7 offset:40960
  v_mfma_f32_16x16x32_bf16 v[68:71], a[196:199], v[40:43], v[68:71]
  v_rcp_f32 v36, v36
  v_mfma_f32_16x16x32_bf16 v[120:123], a[200:203], v[40:43], v[120:123]
  v_rcp_f32 v37, v37
  v_mfma_f32_16x16x32_bf16 v[124:127], a[204:207], v[40:43], v[124:127]
  v_rcp_f32 v38, v38
  v_mfma_f32_16x16x32_bf16 v[112:115], a[208:211], v[40:43], v[112:115]
  v_rcp_f32 v39, v39
  v_mfma_f32_16x16x32_bf16 v[116:119], a[212:215], v[40:43], v[116:119]
  v_mul_f32 v108, v108, v36
  s_waitcnt lgkmcnt(2)
  v_mfma_f32_16x16x32_bf16 v[64:67], a[216:219], v[44:47], v[64:67]
  ds_read_b128 v[40:43], v4 offset:61440
  v_mfma_f32_16x16x32_bf16 v[68:71], a[220:223], v[44:47], v[68:71]
  v_mul_f32 v109, v109, v37
  v_mfma_f32_16x16x32_bf16 v[120:123], a[224:227], v[44:47], v[120:123]
  v_mul_f32 v110, v110, v38
  v_mfma_f32_16x16x32_bf16 v[124:127], a[228:231], v[44:47], v[124:127]
  v_mul_f32 v111, v111, v39
  v_mfma_f32_16x16x32_bf16 v[112:115], a[232:235], v[44:47], v[112:115]
  v_cvt_pk_bf16_f32 v104, v104, v105
  v_mfma_f32_16x16x32_bf16 v[116:119], a[236:239], v[44:47], v[116:119]
  v_cvt_pk_bf16_f32 v105, v106, v107
  s_waitcnt lgkmcnt(2)
  v_mfma_f32_16x16x32_bf16 v[64:67], a[240:243], v[48:51], v[64:67]
  ds_read_b128 v[44:47], v5 offset:61440
  s_add_u32 m0, s36, 90112
  v_mfma_f32_16x16x32_bf16 v[68:71], a[244:247], v[48:51], v[68:71]
  s_add_u32 s37, s87, 22528
  buffer_load_dwordx4 v15, s[8:11], s37 offen nt lds
  v_mfma_f32_16x16x32_bf16 v[120:123], a[248:251], v[48:51], v[120:123]
  v_cvt_pk_bf16_f32 v106, v108, v109
  v_mfma_f32_16x16x32_bf16 v[124:127], a[252:255], v[48:51], v[124:127]
  v_cvt_pk_bf16_f32 v107, v110, v111
  s_mov_b32 s38, 15360
  v_mfma_f32_16x16x32_bf16 v[112:115], v[128:131], v[48:51], v[112:115]
  buffer_store_dwordx4 v[104:107], v17, s[16:19], s38 offen sc1
  v_mfma_f32_16x16x32_bf16 v[116:119], v[132:135], v[48:51], v[116:119]
  s_waitcnt lgkmcnt(2)
  v_mfma_f32_16x16x32_bf16 v[64:67], v[136:139], v[52:55], v[64:67]
  ds_read_b128 v[48:51], v6 offset:61440
  v_mfma_f32_16x16x32_bf16 v[68:71], v[140:143], v[52:55], v[68:71]
  v_mfma_f32_16x16x32_bf16 v[120:123], v[144:147], v[52:55], v[120:123]
  v_mfma_f32_16x16x32_bf16 v[124:127], v[148:151], v[52:55], v[124:127]
  v_mfma_f32_16x16x32_bf16 v[112:115], v[152:155], v[52:55], v[112:115]
  v_mfma_f32_16x16x32_bf16 v[116:119], v[156:159], v[52:55], v[116:119]
  s_waitcnt lgkmcnt(2)
  v_mfma_f32_16x16x32_bf16 v[64:67], v[160:163], v[40:43], v[64:67]
  ds_read_b128 v[52:55], v7 offset:61440
  v_mfma_f32_16x16x32_bf16 v[68:71], v[164:167], v[40:43], v[68:71]
  v_mfma_f32_16x16x32_bf16 v[120:123], v[168:171], v[40:43], v[120:123]
  v_mfma_f32_16x16x32_bf16 v[124:127], v[172:175], v[40:43], v[124:127]
  v_mfma_f32_16x16x32_bf16 v[112:115], v[176:179], v[40:43], v[112:115]
  v_mfma_f32_16x16x32_bf16 v[116:119], v[180:183], v[40:43], v[116:119]
  s_waitcnt lgkmcnt(2)
  v_mfma_f32_16x16x32_bf16 v[64:67], v[184:187], v[44:47], v[64:67]
  ds_read_b128 v[40:43], v8 offset:0
  v_mfma_f32_16x16x32_bf16 v[68:71], v[188:191], v[44:47], v[68:71]
  v_mfma_f32_16x16x32_bf16 v[120:123], v[192:195], v[44:47], v[120:123]
  s_add_u32 m0, s36, 94208
  s_add_u32 s37, s84, 23552
  v_mfma_f32_16x16x32_bf16 v[124:127], v[196:199], v[44:47], v[124:127]
  buffer_load_dwordx4 v15, s[8:11], s37 offen nt lds
  v_mfma_f32_16x16x32_bf16 v[112:115], v[200:203], v[44:47], v[112:115]
  v_mfma_f32_16x16x32_bf16 v[116:119], v[204:207], v[44:47], v[116:119]
  s_waitcnt lgkmcnt(2)
  v_mfma_f32_16x16x32_bf16 v[64:67], v[208:211], v[48:51], v[64:67]
  ds_read_b128 v[44:47], v9 offset:0
  v_mfma_f32_16x16x32_bf16 v[68:71], v[212:215], v[48:51], v[68:71]
  v_mfma_f32_16x16x32_bf16 v[120:123], v[216:219], v[48:51], v[120:123]
  v_mfma_f32_16x16x32_bf16 v[124:127], v[220:223], v[48:51], v[124:127]
  v_mfma_f32_16x16x32_bf16 v[112:115], v[224:227], v[48:51], v[112:115]
  v_mfma_f32_16x16x32_bf16 v[116:119], v[228:231], v[48:51], v[116:119]
  s_waitcnt lgkmcnt(2)
  v_mfma_f32_16x16x32_bf16 v[64:67], v[232:235], v[52:55], v[64:67]
  ds_read_b128 v[48:51], v10 offset:0
  v_mfma_f32_16x16x32_bf16 v[68:71], v[236:239], v[52:55], v[68:71]
  v_mfma_f32_16x16x32_bf16 v[120:123], v[240:243], v[52:55], v[120:123]
  v_mfma_f32_16x16x32_bf16 v[124:127], v[244:247], v[52:55], v[124:127]
  v_mfma_f32_16x16x32_bf16 v[112:115], v[248:251], v[52:55], v[112:115]
  v_mfma_f32_16x16x32_bf16 v[116:119], v[252:255], v[52:55], v[116:119]
  s_waitcnt lgkmcnt(2)
  v_mfma_f32_16x16x32_bf16 v[56:59], a[0:3], v[40:43], 0
  ds_read_b128 v[52:55], v11 offset:0
  v_mfma_f32_16x16x32_bf16 v[60:63], a[4:7], v[40:43], 0
  v_mfma_f32_16x16x32_bf16 v[64:67], a[8:11], v[40:43], v[64:67]
  v_mfma_f32_16x16x32_bf16 v[68:71], a[12:15], v[40:43], v[68:71]
  v_mfma_f32_16x16x32_bf16 v[120:123], a[16:19], v[40:43], v[120:123]
  s_add_u32 m0, s36, 0
  s_add_u32 s37, s85, 23552
  v_mfma_f32_16x16x32_bf16 v[124:127], a[20:23], v[40:43], v[124:127]
  buffer_load_dwordx4 v15, s[8:11], s37 offen nt lds
  s_waitcnt lgkmcnt(2)
  v_mfma_f32_16x16x32_bf16 v[56:59], a[24:27], v[44:47], v[56:59]
  ds_read_b128 v[40:43], v4 offset:16384
  v_fma_f32 v112, v112, v20, v28
  v_mfma_f32_16x16x32_bf16 v[60:63], a[28:31], v[44:47], v[60:63]
  v_fma_f32 v113, v113, v21, v29
  v_mfma_f32_16x16x32_bf16 v[64:67], a[32:35], v[44:47], v[64:67]
  v_fma_f32 v114, v114, v22, v30
  v_mfma_f32_16x16x32_bf16 v[68:71], a[36:39], v[44:47], v[68:71]
  v_fma_f32 v115, v115, v23, v31
  v_mfma_f32_16x16x32_bf16 v[120:123], a[40:43], v[44:47], v[120:123]
  v_exp_f32 v36, v112
  v_mfma_f32_16x16x32_bf16 v[124:127], a[44:47], v[44:47], v[124:127]
  s_waitcnt lgkmcnt(2)
  v_mfma_f32_16x16x32_bf16 v[56:59], a[48:51], v[48:51], v[56:59]
  ds_read_b128 v[44:47], v5 offset:16384
  v_mfma_f32_16x16x32_bf16 v[60:63], a[52:55], v[48:51], v[60:63]
  v_exp_f32 v37, v113
  v_mfma_f32_16x16x32_bf16 v[64:67], a[56:59], v[48:51], v[64:67]
  v_exp_f32 v38, v114
  v_mfma_f32_16x16x32_bf16 v[68:71], a[60:63], v[48:51], v[68:71]
  v_exp_f32 v39, v115
  v_mfma_f32_16x16x32_bf16 v[120:123], a[64:67], v[48:51], v[120:123]
  v_fma_f32 v36, v36, s54, s54
  v_mfma_f32_16x16x32_bf16 v[124:127], a[68:71], v[48:51], v[124:127]
  v_fma_f32 v37, v37, s54, s54
  s_waitcnt lgkmcnt(2)
  v_mfma_f32_16x16x32_bf16 v[56:59], a[72:75], v[52:55], v[56:59]
  ds_read_b128 v[48:51], v6 offset:16384
  v_mfma_f32_16x16x32_bf16 v[60:63], a[76:79], v[52:55], v[60:63]
  v_fma_f32 v38, v38, s54, s54
  v_mfma_f32_16x16x32_bf16 v[64:67], a[80:83], v[52:55], v[64:67]
  v_fma_f32 v39, v39, s54, s54
  v_mfma_f32_16x16x32_bf16 v[68:71], a[84:87], v[52:55], v[68:71]
  v_rcp_f32 v36, v36
  v_mfma_f32_16x16x32_bf16 v[120:123], a[88:91], v[52:55], v[120:123]
  v_rcp_f32 v37, v37
  v_mfma_f32_16x16x32_bf16 v[124:127], a[92:95], v[52:55], v[124:127]
  s_waitcnt lgkmcnt(2)
  v_mfma_f32_16x16x32_bf16 v[56:59], a[96:99], v[40:43], v[56:59]
  ds_read_b128 v[52:55], v7 offset:16384
  s_add_u32 m0, s36, 4096
  v_mfma_f32_16x16x32_bf16 v[60:63], a[100:103], v[40:43], v[60:63]
  s_add_u32 s37, s86, 23552
  buffer_load_dwordx4 v15, s[8:11], s37 offen nt lds
  v_mfma_f32_16x16x32_bf16 v[64:67], a[104:107], v[40:43], v[64:67]
  v_rcp_f32 v38, v38
  v_mfma_f32_16x16x32_bf16 v[68:71], a[108:111], v[40:43], v[68:71]
  v_rcp_f32 v39, v39
  v_mfma_f32_16x16x32_bf16 v[120:123], a[112:115], v[40:43], v[120:123]
  v_mul_f32 v112, v112, v36
  v_mfma_f32_16x16x32_bf16 v[124:127], a[116:119], v[40:43], v[124:127]
  v_mul_f32 v113, v113, v37
  s_waitcnt lgkmcnt(2)
  v_mfma_f32_16x16x32_bf16 v[56:59], a[120:123], v[44:47], v[56:59]
  ds_read_b128 v[40:43], v8 offset:32768
  v_mfma_f32_16x16x32_bf16 v[60:63], a[124:127], v[44:47], v[60:63]
  v_mul_f32 v114, v114, v38
  v_mfma_f32_16x16x32_bf16 v[64:67], a[128:131], v[44:47], v[64:67]
  v_mul_f32 v115, v115, v39
  v_mfma_f32_16x16x32_bf16 v[68:71], a[132:135], v[44:47], v[68:71]
  v_fma_f32 v116, v116, v24, v32
  v_mfma_f32_16x16x32_bf16 v[120:123], a[136:139], v[44:47], v[120:123]
  v_fma_f32 v117, v117, v25, v33
  v_mfma_f32_16x16x32_bf16 v[124:127], a[140:143], v[44:47], v[124:127]
  v_fma_f32 v118, v118, v26, v34
  s_waitcnt lgkmcnt(2)
  v_mfma_f32_16x16x32_bf16 v[56:59], a[144:147], v[48:51], v[56:59]
  ds_read_b128 v[44:47], v9 offset:32768
  v_mfma_f32_16x16x32_bf16 v[60:63], a[148:151], v[48:51], v[60:63]
  v_fma_f32 v119, v119, v27, v35
  v_mfma_f32_16x16x32_bf16 v[64:67], a[152:155], v[48:51], v[64:67]
  v_exp_f32 v36, v116
  v_mfma_f32_16x16x32_bf16 v[68:71], a[156:159], v[48:51], v[68:71]
  v_exp_f32 v37, v117
  v_mfma_f32_16x16x32_bf16 v[120:123], a[160:163], v[48:51], v[120:123]
  v_exp_f32 v38, v118
  v_mfma_f32_16x16x32_bf16 v[124:127], a[164:167], v[48:51], v[124:127]
  s_waitcnt lgkmcnt(2)
  v_mfma_f32_16x16x32_bf16 v[56:59], a[168:171], v[52:55], v[56:59]
  ds_read_b128 v[48:51], v10 offset:32768
  v_mfma_f32_16x16x32_bf16 v[60:63], a[172:175], v[52:55], v[60:63]
  v_exp_f32 v39, v119
  v_mfma_f32_16x16x32_bf16 v[64:67], a[176:179], v[52:55], v[64:67]
  s_add_u32 m0, s36, 8192
  s_add_u32 s37, s87, 23552
  v_mfma_f32_16x16x32_bf16 v[68:71], a[180:183], v[52:55], v[68:71]
  buffer_load_dwordx4 v15, s[8:11], s37 offen nt lds
  v_mfma_f32_16x16x32_bf16 v[120:123], a[184:187], v[52:55], v[120:123]
  v_fma_f32 v36, v36, s54, s54
  v_mfma_f32_16x16x32_bf16 v[124:127], a[188:191], v[52:55], v[124:127]
  v_fma_f32 v37, v37, s54, s54
  s_waitcnt lgkmcnt(2)
  v_mfma_f32_16x16x32_bf16 v[56:59], a[192:195], v[40:43], v[56:59]
  ds_read_b128 v[52:55], v11 offset:32768
  v_mfma_f32_16x16x32_bf16 v[60:63], a[196:199], v[40:43], v[60:63]
  v_fma_f32 v38, v38, s54, s54
  v_mfma_f32_16x16x32_bf16 v[64:67], a[200:203], v[40:43], v[64:67]
  v_fma_f32 v39, v39, s54, s54
  v_mfma_f32_16x16x32_bf16 v[68:71], a[204:207], v[40:43], v[68:71]
  v_rcp_f32 v36, v36
  v_mfma_f32_16x16x32_bf16 v[120:123], a[208:211], v[40:43], v[120:123]
  v_rcp_f32 v37, v37
  v_mfma_f32_16x16x32_bf16 v[124:127], a[212:215], v[40:43], v[124:127]
  s_waitcnt lgkmcnt(2)
  v_mfma_f32_16x16x32_bf16 v[56:59], a[216:219], v[44:47], v[56:59]
  ds_read_b128 v[40:43], v4 offset:45056
  v_mfma_f32_16x16x32_bf16 v[60:63], a[220:223], v[44:47], v[60:63]
  v_rcp_f32 v38, v38
  v_mfma_f32_16x16x32_bf16 v[64:67], a[224:227], v[44:47], v[64:67]
  v_rcp_f32 v39, v39
  v_mfma_f32_16x16x32_bf16 v[68:71], a[228:231], v[44:47], v[68:71]
  v_mul_f32 v116, v116, v36
  v_mfma_f32_16x16x32_bf16 v[120:123], a[232:235], v[44:47], v[120:123]
  v_mul_f32 v117, v117, v37
  v_mfma_f32_16x16x32_bf16 v[124:127], a[236:239], v[44:47], v[124:127]
  v_mul_f32 v118, v118, v38
  s_waitcnt lgkmcnt(2)
  v_mfma_f32_16x16x32_bf16 v[56:59], a[240:243], v[48:51], v[56:59]
  ds_read_b128 v[44:47], v5 offset:45056
  v_mfma_f32_16x16x32_bf16 v[60:63], a[244:247], v[48:51], v[60:63]
  v_mul_f32 v119, v119, v39
  v_mfma_f32_16x16x32_bf16 v[64:67], a[248:251], v[48:51], v[64:67]
  v_cvt_pk_bf16_f32 v112, v112, v113
  v_mfma_f32_16x16x32_bf16 v[68:71], a[252:255], v[48:51], v[68:71]
  v_cvt_pk_bf16_f32 v113, v114, v115
  v_mfma_f32_16x16x32_bf16 v[120:123], v[128:131], v[48:51], v[120:123]
  s_add_u32 m0, s36, 53248
  s_add_u32 s37, s84, 24576
  v_mfma_f32_16x16x32_bf16 v[124:127], v[132:135], v[48:51], v[124:127]
  buffer_load_dwordx4 v15, s[8:11], s37 offen nt lds
  s_waitcnt lgkmcnt(2)
  v_mfma_f32_16x16x32_bf16 v[56:59], v[136:139], v[52:55], v[56:59]
  ds_read_b128 v[48:51], v6 offset:45056
  v_mfma_f32_16x16x32_bf16 v[60:63], v[140:143], v[52:55], v[60:63]
  v_cvt_pk_bf16_f32 v114, v116, v117
  v_mfma_f32_16x16x32_bf16 v[64:67], v[144:147], v[52:55], v[64:67]
  v_cvt_pk_bf16_f32 v115, v118, v119
  s_mov_b32 s38, 16384
  v_mfma_f32_16x16x32_bf16 v[68:71], v[148:151], v[52:55], v[68:71]
  buffer_store_dwordx4 v[112:115], v17, s[16:19], s38 offen sc1
  v_mfma_f32_16x16x32_bf16 v[120:123], v[152:155], v[52:55], v[120:123]
  v_mfma_f32_16x16x32_bf16 v[124:127], v[156:159], v[52:55], v[124:127]
  s_waitcnt lgkmcnt(2)
  v_mfma_f32_16x16x32_bf16 v[56:59], v[160:163], v[40:43], v[56:59]
  ds_read_b128 v[52:55], v7 offset:45056
  v_mfma_f32_16x16x32_bf16 v[60:63], v[164:167], v[40:43], v[60:63]
  v_mfma_f32_16x16x32_bf16 v[64:67], v[168:171], v[40:43], v[64:67]
  v_mfma_f32_16x16x32_bf16 v[68:71], v[172:175], v[40:43], v[68:71]
  v_mfma_f32_16x16x32_bf16 v[120:123], v[176:179], v[40:43], v[120:123]
  v_mfma_f32_16x16x32_bf16 v[124:127], v[180:183], v[40:43], v[124:127]
  s_waitcnt lgkmcnt(2)
  v_mfma_f32_16x16x32_bf16 v[56:59], v[184:187], v[44:47], v[56:59]
  ds_read_b128 v[40:43], v8 offset:16384
  v_mfma_f32_16x16x32_bf16 v[60:63], v[188:191], v[44:47], v[60:63]
  v_mfma_f32_16x16x32_bf16 v[64:67], v[192:195], v[44:47], v[64:67]
  v_mfma_f32_16x16x32_bf16 v[68:71], v[196:199], v[44:47], v[68:71]
  v_mfma_f32_16x16x32_bf16 v[120:123], v[200:203], v[44:47], v[120:123]
  v_mfma_f32_16x16x32_bf16 v[124:127], v[204:207], v[44:47], v[124:127]
  s_waitcnt lgkmcnt(2)
  v_mfma_f32_16x16x32_bf16 v[56:59], v[208:211], v[48:51], v[56:59]
  ds_read_b128 v[44:47], v9 offset:16384
  v_mfma_f32_16x16x32_bf16 v[60:63], v[212:215], v[48:51], v[60:63]
  v_mfma_f32_16x16x32_bf16 v[64:67], v[216:219], v[48:51], v[64:67]
  v_mfma_f32_16x16x32_bf16 v[68:71], v[220:223], v[48:51], v[68:71]
  v_mfma_f32_16x16x32_bf16 v[120:123], v[224:227], v[48:51], v[120:123]
  v_mfma_f32_16x16x32_bf16 v[124:127], v[228:231], v[48:51], v[124:127]
  s_waitcnt lgkmcnt(2)
  v_mfma_f32_16x16x32_bf16 v[56:59], v[232:235], v[52:55], v[56:59]
  ds_read_b128 v[48:51], v10 offset:16384
  v_mfma_f32_16x16x32_bf16 v[60:63], v[236:239], v[52:55], v[60:63]
  v_mfma_f32_16x16x32_bf16 v[64:67], v[240:243], v[52:55], v[64:67]
  v_mfma_f32_16x16x32_bf16 v[68:71], v[244:247], v[52:55], v[68:71]
  v_mfma_f32_16x16x32_bf16 v[120:123], v[248:251], v[52:55], v[120:123]
  v_mfma_f32_16x16x32_bf16 v[124:127], v[252:255], v[52:55], v[124:127]
  s_waitcnt lgkmcnt(2)
  v_mfma_f32_16x16x32_bf16 v[72:75], a[0:3], v[40:43], 0
  ds_read_b128 v[52:55], v11 offset:16384
  v_mfma_f32_16x16x32_bf16 v[76:79], a[4:7], v[40:43], 0
  v_mfma_f32_16x16x32_bf16 v[56:59], a[8:11], v[40:43], v[56:59]
  v_mfma_f32_16x16x32_bf16 v[60:63], a[12:15], v[40:43], v[60:63]
  v_mfma_f32_16x16x32_bf16 v[64:67], a[16:19], v[40:43], v[64:67]
  v_mfma_f32_16x16x32_bf16 v[68:71], a[20:23], v[40:43], v[68:71]
  s_waitcnt lgkmcnt(2)
  v_mfma_f32_16x16x32_bf16 v[72:75], a[24:27], v[44:47], v[72:75]
  ds_read_b128 v[40:43], v8 offset:20480
  v_fma_f32 v120, v120, v20, v28
  v_mfma_f32_16x16x32_bf16 v[76:79], a[28:31], v[44:47], v[76:79]
  v_fma_f32 v121, v121, v21, v29
  v_mfma_f32_16x16x32_bf16 v[56:59], a[32:35], v[44:47], v[56:59]
  v_fma_f32 v122, v122, v22, v30
  v_mfma_f32_16x16x32_bf16 v[60:63], a[36:39], v[44:47], v[60:63]
  v_fma_f32 v123, v123, v23, v31
  v_mfma_f32_16x16x32_bf16 v[64:67], a[40:43], v[44:47], v[64:67]
  v_exp_f32 v36, v120
  v_mfma_f32_16x16x32_bf16 v[68:71], a[44:47], v[44:47], v[68:71]
  s_waitcnt lgkmcnt(2)
  v_mfma_f32_16x16x32_bf16 v[72:75], a[48:51], v[48:51], v[72:75]
  ds_read_b128 v[44:47], v9 offset:20480
  v_mfma_f32_16x16x32_bf16 v[76:79], a[52:55], v[48:51], v[76:79]
  v_exp_f32 v37, v121
  v_mfma_f32_16x16x32_bf16 v[56:59], a[56:59], v[48:51], v[56:59]
  v_exp_f32 v38, v122
  v_mfma_f32_16x16x32_bf16 v[60:63], a[60:63], v[48:51], v[60:63]
  v_exp_f32 v39, v123
  v_mfma_f32_16x16x32_bf16 v[64:67], a[64:67], v[48:51], v[64:67]
  v_fma_f32 v36, v36, s54, s54
  v_mfma_f32_16x16x32_bf16 v[68:71], a[68:71], v[48:51], v[68:71]
  v_fma_f32 v37, v37, s54, s54
  s_waitcnt lgkmcnt(2)
  v_mfma_f32_16x16x32_bf16 v[72:75], a[72:75], v[52:55], v[72:75]
  ds_read_b128 v[48:51], v10 offset:20480
  v_mfma_f32_16x16x32_bf16 v[76:79], a[76:79], v[52:55], v[76:79]
  v_fma_f32 v38, v38, s54, s54
  v_mfma_f32_16x16x32_bf16 v[56:59], a[80:83], v[52:55], v[56:59]
  v_fma_f32 v39, v39, s54, s54
  v_mfma_f32_16x16x32_bf16 v[60:63], a[84:87], v[52:55], v[60:63]
  v_rcp_f32 v36, v36
  v_mfma_f32_16x16x32_bf16 v[64:67], a[88:91], v[52:55], v[64:67]
  v_rcp_f32 v37, v37
  v_mfma_f32_16x16x32_bf16 v[68:71], a[92:95], v[52:55], v[68:71]
  s_waitcnt lgkmcnt(2)
  v_mfma_f32_16x16x32_bf16 v[72:75], a[96:99], v[40:43], v[72:75]
  ds_read_b128 v[52:55], v11 offset:20480
  v_mfma_f32_16x16x32_bf16 v[76:79], a[100:103], v[40:43], v[76:79]
  v_rcp_f32 v38, v38
  v_mfma_f32_16x16x32_bf16 v[56:59], a[104:107], v[40:43], v[56:59]
  v_rcp_f32 v39, v39
  v_mfma_f32_16x16x32_bf16 v[60:63], a[108:111], v[40:43], v[60:63]
  v_mul_f32 v120, v120, v36
  v_mfma_f32_16x16x32_bf16 v[64:67], a[112:115], v[40:43], v[64:67]
  v_mul_f32 v121, v121, v37
  v_mfma_f32_16x16x32_bf16 v[68:71], a[116:119], v[40:43], v[68:71]
  v_mul_f32 v122, v122, v38
  s_waitcnt lgkmcnt(2)
  v_mfma_f32_16x16x32_bf16 v[72:75], a[120:123], v[44:47], v[72:75]
  ds_read_b128 v[40:43], v8 offset:36864
  v_mfma_f32_16x16x32_bf16 v[76:79], a[124:127], v[44:47], v[76:79]
  v_mul_f32 v123, v123, v39
  v_mfma_f32_16x16x32_bf16 v[56:59], a[128:131], v[44:47], v[56:59]
  v_fma_f32 v124, v124, v24, v32
  v_mfma_f32_16x16x32_bf16 v[60:63], a[132:135], v[44:47], v[60:63]
  v_fma_f32 v125, v125, v25, v33
  v_mfma_f32_16x16x32_bf16 v[64:67], a[136:139], v[44:47], v[64:67]
  v_fma_f32 v126, v126, v26, v34
  v_mfma_f32_16x16x32_bf16 v[68:71], a[140:143], v[44:47], v[68:71]
  v_fma_f32 v127, v127, v27, v35
  s_waitcnt vmcnt(8)
  s_barrier
  s_waitcnt lgkmcnt(2)
  v_mfma_f32_16x16x32_bf16 v[72:75], a[144:147], v[48:51], v[72:75]
  ds_read_b128 v[44:47], v9 offset:36864
  s_add_u32 m0, s36, 57344
  v_mfma_f32_16x16x32_bf16 v[76:79], a[148:151], v[48:51], v[76:79]
  s_add_u32 s37, s85, 24576
  buffer_load_dwordx4 v15, s[8:11], s37 offen nt lds
  v_mfma_f32_16x16x32_bf16 v[56:59], a[152:155], v[48:51], v[56:59]
  v_exp_f32 v36, v124
  v_mfma_f32_16x16x32_bf16 v[60:63], a[156:159], v[48:51], v[60:63]
  v_exp_f32 v37, v125
  v_mfma_f32_16x16x32_bf16 v[64:67], a[160:163], v[48:51], v[64:67]
  v_exp_f32 v38, v126
  v_mfma_f32_16x16x32_bf16 v[68:71], a[164:167], v[48:51], v[68:71]
  s_waitcnt lgkmcnt(2)
  v_mfma_f32_16x16x32_bf16 v[72:75], a[168:171], v[52:55], v[72:75]
  ds_read_b128 v[48:51], v10 offset:36864
  v_mfma_f32_16x16x32_bf16 v[76:79], a[172:175], v[52:55], v[76:79]
  v_exp_f32 v39, v127
  v_mfma_f32_16x16x32_bf16 v[56:59], a[176:179], v[52:55], v[56:59]
  v_fma_f32 v36, v36, s54, s54
  v_mfma_f32_16x16x32_bf16 v[60:63], a[180:183], v[52:55], v[60:63]
  v_fma_f32 v37, v37, s54, s54
  v_mfma_f32_16x16x32_bf16 v[64:67], a[184:187], v[52:55], v[64:67]
  v_fma_f32 v38, v38, s54, s54
  v_mfma_f32_16x16x32_bf16 v[68:71], a[188:191], v[52:55], v[68:71]
  v_fma_f32 v39, v39, s54, s54
  s_waitcnt lgkmcnt(2)
  v_mfma_f32_16x16x32_bf16 v[72:75], a[192:195], v[40:43], v[72:75]
  ds_read_b128 v[52:55], v11 offset:36864
  v_mfma_f32_16x16x32_bf16 v[76:79], a[196:199], v[40:43], v[76:79]
  v_rcp_f32 v36, v36
  v_mfma_f32_16x16x32_bf16 v[56:59], a[200:203], v[40:43], v[56:59]
  v_rcp_f32 v37, v37
  v_mfma_f32_16x16x32_bf16 v[60:63], a[204:207], v[40:43], v[60:63]
  v_rcp_f32 v38, v38
  v_mfma_f32_16x16x32_bf16 v[64:67], a[208:211], v[40:43], v[64:67]
  v_rcp_f32 v39, v39
  v_mfma_f32_16x16x32_bf16 v[68:71], a[212:215], v[40:43], v[68:71]
  v_mul_f32 v124, v124, v36
  s_waitcnt lgkmcnt(2)
  v_mfma_f32_16x16x32_bf16 v[72:75], a[216:219], v[44:47], v[72:75]
  ds_read_b128 v[40:43], v8 offset:4096
  v_mfma_f32_16x16x32_bf16 v[76:79], a[220:223], v[44:47], v[76:79]
  v_mul_f32 v125, v125, v37
  v_mfma_f32_16x16x32_bf16 v[56:59], a[224:227], v[44:47], v[56:59]
  s_add_u32 m0, s36, 122880
  s_add_u32 s37, s86, 24576
  v_mfma_f32_16x16x32_bf16 v[60:63], a[228:231], v[44:47], v[60:63]
  buffer_load_dwordx4 v15, s[8:11], s37 offen nt lds
  v_mfma_f32_16x16x32_bf16 v[64:67], a[232:235], v[44:47], v[64:67]
  v_mul_f32 v126, v126, v38
  v_mfma_f32_16x16x32_bf16 v[68:71], a[236:239], v[44:47], v[68:71]
  v_mul_f32 v127, v127, v39
  s_waitcnt lgkmcnt(2)
  v_mfma_f32_16x16x32_bf16 v[72:75], a[240:243], v[48:51], v[72:75]
  ds_read_b128 v[44:47], v9 offset:4096
  v_mfma_f32_16x16x32_bf16 v[76:79], a[244:247], v[48:51], v[76:79]
  v_cvt_pk_bf16_f32 v120, v120, v121
  v_mfma_f32_16x16x32_bf16 v[56:59], a[248:251], v[48:51], v[56:59]
  v_cvt_pk_bf16_f32 v121, v122, v123
  v_mfma_f32_16x16x32_bf16 v[60:63], a[252:255], v[48:51], v[60:63]
  v_cvt_pk_bf16_f32 v122, v124, v125
  v_mfma_f32_16x16x32_bf16 v[64:67], v[128:131], v[48:51], v[64:67]
  v_cvt_pk_bf16_f32 v123, v126, v127
  s_mov_b32 s38, 17408
  v_mfma_f32_16x16x32_bf16 v[68:71], v[132:135], v[48:51], v[68:71]
  buffer_store_dwordx4 v[120:123], v17, s[16:19], s38 offen sc1
  s_waitcnt lgkmcnt(2)
  v_mfma_f32_16x16x32_bf16 v[72:75], v[136:139], v[52:55], v[72:75]
  ds_read_b128 v[48:51], v10 offset:4096
  v_mfma_f32_16x16x32_bf16 v[76:79], v[140:143], v[52:55], v[76:79]
  v_mbcnt_lo_u32_b32 v12, -1, 0
  v_mfma_f32_16x16x32_bf16 v[56:59], v[144:147], v[52:55], v[56:59]
  v_mbcnt_hi_u32_b32 v12, -1, v12
  v_mfma_f32_16x16x32_bf16 v[60:63], v[148:151], v[52:55], v[60:63]
  v_lshl_add_u32 v12, v12, 3, s52
  v_mfma_f32_16x16x32_bf16 v[64:67], v[152:155], v[52:55], v[64:67]
  buffer_load_dword v13, v12, s[48:51], 0 offen
  v_mfma_f32_16x16x32_bf16 v[68:71], v[156:159], v[52:55], v[68:71]
  s_waitcnt lgkmcnt(2)
  v_mfma_f32_16x16x32_bf16 v[72:75], v[160:163], v[40:43], v[72:75]
  ds_read_b128 v[52:55], v11 offset:4096
  v_mfma_f32_16x16x32_bf16 v[76:79], v[164:167], v[40:43], v[76:79]
  v_mfma_f32_16x16x32_bf16 v[56:59], v[168:171], v[40:43], v[56:59]
  v_mfma_f32_16x16x32_bf16 v[60:63], v[172:175], v[40:43], v[60:63]
  v_mfma_f32_16x16x32_bf16 v[64:67], v[176:179], v[40:43], v[64:67]
  s_add_u32 m0, s36, 126976
  s_add_u32 s37, s87, 24576
  v_mfma_f32_16x16x32_bf16 v[68:71], v[180:183], v[40:43], v[68:71]
  buffer_load_dwordx4 v15, s[8:11], s37 offen nt lds
  s_waitcnt lgkmcnt(2)
  v_mfma_f32_16x16x32_bf16 v[72:75], v[184:187], v[44:47], v[72:75]
  ds_read_b128 v[40:43], v8 offset:8192
  v_mfma_f32_16x16x32_bf16 v[76:79], v[188:191], v[44:47], v[76:79]
  v_mfma_f32_16x16x32_bf16 v[56:59], v[192:195], v[44:47], v[56:59]
  v_mfma_f32_16x16x32_bf16 v[60:63], v[196:199], v[44:47], v[60:63]
  v_mfma_f32_16x16x32_bf16 v[64:67], v[200:203], v[44:47], v[64:67]
  v_mfma_f32_16x16x32_bf16 v[68:71], v[204:207], v[44:47], v[68:71]
  s_waitcnt lgkmcnt(2)
  v_mfma_f32_16x16x32_bf16 v[72:75], v[208:211], v[48:51], v[72:75]
  ds_read_b128 v[44:47], v9 offset:8192
  v_mfma_f32_16x16x32_bf16 v[76:79], v[212:215], v[48:51], v[76:79]
  v_mfma_f32_16x16x32_bf16 v[56:59], v[216:219], v[48:51], v[56:59]
  v_mfma_f32_16x16x32_bf16 v[60:63], v[220:223], v[48:51], v[60:63]
  v_mfma_f32_16x16x32_bf16 v[64:67], v[224:227], v[48:51], v[64:67]
  v_mfma_f32_16x16x32_bf16 v[68:71], v[228:231], v[48:51], v[68:71]
  s_waitcnt lgkmcnt(2)
  v_mfma_f32_16x16x32_bf16 v[72:75], v[232:235], v[52:55], v[72:75]
  ds_read_b128 v[48:51], v10 offset:8192
  v_mfma_f32_16x16x32_bf16 v[76:79], v[236:239], v[52:55], v[76:79]
  v_mfma_f32_16x16x32_bf16 v[56:59], v[240:243], v[52:55], v[56:59]
  v_mfma_f32_16x16x32_bf16 v[60:63], v[244:247], v[52:55], v[60:63]
  v_mfma_f32_16x16x32_bf16 v[64:67], v[248:251], v[52:55], v[64:67]
  v_mfma_f32_16x16x32_bf16 v[68:71], v[252:255], v[52:55], v[68:71]
  s_waitcnt lgkmcnt(2)
  v_mfma_f32_16x16x32_bf16 v[80:83], a[0:3], v[40:43], 0
  ds_read_b128 v[52:55], v11 offset:8192
  s_add_u32 m0, s36, 32768
  v_mfma_f32_16x16x32_bf16 v[84:87], a[4:7], v[40:43], 0
  s_add_u32 s37, s84, 25600
  buffer_load_dwordx4 v15, s[8:11], s37 offen nt lds
  v_mfma_f32_16x16x32_bf16 v[72:75], a[8:11], v[40:43], v[72:75]
  v_mfma_f32_16x16x32_bf16 v[76:79], a[12:15], v[40:43], v[76:79]
  v_mfma_f32_16x16x32_bf16 v[56:59], a[16:19], v[40:43], v[56:59]
  v_fma_f32 v64, v64, v20, v28
  v_fma_f32 v65, v65, v21, v29
  v_mfma_f32_16x16x32_bf16 v[60:63], a[20:23], v[40:43], v[60:63]
  v_fma_f32 v66, v66, v22, v30
  s_waitcnt lgkmcnt(2)
  v_mfma_f32_16x16x32_bf16 v[80:83], a[24:27], v[44:47], v[80:83]
  ds_read_b128 v[40:43], v8 offset:12288
  v_mfma_f32_16x16x32_bf16 v[84:87], a[28:31], v[44:47], v[84:87]
  v_fma_f32 v67, v67, v23, v31
  v_mfma_f32_16x16x32_bf16 v[72:75], a[32:35], v[44:47], v[72:75]
  v_exp_f32 v36, v64
  v_mfma_f32_16x16x32_bf16 v[76:79], a[36:39], v[44:47], v[76:79]
  v_exp_f32 v37, v65
  v_mfma_f32_16x16x32_bf16 v[56:59], a[40:43], v[44:47], v[56:59]
  v_exp_f32 v38, v66
  v_mfma_f32_16x16x32_bf16 v[60:63], a[44:47], v[44:47], v[60:63]
  s_waitcnt lgkmcnt(2)
  v_mfma_f32_16x16x32_bf16 v[80:83], a[48:51], v[48:51], v[80:83]
  ds_read_b128 v[44:47], v9 offset:12288
  v_mfma_f32_16x16x32_bf16 v[84:87], a[52:55], v[48:51], v[84:87]
  v_exp_f32 v39, v67
  v_mfma_f32_16x16x32_bf16 v[72:75], a[56:59], v[48:51], v[72:75]
  v_fma_f32 v36, v36, s54, s54
  v_mfma_f32_16x16x32_bf16 v[76:79], a[60:63], v[48:51], v[76:79]
  v_fma_f32 v37, v37, s54, s54
  v_mfma_f32_16x16x32_bf16 v[56:59], a[64:67], v[48:51], v[56:59]
  v_fma_f32 v38, v38, s54, s54
  v_mfma_f32_16x16x32_bf16 v[60:63], a[68:71], v[48:51], v[60:63]
  v_fma_f32 v39, v39, s54, s54
  s_waitcnt lgkmcnt(2)
  v_mfma_f32_16x16x32_bf16 v[80:83], a[72:75], v[52:55], v[80:83]
  ds_read_b128 v[48:51], v10 offset:12288
  v_mfma_f32_16x16x32_bf16 v[84:87], a[76:79], v[52:55], v[84:87]
  v_rcp_f32 v36, v36
  v_mfma_f32_16x16x32_bf16 v[72:75], a[80:83], v[52:55], v[72:75]
  s_add_u32 m0, s36, 36864
  s_add_u32 s37, s85, 25600
  v_mfma_f32_16x16x32_bf16 v[76:79], a[84:87], v[52:55], v[76:79]
  buffer_load_dwordx4 v15, s[8:11], s37 offen nt lds
  v_mfma_f32_16x16x32_bf16 v[56:59], a[88:91], v[52:55], v[56:59]
  v_rcp_f32 v37, v37
  v_mfma_f32_16x16x32_bf16 v[60:63], a[92:95], v[52:55], v[60:63]
  s_waitcnt lgkmcnt(2)
  v_mfma_f32_16x16x32_bf16 v[80:83], a[96:99], v[40:43], v[80:83]
  ds_read_b128 v[52:55], v11 offset:12288
  v_mfma_f32_16x16x32_bf16 v[84:87], a[100:103], v[40:43], v[84:87]
  v_rcp_f32 v38, v38
  v_mfma_f32_16x16x32_bf16 v[72:75], a[104:107], v[40:43], v[72:75]
  v_rcp_f32 v39, v39
  v_mfma_f32_16x16x32_bf16 v[76:79], a[108:111], v[40:43], v[76:79]
  v_mul_f32 v64, v64, v36
  v_mfma_f32_16x16x32_bf16 v[56:59], a[112:115], v[40:43], v[56:59]
  v_mul_f32 v65, v65, v37
  v_mfma_f32_16x16x32_bf16 v[60:63], a[116:119], v[40:43], v[60:63]
  v_mul_f32 v66, v66, v38
  s_waitcnt lgkmcnt(2)
  v_mfma_f32_16x16x32_bf16 v[80:83], a[120:123], v[44:47], v[80:83]
  ds_read_b128 v[40:43], v8 offset:40960
  v_mfma_f32_16x16x32_bf16 v[84:87], a[124:127], v[44:47], v[84:87]
  v_mul_f32 v67, v67, v39
  v_mfma_f32_16x16x32_bf16 v[72:75], a[128:131], v[44:47], v[72:75]
  v_fma_f32 v68, v68, v24, v32
  v_mfma_f32_16x16x32_bf16 v[76:79], a[132:135], v[44:47], v[76:79]
  v_fma_f32 v69, v69, v25, v33
  v_mfma_f32_16x16x32_bf16 v[56:59], a[136:139], v[44:47], v[56:59]
  v_fma_f32 v70, v70, v26, v34
  v_mfma_f32_16x16x32_bf16 v[60:63], a[140:143], v[44:47], v[60:63]
  v_fma_f32 v71, v71, v27, v35
  s_waitcnt lgkmcnt(2)
  v_mfma_f32_16x16x32_bf16 v[80:83], a[144:147], v[48:51], v[80:83]
  ds_read_b128 v[44:47], v9 offset:40960
  v_mfma_f32_16x16x32_bf16 v[84:87], a[148:151], v[48:51], v[84:87]
  v_exp_f32 v36, v68
  v_mfma_f32_16x16x32_bf16 v[72:75], a[152:155], v[48:51], v[72:75]
  v_exp_f32 v37, v69
  v_mfma_f32_16x16x32_bf16 v[76:79], a[156:159], v[48:51], v[76:79]
  v_exp_f32 v38, v70
  v_mfma_f32_16x16x32_bf16 v[56:59], a[160:163], v[48:51], v[56:59]
  s_add_u32 m0, s36, 40960
  s_add_u32 s37, s86, 25600
  v_mfma_f32_16x16x32_bf16 v[60:63], a[164:167], v[48:51], v[60:63]
  buffer_load_dwordx4 v15, s[8:11], s37 offen nt lds
  s_waitcnt lgkmcnt(2)
  v_mfma_f32_16x16x32_bf16 v[80:83], a[168:171], v[52:55], v[80:83]
  ds_read_b128 v[48:51], v10 offset:40960
  v_mfma_f32_16x16x32_bf16 v[84:87], a[172:175], v[52:55], v[84:87]
  v_exp_f32 v39, v71
  v_mfma_f32_16x16x32_bf16 v[72:75], a[176:179], v[52:55], v[72:75]
  v_fma_f32 v36, v36, s54, s54
  v_mfma_f32_16x16x32_bf16 v[76:79], a[180:183], v[52:55], v[76:79]
  v_fma_f32 v37, v37, s54, s54
  v_mfma_f32_16x16x32_bf16 v[56:59], a[184:187], v[52:55], v[56:59]
  v_fma_f32 v38, v38, s54, s54
  v_mfma_f32_16x16x32_bf16 v[60:63], a[188:191], v[52:55], v[60:63]
  v_fma_f32 v39, v39, s54, s54
  s_waitcnt lgkmcnt(2)
  v_mfma_f32_16x16x32_bf16 v[80:83], a[192:195], v[40:43], v[80:83]
  ds_read_b128 v[52:55], v11 offset:40960
  v_mfma_f32_16x16x32_bf16 v[84:87], a[196:199], v[40:43], v[84:87]
  v_rcp_f32 v36, v36
  v_mfma_f32_16x16x32_bf16 v[72:75], a[200:203], v[40:43], v[72:75]
  v_rcp_f32 v37, v37
  v_mfma_f32_16x16x32_bf16 v[76:79], a[204:207], v[40:43], v[76:79]
  v_rcp_f32 v38, v38
  v_mfma_f32_16x16x32_bf16 v[56:59], a[208:211], v[40:43], v[56:59]
  v_rcp_f32 v39, v39
  v_mfma_f32_16x16x32_bf16 v[60:63], a[212:215], v[40:43], v[60:63]
  v_mul_f32 v68, v68, v36
  s_waitcnt lgkmcnt(2)
  v_mfma_f32_16x16x32_bf16 v[80:83], a[216:219], v[44:47], v[80:83]
  ds_read_b128 v[40:43], v8 offset:45056
  v_mfma_f32_16x16x32_bf16 v[84:87], a[220:223], v[44:47], v[84:87]
  v_mul_f32 v69, v69, v37
  v_mfma_f32_16x16x32_bf16 v[72:75], a[224:227], v[44:47], v[72:75]
  v_mul_f32 v70, v70, v38
  v_mfma_f32_16x16x32_bf16 v[76:79], a[228:231], v[44:47], v[76:79]
  v_mul_f32 v71, v71, v39
  v_mfma_f32_16x16x32_bf16 v[56:59], a[232:235], v[44:47], v[56:59]
  v_cvt_pk_bf16_f32 v64, v64, v65
  v_mfma_f32_16x16x32_bf16 v[60:63], a[236:239], v[44:47], v[60:63]
  v_cvt_pk_bf16_f32 v65, v66, v67
  s_waitcnt lgkmcnt(2)
  v_mfma_f32_16x16x32_bf16 v[80:83], a[240:243], v[48:51], v[80:83]
  ds_read_b128 v[44:47], v9 offset:45056
  s_add_u32 m0, s36, 61440
  v_mfma_f32_16x16x32_bf16 v[84:87], a[244:247], v[48:51], v[84:87]
  s_add_u32 s37, s87, 25600
  buffer_load_dwordx4 v15, s[8:11], s37 offen nt lds
  v_mfma_f32_16x16x32_bf16 v[72:75], a[248:251], v[48:51], v[72:75]
  v_cvt_pk_bf16_f32 v66, v68, v69
  v_mfma_f32_16x16x32_bf16 v[76:79], a[252:255], v[48:51], v[76:79]
  v_cvt_pk_bf16_f32 v67, v70, v71
  s_mov_b32 s38, 18432
  v_mfma_f32_16x16x32_bf16 v[56:59], v[128:131], v[48:51], v[56:59]
  buffer_store_dwordx4 v[64:67], v17, s[16:19], s38 offen sc1
  v_mfma_f32_16x16x32_bf16 v[60:63], v[132:135], v[48:51], v[60:63]
  s_waitcnt lgkmcnt(2)
  v_mfma_f32_16x16x32_bf16 v[80:83], v[136:139], v[52:55], v[80:83]
  ds_read_b128 v[48:51], v10 offset:45056
  v_mfma_f32_16x16x32_bf16 v[84:87], v[140:143], v[52:55], v[84:87]
  v_mfma_f32_16x16x32_bf16 v[72:75], v[144:147], v[52:55], v[72:75]
  v_mfma_f32_16x16x32_bf16 v[76:79], v[148:151], v[52:55], v[76:79]
  v_mfma_f32_16x16x32_bf16 v[56:59], v[152:155], v[52:55], v[56:59]
  v_mfma_f32_16x16x32_bf16 v[60:63], v[156:159], v[52:55], v[60:63]
  s_waitcnt lgkmcnt(2)
  v_mfma_f32_16x16x32_bf16 v[80:83], v[160:163], v[40:43], v[80:83]
  ds_read_b128 v[52:55], v11 offset:45056
  v_mfma_f32_16x16x32_bf16 v[84:87], v[164:167], v[40:43], v[84:87]
  v_mfma_f32_16x16x32_bf16 v[72:75], v[168:171], v[40:43], v[72:75]
  v_mfma_f32_16x16x32_bf16 v[76:79], v[172:175], v[40:43], v[76:79]
  v_mfma_f32_16x16x32_bf16 v[56:59], v[176:179], v[40:43], v[56:59]
  v_mfma_f32_16x16x32_bf16 v[60:63], v[180:183], v[40:43], v[60:63]
  s_waitcnt lgkmcnt(2)
  v_mfma_f32_16x16x32_bf16 v[80:83], v[184:187], v[44:47], v[80:83]
  ds_read_b128 v[40:43], v8 offset:49152
  v_mfma_f32_16x16x32_bf16 v[84:87], v[188:191], v[44:47], v[84:87]
  v_mfma_f32_16x16x32_bf16 v[72:75], v[192:195], v[44:47], v[72:75]
  s_add_u32 m0, s36, 65536
  s_add_u32 s37, s84, 26624
  v_mfma_f32_16x16x32_bf16 v[76:79], v[196:199], v[44:47], v[76:79]
  buffer_load_dwordx4 v15, s[8:11], s37 offen nt lds
  v_mfma_f32_16x16x32_bf16 v[56:59], v[200:203], v[44:47], v[56:59]
  v_mfma_f32_16x16x32_bf16 v[60:63], v[204:207], v[44:47], v[60:63]
  s_waitcnt lgkmcnt(2)
  v_mfma_f32_16x16x32_bf16 v[80:83], v[208:211], v[48:51], v[80:83]
  ds_read_b128 v[44:47], v9 offset:49152
  v_mfma_f32_16x16x32_bf16 v[84:87], v[212:215], v[48:51], v[84:87]
  v_mfma_f32_16x16x32_bf16 v[72:75], v[216:219], v[48:51], v[72:75]
  v_mfma_f32_16x16x32_bf16 v[76:79], v[220:223], v[48:51], v[76:79]
  v_mfma_f32_16x16x32_bf16 v[56:59], v[224:227], v[48:51], v[56:59]
  v_mfma_f32_16x16x32_bf16 v[60:63], v[228:231], v[48:51], v[60:63]
  s_waitcnt lgkmcnt(2)
  v_mfma_f32_16x16x32_bf16 v[80:83], v[232:235], v[52:55], v[80:83]
  ds_read_b128 v[48:51], v10 offset:49152
  v_mfma_f32_16x16x32_bf16 v[84:87], v[236:239], v[52:55], v[84:87]
  v_mfma_f32_16x16x32_bf16 v[72:75], v[240:243], v[52:55], v[72:75]
  v_mfma_f32_16x16x32_bf16 v[76:79], v[244:247], v[52:55], v[76:79]
  v_mfma_f32_16x16x32_bf16 v[56:59], v[248:251], v[52:55], v[56:59]
  v_mfma_f32_16x16x32_bf16 v[60:63], v[252:255], v[52:55], v[60:63]
  s_waitcnt lgkmcnt(2)
  v_mfma_f32_16x16x32_bf16 v[88:91], a[0:3], v[40:43], 0
  ds_read_b128 v[52:55], v11 offset:49152
  v_mfma_f32_16x16x32_bf16 v[92:95], a[4:7], v[40:43], 0
  v_mfma_f32_16x16x32_bf16 v[80:83], a[8:11], v[40:43], v[80:83]
  v_mfma_f32_16x16x32_bf16 v[84:87], a[12:15], v[40:43], v[84:87]
  v_mfma_f32_16x16x32_bf16 v[72:75], a[16:19], v[40:43], v[72:75]
  s_add_u32 m0, s36, 16384
  s_add_u32 s37, s85, 26624
  v_mfma_f32_16x16x32_bf16 v[76:79], a[20:23], v[40:43], v[76:79]
  buffer_load_dwordx4 v15, s[8:11], s37 offen nt lds
  s_waitcnt lgkmcnt(2)
  v_mfma_f32_16x16x32_bf16 v[88:91], a[24:27], v[44:47], v[88:91]
  ds_read_b128 v[40:43], v4 offset:20480
  v_fma_f32 v56, v56, v20, v28
  v_mfma_f32_16x16x32_bf16 v[92:95], a[28:31], v[44:47], v[92:95]
  v_fma_f32 v57, v57, v21, v29
  v_mfma_f32_16x16x32_bf16 v[80:83], a[32:35], v[44:47], v[80:83]
  v_fma_f32 v58, v58, v22, v30
  v_mfma_f32_16x16x32_bf16 v[84:87], a[36:39], v[44:47], v[84:87]
  v_fma_f32 v59, v59, v23, v31
  v_mfma_f32_16x16x32_bf16 v[72:75], a[40:43], v[44:47], v[72:75]
  v_exp_f32 v36, v56
  v_mfma_f32_16x16x32_bf16 v[76:79], a[44:47], v[44:47], v[76:79]
  s_waitcnt lgkmcnt(2)
  v_mfma_f32_16x16x32_bf16 v[88:91], a[48:51], v[48:51], v[88:91]
  ds_read_b128 v[44:47], v5 offset:20480
  v_mfma_f32_16x16x32_bf16 v[92:95], a[52:55], v[48:51], v[92:95]
  v_exp_f32 v37, v57
  v_mfma_f32_16x16x32_bf16 v[80:83], a[56:59], v[48:51], v[80:83]
  v_exp_f32 v38, v58
  v_mfma_f32_16x16x32_bf16 v[84:87], a[60:63], v[48:51], v[84:87]
  v_exp_f32 v39, v59
  v_mfma_f32_16x16x32_bf16 v[72:75], a[64:67], v[48:51], v[72:75]
  v_fma_f32 v36, v36, s54, s54
  v_mfma_f32_16x16x32_bf16 v[76:79], a[68:71], v[48:51], v[76:79]
  v_fma_f32 v37, v37, s54, s54
  s_waitcnt lgkmcnt(2)
  v_mfma_f32_16x16x32_bf16 v[88:91], a[72:75], v[52:55], v[88:91]
  ds_read_b128 v[48:51], v6 offset:20480
  v_mfma_f32_16x16x32_bf16 v[92:95], a[76:79], v[52:55], v[92:95]
  v_fma_f32 v38, v38, s54, s54
  v_mfma_f32_16x16x32_bf16 v[80:83], a[80:83], v[52:55], v[80:83]
  v_fma_f32 v39, v39, s54, s54
  v_mfma_f32_16x16x32_bf16 v[84:87], a[84:87], v[52:55], v[84:87]
  v_rcp_f32 v36, v36
  v_mfma_f32_16x16x32_bf16 v[72:75], a[88:91], v[52:55], v[72:75]
  v_rcp_f32 v37, v37
  v_mfma_f32_16x16x32_bf16 v[76:79], a[92:95], v[52:55], v[76:79]
  s_waitcnt lgkmcnt(2)
  v_mfma_f32_16x16x32_bf16 v[88:91], a[96:99], v[40:43], v[88:91]
  ds_read_b128 v[52:55], v7 offset:20480
  s_add_u32 m0, s36, 98304
  v_mfma_f32_16x16x32_bf16 v[92:95], a[100:103], v[40:43], v[92:95]
  s_add_u32 s37, s86, 26624
  buffer_load_dwordx4 v15, s[8:11], s37 offen nt lds
  v_mfma_f32_16x16x32_bf16 v[80:83], a[104:107], v[40:43], v[80:83]
  v_rcp_f32 v38, v38
  v_mfma_f32_16x16x32_bf16 v[84:87], a[108:111], v[40:43], v[84:87]
  v_rcp_f32 v39, v39
  v_mfma_f32_16x16x32_bf16 v[72:75], a[112:115], v[40:43], v[72:75]
  v_mul_f32 v56, v56, v36
  v_mfma_f32_16x16x32_bf16 v[76:79], a[116:119], v[40:43], v[76:79]
  v_mul_f32 v57, v57, v37
  s_waitcnt lgkmcnt(2)
  v_mfma_f32_16x16x32_bf16 v[88:91], a[120:123], v[44:47], v[88:91]
  ds_read_b128 v[40:43], v4 offset:12288
  v_mfma_f32_16x16x32_bf16 v[92:95], a[124:127], v[44:47], v[92:95]
  v_mul_f32 v58, v58, v38
  v_mfma_f32_16x16x32_bf16 v[80:83], a[128:131], v[44:47], v[80:83]
  v_mul_f32 v59, v59, v39
  v_mfma_f32_16x16x32_bf16 v[84:87], a[132:135], v[44:47], v[84:87]
  v_fma_f32 v60, v60, v24, v32
  v_mfma_f32_16x16x32_bf16 v[72:75], a[136:139], v[44:47], v[72:75]
  v_fma_f32 v61, v61, v25, v33
  v_mfma_f32_16x16x32_bf16 v[76:79], a[140:143], v[44:47], v[76:79]
  v_fma_f32 v62, v62, v26, v34
  s_waitcnt lgkmcnt(2)
  v_mfma_f32_16x16x32_bf16 v[88:91], a[144:147], v[48:51], v[88:91]
  ds_read_b128 v[44:47], v5 offset:12288
  v_mfma_f32_16x16x32_bf16 v[92:95], a[148:151], v[48:51], v[92:95]
  v_fma_f32 v63, v63, v27, v35
  v_mfma_f32_16x16x32_bf16 v[80:83], a[152:155], v[48:51], v[80:83]
  v_exp_f32 v36, v60
  v_mfma_f32_16x16x32_bf16 v[84:87], a[156:159], v[48:51], v[84:87]
  v_exp_f32 v37, v61
  v_mfma_f32_16x16x32_bf16 v[72:75], a[160:163], v[48:51], v[72:75]
  v_exp_f32 v38, v62
  v_mfma_f32_16x16x32_bf16 v[76:79], a[164:167], v[48:51], v[76:79]
  s_waitcnt lgkmcnt(2)
  v_mfma_f32_16x16x32_bf16 v[88:91], a[168:171], v[52:55], v[88:91]
  ds_read_b128 v[48:51], v6 offset:12288
  v_mfma_f32_16x16x32_bf16 v[92:95], a[172:175], v[52:55], v[92:95]
  v_exp_f32 v39, v63
  v_mfma_f32_16x16x32_bf16 v[80:83], a[176:179], v[52:55], v[80:83]
  s_add_u32 m0, s36, 45056
  s_add_u32 s37, s87, 26624
  v_mfma_f32_16x16x32_bf16 v[84:87], a[180:183], v[52:55], v[84:87]
  buffer_load_dwordx4 v15, s[8:11], s37 offen nt lds
  v_mfma_f32_16x16x32_bf16 v[72:75], a[184:187], v[52:55], v[72:75]
  v_fma_f32 v36, v36, s54, s54
  v_mfma_f32_16x16x32_bf16 v[76:79], a[188:191], v[52:55], v[76:79]
  v_fma_f32 v37, v37, s54, s54
  s_waitcnt lgkmcnt(2)
  v_mfma_f32_16x16x32_bf16 v[88:91], a[192:195], v[40:43], v[88:91]
  ds_read_b128 v[52:55], v7 offset:12288
  v_mfma_f32_16x16x32_bf16 v[92:95], a[196:199], v[40:43], v[92:95]
  v_fma_f32 v38, v38, s54, s54
  v_mfma_f32_16x16x32_bf16 v[80:83], a[200:203], v[40:43], v[80:83]
  v_fma_f32 v39, v39, s54, s54
  v_mfma_f32_16x16x32_bf16 v[84:87], a[204:207], v[40:43], v[84:87]
  v_rcp_f32 v36, v36
  v_mfma_f32_16x16x32_bf16 v[72:75], a[208:211], v[40:43], v[72:75]
  v_rcp_f32 v37, v37
  v_mfma_f32_16x16x32_bf16 v[76:79], a[212:215], v[40:43], v[76:79]
  s_waitcnt lgkmcnt(2)
  v_mfma_f32_16x16x32_bf16 v[88:91], a[216:219], v[44:47], v[88:91]
  ds_read_b128 v[40:43], v4 offset:49152
  v_mfma_f32_16x16x32_bf16 v[92:95], a[220:223], v[44:47], v[92:95]
  v_rcp_f32 v38, v38
  v_mfma_f32_16x16x32_bf16 v[80:83], a[224:227], v[44:47], v[80:83]
  v_rcp_f32 v39, v39
  v_mfma_f32_16x16x32_bf16 v[84:87], a[228:231], v[44:47], v[84:87]
  v_mul_f32 v60, v60, v36
  v_mfma_f32_16x16x32_bf16 v[72:75], a[232:235], v[44:47], v[72:75]
  v_mul_f32 v61, v61, v37
  v_mfma_f32_16x16x32_bf16 v[76:79], a[236:239], v[44:47], v[76:79]
  v_mul_f32 v62, v62, v38
  s_waitcnt lgkmcnt(2)
  v_mfma_f32_16x16x32_bf16 v[88:91], a[240:243], v[48:51], v[88:91]
  ds_read_b128 v[44:47], v5 offset:49152
  v_mfma_f32_16x16x32_bf16 v[92:95], a[244:247], v[48:51], v[92:95]
  v_mul_f32 v63, v63, v39
  v_mfma_f32_16x16x32_bf16 v[80:83], a[248:251], v[48:51], v[80:83]
  v_cvt_pk_bf16_f32 v56, v56, v57
  v_mfma_f32_16x16x32_bf16 v[84:87], a[252:255], v[48:51], v[84:87]
  v_cvt_pk_bf16_f32 v57, v58, v59
  v_mfma_f32_16x16x32_bf16 v[72:75], v[128:131], v[48:51], v[72:75]
  s_add_u32 m0, s36, 81920
  s_add_u32 s37, s84, 27648
  v_mfma_f32_16x16x32_bf16 v[76:79], v[132:135], v[48:51], v[76:79]
  buffer_load_dwordx4 v15, s[8:11], s37 offen nt lds
  s_waitcnt lgkmcnt(2)
  v_mfma_f32_16x16x32_bf16 v[88:91], v[136:139], v[52:55], v[88:91]
  ds_read_b128 v[48:51], v6 offset:49152
  v_mfma_f32_16x16x32_bf16 v[92:95], v[140:143], v[52:55], v[92:95]
  v_cvt_pk_bf16_f32 v58, v60, v61
  v_mfma_f32_16x16x32_bf16 v[80:83], v[144:147], v[52:55], v[80:83]
  v_cvt_pk_bf16_f32 v59, v62, v63
  s_mov_b32 s38, 19456
  v_mfma_f32_16x16x32_bf16 v[84:87], v[148:151], v[52:55], v[84:87]
  buffer_store_dwordx4 v[56:59], v17, s[16:19], s38 offen sc1
  v_mfma_f32_16x16x32_bf16 v[72:75], v[152:155], v[52:55], v[72:75]
  v_mfma_f32_16x16x32_bf16 v[76:79], v[156:159], v[52:55], v[76:79]
  s_waitcnt lgkmcnt(2)
  v_mfma_f32_16x16x32_bf16 v[88:91], v[160:163], v[40:43], v[88:91]
  ds_read_b128 v[52:55], v7 offset:49152
  v_mfma_f32_16x16x32_bf16 v[92:95], v[164:167], v[40:43], v[92:95]
  v_mfma_f32_16x16x32_bf16 v[80:83], v[168:171], v[40:43], v[80:83]
  v_mfma_f32_16x16x32_bf16 v[84:87], v[172:175], v[40:43], v[84:87]
  v_mfma_f32_16x16x32_bf16 v[72:75], v[176:179], v[40:43], v[72:75]
  v_mfma_f32_16x16x32_bf16 v[76:79], v[180:183], v[40:43], v[76:79]
  s_waitcnt lgkmcnt(2)
  v_mfma_f32_16x16x32_bf16 v[88:91], v[184:187], v[44:47], v[88:91]
  ds_read_b128 v[40:43], v4 offset:24576
  v_mfma_f32_16x16x32_bf16 v[92:95], v[188:191], v[44:47], v[92:95]
  v_mfma_f32_16x16x32_bf16 v[80:83], v[192:195], v[44:47], v[80:83]
  v_mfma_f32_16x16x32_bf16 v[84:87], v[196:199], v[44:47], v[84:87]
  v_mfma_f32_16x16x32_bf16 v[72:75], v[200:203], v[44:47], v[72:75]
  v_mfma_f32_16x16x32_bf16 v[76:79], v[204:207], v[44:47], v[76:79]
  s_waitcnt lgkmcnt(2)
  v_mfma_f32_16x16x32_bf16 v[88:91], v[208:211], v[48:51], v[88:91]
  ds_read_b128 v[44:47], v5 offset:24576
  v_mfma_f32_16x16x32_bf16 v[92:95], v[212:215], v[48:51], v[92:95]
  v_mfma_f32_16x16x32_bf16 v[80:83], v[216:219], v[48:51], v[80:83]
  v_mfma_f32_16x16x32_bf16 v[84:87], v[220:223], v[48:51], v[84:87]
  v_mfma_f32_16x16x32_bf16 v[72:75], v[224:227], v[48:51], v[72:75]
  v_mfma_f32_16x16x32_bf16 v[76:79], v[228:231], v[48:51], v[76:79]
  s_waitcnt lgkmcnt(2)
  v_mfma_f32_16x16x32_bf16 v[88:91], v[232:235], v[52:55], v[88:91]
  ds_read_b128 v[48:51], v6 offset:24576
  v_mfma_f32_16x16x32_bf16 v[92:95], v[236:239], v[52:55], v[92:95]
  v_mfma_f32_16x16x32_bf16 v[80:83], v[240:243], v[52:55], v[80:83]
  v_mfma_f32_16x16x32_bf16 v[84:87], v[244:247], v[52:55], v[84:87]
  v_mfma_f32_16x16x32_bf16 v[72:75], v[248:251], v[52:55], v[72:75]
  v_mfma_f32_16x16x32_bf16 v[76:79], v[252:255], v[52:55], v[76:79]
  s_waitcnt lgkmcnt(2)
  v_mfma_f32_16x16x32_bf16 v[96:99], a[0:3], v[40:43], 0
  ds_read_b128 v[52:55], v7 offset:24576
  v_mfma_f32_16x16x32_bf16 v[100:103], a[4:7], v[40:43], 0
  v_mfma_f32_16x16x32_bf16 v[88:91], a[8:11], v[40:43], v[88:91]
  v_mfma_f32_16x16x32_bf16 v[92:95], a[12:15], v[40:43], v[92:95]
  v_mfma_f32_16x16x32_bf16 v[80:83], a[16:19], v[40:43], v[80:83]
  v_mfma_f32_16x16x32_bf16 v[84:87], a[20:23], v[40:43], v[84:87]
  s_waitcnt lgkmcnt(2)
  v_mfma_f32_16x16x32_bf16 v[96:99], a[24:27], v[44:47], v[96:99]
  ds_read_b128 v[40:43], v4 offset:28672
  v_fma_f32 v72, v72, v20, v28
  v_mfma_f32_16x16x32_bf16 v[100:103], a[28:31], v[44:47], v[100:103]
  v_fma_f32 v73, v73, v21, v29
  v_mfma_f32_16x16x32_bf16 v[88:91], a[32:35], v[44:47], v[88:91]
  v_fma_f32 v74, v74, v22, v30
  v_mfma_f32_16x16x32_bf16 v[92:95], a[36:39], v[44:47], v[92:95]
  v_fma_f32 v75, v75, v23, v31
  v_mfma_f32_16x16x32_bf16 v[80:83], a[40:43], v[44:47], v[80:83]
  v_exp_f32 v36, v72
  v_mfma_f32_16x16x32_bf16 v[84:87], a[44:47], v[44:47], v[84:87]
  s_waitcnt lgkmcnt(2)
  v_mfma_f32_16x16x32_bf16 v[96:99], a[48:51], v[48:51], v[96:99]
  ds_read_b128 v[44:47], v5 offset:28672
  v_mfma_f32_16x16x32_bf16 v[100:103], a[52:55], v[48:51], v[100:103]
  v_exp_f32 v37, v73
  v_mfma_f32_16x16x32_bf16 v[88:91], a[56:59], v[48:51], v[88:91]
  v_exp_f32 v38, v74
  v_mfma_f32_16x16x32_bf16 v[92:95], a[60:63], v[48:51], v[92:95]
  v_exp_f32 v39, v75
  v_mfma_f32_16x16x32_bf16 v[80:83], a[64:67], v[48:51], v[80:83]
  v_fma_f32 v36, v36, s54, s54
  v_mfma_f32_16x16x32_bf16 v[84:87], a[68:71], v[48:51], v[84:87]
  v_fma_f32 v37, v37, s54, s54
  s_waitcnt lgkmcnt(2)
  v_mfma_f32_16x16x32_bf16 v[96:99], a[72:75], v[52:55], v[96:99]
  ds_read_b128 v[48:51], v6 offset:28672
  v_mfma_f32_16x16x32_bf16 v[100:103], a[76:79], v[52:55], v[100:103]
  v_fma_f32 v38, v38, s54, s54
  v_mfma_f32_16x16x32_bf16 v[88:91], a[80:83], v[52:55], v[88:91]
  v_fma_f32 v39, v39, s54, s54
  v_mfma_f32_16x16x32_bf16 v[92:95], a[84:87], v[52:55], v[92:95]
  v_rcp_f32 v36, v36
  v_mfma_f32_16x16x32_bf16 v[80:83], a[88:91], v[52:55], v[80:83]
  v_rcp_f32 v37, v37
  v_mfma_f32_16x16x32_bf16 v[84:87], a[92:95], v[52:55], v[84:87]
  s_waitcnt lgkmcnt(2)
  v_mfma_f32_16x16x32_bf16 v[96:99], a[96:99], v[40:43], v[96:99]
  ds_read_b128 v[52:55], v7 offset:28672
  v_mfma_f32_16x16x32_bf16 v[100:103], a[100:103], v[40:43], v[100:103]
  v_rcp_f32 v38, v38
  v_mfma_f32_16x16x32_bf16 v[88:91], a[104:107], v[40:43], v[88:91]
  v_rcp_f32 v39, v39
  v_mfma_f32_16x16x32_bf16 v[92:95], a[108:111], v[40:43], v[92:95]
  v_mul_f32 v72, v72, v36
  v_mfma_f32_16x16x32_bf16 v[80:83], a[112:115], v[40:43], v[80:83]
  v_mul_f32 v73, v73, v37
  v_mfma_f32_16x16x32_bf16 v[84:87], a[116:119], v[40:43], v[84:87]
  v_mul_f32 v74, v74, v38
  s_waitcnt lgkmcnt(2)
  v_mfma_f32_16x16x32_bf16 v[96:99], a[120:123], v[44:47], v[96:99]
  ds_read_b128 v[40:43], v8 offset:53248
  v_mfma_f32_16x16x32_bf16 v[100:103], a[124:127], v[44:47], v[100:103]
  v_mul_f32 v75, v75, v39
  v_mfma_f32_16x16x32_bf16 v[88:91], a[128:131], v[44:47], v[88:91]
  v_fma_f32 v76, v76, v24, v32
  v_mfma_f32_16x16x32_bf16 v[92:95], a[132:135], v[44:47], v[92:95]
  v_fma_f32 v77, v77, v25, v33
  v_mfma_f32_16x16x32_bf16 v[80:83], a[136:139], v[44:47], v[80:83]
  v_fma_f32 v78, v78, v26, v34
  v_mfma_f32_16x16x32_bf16 v[84:87], a[140:143], v[44:47], v[84:87]
  v_fma_f32 v79, v79, v27, v35
  s_waitcnt vmcnt(8)
  s_barrier
  s_waitcnt lgkmcnt(2)
  v_mfma_f32_16x16x32_bf16 v[96:99], a[144:147], v[48:51], v[96:99]
  ds_read_b128 v[44:47], v9 offset:53248
  s_add_u32 m0, s36, 86016
  v_mfma_f32_16x16x32_bf16 v[100:103], a[148:151], v[48:51], v[100:103]
  s_add_u32 s37, s85, 27648
  buffer_load_dwordx4 v15, s[8:11], s37 offen nt lds
  v_mfma_f32_16x16x32_bf16 v[88:91], a[152:155], v[48:51], v[88:91]
  v_exp_f32 v36, v76
  v_mfma_f32_16x16x32_bf16 v[92:95], a[156:159], v[48:51], v[92:95]
  v_exp_f32 v37, v77
  v_mfma_f32_16x16x32_bf16 v[80:83], a[160:163], v[48:51], v[80:83]
  v_exp_f32 v38, v78
  v_mfma_f32_16x16x32_bf16 v[84:87], a[164:167], v[48:51], v[84:87]
  s_waitcnt lgkmcnt(2)
  v_mfma_f32_16x16x32_bf16 v[96:99], a[168:171], v[52:55], v[96:99]
  ds_read_b128 v[48:51], v10 offset:53248
  v_mfma_f32_16x16x32_bf16 v[100:103], a[172:175], v[52:55], v[100:103]
  v_exp_f32 v39, v79
  v_mfma_f32_16x16x32_bf16 v[88:91], a[176:179], v[52:55], v[88:91]
  v_fma_f32 v36, v36, s54, s54
  v_mfma_f32_16x16x32_bf16 v[92:95], a[180:183], v[52:55], v[92:95]
  v_fma_f32 v37, v37, s54, s54
  v_mfma_f32_16x16x32_bf16 v[80:83], a[184:187], v[52:55], v[80:83]
  v_fma_f32 v38, v38, s54, s54
  v_mfma_f32_16x16x32_bf16 v[84:87], a[188:191], v[52:55], v[84:87]
  v_fma_f32 v39, v39, s54, s54
  s_waitcnt lgkmcnt(2)
  v_mfma_f32_16x16x32_bf16 v[96:99], a[192:195], v[40:43], v[96:99]
  ds_read_b128 v[52:55], v11 offset:53248
  v_mfma_f32_16x16x32_bf16 v[100:103], a[196:199], v[40:43], v[100:103]
  v_rcp_f32 v36, v36
  v_mfma_f32_16x16x32_bf16 v[88:91], a[200:203], v[40:43], v[88:91]
  v_rcp_f32 v37, v37
  v_mfma_f32_16x16x32_bf16 v[92:95], a[204:207], v[40:43], v[92:95]
  v_rcp_f32 v38, v38
  v_mfma_f32_16x16x32_bf16 v[80:83], a[208:211], v[40:43], v[80:83]
  v_rcp_f32 v39, v39
  v_mfma_f32_16x16x32_bf16 v[84:87], a[212:215], v[40:43], v[84:87]
  v_mul_f32 v76, v76, v36
  s_waitcnt lgkmcnt(2)
  v_mfma_f32_16x16x32_bf16 v[96:99], a[216:219], v[44:47], v[96:99]
  ds_read_b128 v[40:43], v8 offset:24576
  v_mfma_f32_16x16x32_bf16 v[100:103], a[220:223], v[44:47], v[100:103]
  v_mul_f32 v77, v77, v37
  v_mfma_f32_16x16x32_bf16 v[88:91], a[224:227], v[44:47], v[88:91]
  s_add_u32 m0, s36, 102400
  s_add_u32 s37, s86, 27648
  v_mfma_f32_16x16x32_bf16 v[92:95], a[228:231], v[44:47], v[92:95]
  buffer_load_dwordx4 v15, s[8:11], s37 offen nt lds
  v_mfma_f32_16x16x32_bf16 v[80:83], a[232:235], v[44:47], v[80:83]
  v_mul_f32 v78, v78, v38
  v_mfma_f32_16x16x32_bf16 v[84:87], a[236:239], v[44:47], v[84:87]
  v_mul_f32 v79, v79, v39
  s_waitcnt lgkmcnt(2)
  v_mfma_f32_16x16x32_bf16 v[96:99], a[240:243], v[48:51], v[96:99]
  ds_read_b128 v[44:47], v9 offset:24576
  v_mfma_f32_16x16x32_bf16 v[100:103], a[244:247], v[48:51], v[100:103]
  v_cvt_pk_bf16_f32 v72, v72, v73
  v_mfma_f32_16x16x32_bf16 v[88:91], a[248:251], v[48:51], v[88:91]
  v_cvt_pk_bf16_f32 v73, v74, v75
  v_mfma_f32_16x16x32_bf16 v[92:95], a[252:255], v[48:51], v[92:95]
  v_cvt_pk_bf16_f32 v74, v76, v77
  v_mfma_f32_16x16x32_bf16 v[80:83], v[128:131], v[48:51], v[80:83]
  v_cvt_pk_bf16_f32 v75, v78, v79
  s_mov_b32 s38, 20480
  v_mfma_f32_16x16x32_bf16 v[84:87], v[132:135], v[48:51], v[84:87]
  buffer_store_dwordx4 v[72:75], v17, s[16:19], s38 offen sc1
  s_waitcnt lgkmcnt(2)
  v_mfma_f32_16x16x32_bf16 v[96:99], v[136:139], v[52:55], v[96:99]
  ds_read_b128 v[48:51], v10 offset:24576
  v_mfma_f32_16x16x32_bf16 v[100:103], v[140:143], v[52:55], v[100:103]
  v_mfma_f32_16x16x32_bf16 v[88:91], v[144:147], v[52:55], v[88:91]
  v_mfma_f32_16x16x32_bf16 v[92:95], v[148:151], v[52:55], v[92:95]
  v_mfma_f32_16x16x32_bf16 v[80:83], v[152:155], v[52:55], v[80:83]
  v_mfma_f32_16x16x32_bf16 v[84:87], v[156:159], v[52:55], v[84:87]
  s_waitcnt lgkmcnt(2)
  v_mfma_f32_16x16x32_bf16 v[96:99], v[160:163], v[40:43], v[96:99]
  ds_read_b128 v[52:55], v11 offset:24576
  v_mfma_f32_16x16x32_bf16 v[100:103], v[164:167], v[40:43], v[100:103]
  v_mfma_f32_16x16x32_bf16 v[88:91], v[168:171], v[40:43], v[88:91]
  v_mfma_f32_16x16x32_bf16 v[92:95], v[172:175], v[40:43], v[92:95]
  v_mfma_f32_16x16x32_bf16 v[80:83], v[176:179], v[40:43], v[80:83]
  s_add_u32 m0, s36, 69632
  s_add_u32 s37, s87, 27648
  v_mfma_f32_16x16x32_bf16 v[84:87], v[180:183], v[40:43], v[84:87]
  buffer_load_dwordx4 v15, s[8:11], s37 offen nt lds
  s_waitcnt lgkmcnt(2)
  v_mfma_f32_16x16x32_bf16 v[96:99], v[184:187], v[44:47], v[96:99]
  ds_read_b128 v[40:43], v8 offset:28672
  v_mfma_f32_16x16x32_bf16 v[100:103], v[188:191], v[44:47], v[100:103]
  v_mfma_f32_16x16x32_bf16 v[88:91], v[192:195], v[44:47], v[88:91]
  v_mfma_f32_16x16x32_bf16 v[92:95], v[196:199], v[44:47], v[92:95]
  v_mfma_f32_16x16x32_bf16 v[80:83], v[200:203], v[44:47], v[80:83]
  v_mfma_f32_16x16x32_bf16 v[84:87], v[204:207], v[44:47], v[84:87]
  s_waitcnt lgkmcnt(2)
  v_mfma_f32_16x16x32_bf16 v[96:99], v[208:211], v[48:51], v[96:99]
  ds_read_b128 v[44:47], v9 offset:28672
  v_mfma_f32_16x16x32_bf16 v[100:103], v[212:215], v[48:51], v[100:103]
  v_mfma_f32_16x16x32_bf16 v[88:91], v[216:219], v[48:51], v[88:91]
  v_mfma_f32_16x16x32_bf16 v[92:95], v[220:223], v[48:51], v[92:95]
  v_mfma_f32_16x16x32_bf16 v[80:83], v[224:227], v[48:51], v[80:83]
  v_mfma_f32_16x16x32_bf16 v[84:87], v[228:231], v[48:51], v[84:87]
  s_waitcnt lgkmcnt(2)
  v_mfma_f32_16x16x32_bf16 v[96:99], v[232:235], v[52:55], v[96:99]
  ds_read_b128 v[48:51], v10 offset:28672
  v_mfma_f32_16x16x32_bf16 v[100:103], v[236:239], v[52:55], v[100:103]
  v_mfma_f32_16x16x32_bf16 v[88:91], v[240:243], v[52:55], v[88:91]
  v_mfma_f32_16x16x32_bf16 v[92:95], v[244:247], v[52:55], v[92:95]
  v_mfma_f32_16x16x32_bf16 v[80:83], v[248:251], v[52:55], v[80:83]
  v_mfma_f32_16x16x32_bf16 v[84:87], v[252:255], v[52:55], v[84:87]
  s_waitcnt lgkmcnt(2)
  v_mfma_f32_16x16x32_bf16 v[104:107], a[0:3], v[40:43], 0
  ds_read_b128 v[52:55], v11 offset:28672
  s_add_u32 m0, s36, 73728
  v_mfma_f32_16x16x32_bf16 v[108:111], a[4:7], v[40:43], 0
  s_add_u32 s37, s84, 28672
  buffer_load_dwordx4 v15, s[8:11], s37 offen nt lds
  v_mfma_f32_16x16x32_bf16 v[96:99], a[8:11], v[40:43], v[96:99]
  v_mfma_f32_16x16x32_bf16 v[100:103], a[12:15], v[40:43], v[100:103]
  v_mfma_f32_16x16x32_bf16 v[88:91], a[16:19], v[40:43], v[88:91]
  v_fma_f32 v80, v80, v20, v28
  v_fma_f32 v81, v81, v21, v29
  v_mfma_f32_16x16x32_bf16 v[92:95], a[20:23], v[40:43], v[92:95]
  v_fma_f32 v82, v82, v22, v30
  s_waitcnt lgkmcnt(2)
  v_mfma_f32_16x16x32_bf16 v[104:107], a[24:27], v[44:47], v[104:107]
  ds_read_b128 v[40:43], v4 offset:0
  v_mfma_f32_16x16x32_bf16 v[108:111], a[28:31], v[44:47], v[108:111]
  v_fma_f32 v83, v83, v23, v31
  v_mfma_f32_16x16x32_bf16 v[96:99], a[32:35], v[44:47], v[96:99]
  v_exp_f32 v36, v80
  v_mfma_f32_16x16x32_bf16 v[100:103], a[36:39], v[44:47], v[100:103]
  v_exp_f32 v37, v81
  v_mfma_f32_16x16x32_bf16 v[88:91], a[40:43], v[44:47], v[88:91]
  v_exp_f32 v38, v82
  v_mfma_f32_16x16x32_bf16 v[92:95], a[44:47], v[44:47], v[92:95]
  s_waitcnt lgkmcnt(2)
  v_mfma_f32_16x16x32_bf16 v[104:107], a[48:51], v[48:51], v[104:107]
  ds_read_b128 v[44:47], v5 offset:0
  v_mfma_f32_16x16x32_bf16 v[108:111], a[52:55], v[48:51], v[108:111]
  v_exp_f32 v39, v83
  v_mfma_f32_16x16x32_bf16 v[96:99], a[56:59], v[48:51], v[96:99]
  v_fma_f32 v36, v36, s54, s54
  v_mfma_f32_16x16x32_bf16 v[100:103], a[60:63], v[48:51], v[100:103]
  v_fma_f32 v37, v37, s54, s54
  v_mfma_f32_16x16x32_bf16 v[88:91], a[64:67], v[48:51], v[88:91]
  v_fma_f32 v38, v38, s54, s54
  v_mfma_f32_16x16x32_bf16 v[92:95], a[68:71], v[48:51], v[92:95]
  v_fma_f32 v39, v39, s54, s54
  s_waitcnt lgkmcnt(2)
  v_mfma_f32_16x16x32_bf16 v[104:107], a[72:75], v[52:55], v[104:107]
  ds_read_b128 v[48:51], v6 offset:0
  v_mfma_f32_16x16x32_bf16 v[108:111], a[76:79], v[52:55], v[108:111]
  v_rcp_f32 v36, v36
  v_mfma_f32_16x16x32_bf16 v[96:99], a[80:83], v[52:55], v[96:99]
  s_add_u32 m0, s36, 77824
  s_add_u32 s37, s85, 28672
  v_mfma_f32_16x16x32_bf16 v[100:103], a[84:87], v[52:55], v[100:103]
  buffer_load_dwordx4 v15, s[8:11], s37 offen nt lds
  v_mfma_f32_16x16x32_bf16 v[88:91], a[88:91], v[52:55], v[88:91]
  v_rcp_f32 v37, v37
  v_mfma_f32_16x16x32_bf16 v[92:95], a[92:95], v[52:55], v[92:95]
  s_waitcnt lgkmcnt(2)
  v_mfma_f32_16x16x32_bf16 v[104:107], a[96:99], v[40:43], v[104:107]
  ds_read_b128 v[52:55], v7 offset:0
  v_mfma_f32_16x16x32_bf16 v[108:111], a[100:103], v[40:43], v[108:111]
  v_rcp_f32 v38, v38
  v_mfma_f32_16x16x32_bf16 v[96:99], a[104:107], v[40:43], v[96:99]
  v_rcp_f32 v39, v39
  v_mfma_f32_16x16x32_bf16 v[100:103], a[108:111], v[40:43], v[100:103]
  v_mul_f32 v80, v80, v36
  v_mfma_f32_16x16x32_bf16 v[88:91], a[112:115], v[40:43], v[88:91]
  v_mul_f32 v81, v81, v37
  v_mfma_f32_16x16x32_bf16 v[92:95], a[116:119], v[40:43], v[92:95]
  v_mul_f32 v82, v82, v38
  s_waitcnt lgkmcnt(2)
  v_mfma_f32_16x16x32_bf16 v[104:107], a[120:123], v[44:47], v[104:107]
  ds_read_b128 v[40:43], v4 offset:4096
  v_mfma_f32_16x16x32_bf16 v[108:111], a[124:127], v[44:47], v[108:111]
  v_mul_f32 v83, v83, v39
  v_mfma_f32_16x16x32_bf16 v[96:99], a[128:131], v[44:47], v[96:99]
  v_fma_f32 v84, v84, v24, v32
  v_mfma_f32_16x16x32_bf16 v[100:103], a[132:135], v[44:47], v[100:103]
  v_fma_f32 v85, v85, v25, v33
  v_mfma_f32_16x16x32_bf16 v[88:91], a[136:139], v[44:47], v[88:91]
  v_fma_f32 v86, v86, v26, v34
  v_mfma_f32_16x16x32_bf16 v[92:95], a[140:143], v[44:47], v[92:95]
  v_fma_f32 v87, v87, v27, v35
  s_waitcnt lgkmcnt(2)
  v_mfma_f32_16x16x32_bf16 v[104:107], a[144:147], v[48:51], v[104:107]
  ds_read_b128 v[44:47], v5 offset:4096
  v_mfma_f32_16x16x32_bf16 v[108:111], a[148:151], v[48:51], v[108:111]
  v_exp_f32 v36, v84
  v_mfma_f32_16x16x32_bf16 v[96:99], a[152:155], v[48:51], v[96:99]
  v_exp_f32 v37, v85
  v_mfma_f32_16x16x32_bf16 v[100:103], a[156:159], v[48:51], v[100:103]
  v_exp_f32 v38, v86
  v_mfma_f32_16x16x32_bf16 v[88:91], a[160:163], v[48:51], v[88:91]
  s_add_u32 m0, s36, 106496
  s_add_u32 s37, s86, 28672
  v_mfma_f32_16x16x32_bf16 v[92:95], a[164:167], v[48:51], v[92:95]
  buffer_load_dwordx4 v15, s[8:11], s37 offen nt lds
  s_waitcnt lgkmcnt(2)
  v_mfma_f32_16x16x32_bf16 v[104:107], a[168:171], v[52:55], v[104:107]
  ds_read_b128 v[48:51], v6 offset:4096
  v_mfma_f32_16x16x32_bf16 v[108:111], a[172:175], v[52:55], v[108:111]
  v_exp_f32 v39, v87
  v_mfma_f32_16x16x32_bf16 v[96:99], a[176:179], v[52:55], v[96:99]
  v_fma_f32 v36, v36, s54, s54
  v_mfma_f32_16x16x32_bf16 v[100:103], a[180:183], v[52:55], v[100:103]
  v_fma_f32 v37, v37, s54, s54
  v_mfma_f32_16x16x32_bf16 v[88:91], a[184:187], v[52:55], v[88:91]
  v_fma_f32 v38, v38, s54, s54
  v_mfma_f32_16x16x32_bf16 v[92:95], a[188:191], v[52:55], v[92:95]
  v_fma_f32 v39, v39, s54, s54
  s_waitcnt lgkmcnt(2)
  v_mfma_f32_16x16x32_bf16 v[104:107], a[192:195], v[40:43], v[104:107]
  ds_read_b128 v[52:55], v7 offset:4096
  v_mfma_f32_16x16x32_bf16 v[108:111], a[196:199], v[40:43], v[108:111]
  v_rcp_f32 v36, v36
  v_mfma_f32_16x16x32_bf16 v[96:99], a[200:203], v[40:43], v[96:99]
  v_rcp_f32 v37, v37
  v_mfma_f32_16x16x32_bf16 v[100:103], a[204:207], v[40:43], v[100:103]
  v_rcp_f32 v38, v38
  v_mfma_f32_16x16x32_bf16 v[88:91], a[208:211], v[40:43], v[88:91]
  v_rcp_f32 v39, v39
  v_mfma_f32_16x16x32_bf16 v[92:95], a[212:215], v[40:43], v[92:95]
  v_mul_f32 v84, v84, v36
  s_waitcnt lgkmcnt(2)
  v_mfma_f32_16x16x32_bf16 v[104:107], a[216:219], v[44:47], v[104:107]
  ds_read_b128 v[40:43], v4 offset:8192
  v_mfma_f32_16x16x32_bf16 v[108:111], a[220:223], v[44:47], v[108:111]
  v_mul_f32 v85, v85, v37
  v_mfma_f32_16x16x32_bf16 v[96:99], a[224:227], v[44:47], v[96:99]
  v_mul_f32 v86, v86, v38
  v_mfma_f32_16x16x32_bf16 v[100:103], a[228:231], v[44:47], v[100:103]
  v_mul_f32 v87, v87, v39
  v_mfma_f32_16x16x32_bf16 v[88:91], a[232:235], v[44:47], v[88:91]
  v_cvt_pk_bf16_f32 v80, v80, v81
  v_mfma_f32_16x16x32_bf16 v[92:95], a[236:239], v[44:47], v[92:95]
  v_cvt_pk_bf16_f32 v81, v82, v83
  s_waitcnt lgkmcnt(2)
  v_mfma_f32_16x16x32_bf16 v[104:107], a[240:243], v[48:51], v[104:107]
  ds_read_b128 v[44:47], v5 offset:8192
  s_add_u32 m0, s36, 110592
  v_mfma_f32_16x16x32_bf16 v[108:111], a[244:247], v[48:51], v[108:111]
  s_add_u32 s37, s87, 28672
  buffer_load_dwordx4 v15, s[8:11], s37 offen nt lds
  v_mfma_f32_16x16x32_bf16 v[96:99], a[248:251], v[48:51], v[96:99]
  v_cvt_pk_bf16_f32 v82, v84, v85
  v_mfma_f32_16x16x32_bf16 v[100:103], a[252:255], v[48:51], v[100:103]
  v_cvt_pk_bf16_f32 v83, v86, v87
  s_mov_b32 s38, 21504
  v_mfma_f32_16x16x32_bf16 v[88:91], v[128:131], v[48:51], v[88:91]
  buffer_store_dwordx4 v[80:83], v17, s[16:19], s38 offen sc1
  v_mfma_f32_16x16x32_bf16 v[92:95], v[132:135], v[48:51], v[92:95]
  s_waitcnt lgkmcnt(2)
  v_mfma_f32_16x16x32_bf16 v[104:107], v[136:139], v[52:55], v[104:107]
  ds_read_b128 v[48:51], v6 offset:8192
  v_mfma_f32_16x16x32_bf16 v[108:111], v[140:143], v[52:55], v[108:111]
  v_mfma_f32_16x16x32_bf16 v[96:99], v[144:147], v[52:55], v[96:99]
  v_mfma_f32_16x16x32_bf16 v[100:103], v[148:151], v[52:55], v[100:103]
  v_mfma_f32_16x16x32_bf16 v[88:91], v[152:155], v[52:55], v[88:91]
  v_mfma_f32_16x16x32_bf16 v[92:95], v[156:159], v[52:55], v[92:95]
  s_waitcnt lgkmcnt(2)
  v_mfma_f32_16x16x32_bf16 v[104:107], v[160:163], v[40:43], v[104:107]
  ds_read_b128 v[52:55], v7 offset:8192
  v_mfma_f32_16x16x32_bf16 v[108:111], v[164:167], v[40:43], v[108:111]
  v_mfma_f32_16x16x32_bf16 v[96:99], v[168:171], v[40:43], v[96:99]
  v_mfma_f32_16x16x32_bf16 v[100:103], v[172:175], v[40:43], v[100:103]
  v_mfma_f32_16x16x32_bf16 v[88:91], v[176:179], v[40:43], v[88:91]
  v_mfma_f32_16x16x32_bf16 v[92:95], v[180:183], v[40:43], v[92:95]
  s_waitcnt lgkmcnt(2)
  v_mfma_f32_16x16x32_bf16 v[104:107], v[184:187], v[44:47], v[104:107]
  ds_read_b128 v[40:43], v4 offset:53248
  v_mfma_f32_16x16x32_bf16 v[108:111], v[188:191], v[44:47], v[108:111]
  v_mfma_f32_16x16x32_bf16 v[96:99], v[192:195], v[44:47], v[96:99]
  s_add_u32 m0, s36, 114688
  s_add_u32 s37, s84, 29696
  v_mfma_f32_16x16x32_bf16 v[100:103], v[196:199], v[44:47], v[100:103]
  buffer_load_dwordx4 v15, s[8:11], s37 offen nt lds
  v_mfma_f32_16x16x32_bf16 v[88:91], v[200:203], v[44:47], v[88:91]
  v_mfma_f32_16x16x32_bf16 v[92:95], v[204:207], v[44:47], v[92:95]
  s_waitcnt lgkmcnt(2)
  v_mfma_f32_16x16x32_bf16 v[104:107], v[208:211], v[48:51], v[104:107]
  ds_read_b128 v[44:47], v5 offset:53248
  v_mfma_f32_16x16x32_bf16 v[108:111], v[212:215], v[48:51], v[108:111]
  v_mfma_f32_16x16x32_bf16 v[96:99], v[216:219], v[48:51], v[96:99]
  v_mfma_f32_16x16x32_bf16 v[100:103], v[220:223], v[48:51], v[100:103]
  v_mfma_f32_16x16x32_bf16 v[88:91], v[224:227], v[48:51], v[88:91]
  v_mfma_f32_16x16x32_bf16 v[92:95], v[228:231], v[48:51], v[92:95]
  s_waitcnt lgkmcnt(2)
  v_mfma_f32_16x16x32_bf16 v[104:107], v[232:235], v[52:55], v[104:107]
  ds_read_b128 v[48:51], v6 offset:53248
  v_mfma_f32_16x16x32_bf16 v[108:111], v[236:239], v[52:55], v[108:111]
  v_mfma_f32_16x16x32_bf16 v[96:99], v[240:243], v[52:55], v[96:99]
  v_mfma_f32_16x16x32_bf16 v[100:103], v[244:247], v[52:55], v[100:103]
  v_mfma_f32_16x16x32_bf16 v[88:91], v[248:251], v[52:55], v[88:91]
  v_mfma_f32_16x16x32_bf16 v[92:95], v[252:255], v[52:55], v[92:95]
  s_waitcnt lgkmcnt(2)
  v_mfma_f32_16x16x32_bf16 v[112:115], a[0:3], v[40:43], 0
  ds_read_b128 v[52:55], v7 offset:53248
  v_mfma_f32_16x16x32_bf16 v[116:119], a[4:7], v[40:43], 0
  v_mfma_f32_16x16x32_bf16 v[104:107], a[8:11], v[40:43], v[104:107]
  v_mfma_f32_16x16x32_bf16 v[108:111], a[12:15], v[40:43], v[108:111]
  v_mfma_f32_16x16x32_bf16 v[96:99], a[16:19], v[40:43], v[96:99]
  s_add_u32 m0, s36, 20480
  s_add_u32 s37, s85, 29696
  v_mfma_f32_16x16x32_bf16 v[100:103], a[20:23], v[40:43], v[100:103]
  buffer_load_dwordx4 v15, s[8:11], s37 offen nt lds
  s_waitcnt lgkmcnt(2)
  v_mfma_f32_16x16x32_bf16 v[112:115], a[24:27], v[44:47], v[112:115]
  ds_read_b128 v[40:43], v4 offset:57344
  v_fma_f32 v88, v88, v20, v28
  v_mfma_f32_16x16x32_bf16 v[116:119], a[28:31], v[44:47], v[116:119]
  v_fma_f32 v89, v89, v21, v29
  v_mfma_f32_16x16x32_bf16 v[104:107], a[32:35], v[44:47], v[104:107]
  v_fma_f32 v90, v90, v22, v30
  v_mfma_f32_16x16x32_bf16 v[108:111], a[36:39], v[44:47], v[108:111]
  v_fma_f32 v91, v91, v23, v31
  v_mfma_f32_16x16x32_bf16 v[96:99], a[40:43], v[44:47], v[96:99]
  v_exp_f32 v36, v88
  v_mfma_f32_16x16x32_bf16 v[100:103], a[44:47], v[44:47], v[100:103]
  s_waitcnt lgkmcnt(2)
  v_mfma_f32_16x16x32_bf16 v[112:115], a[48:51], v[48:51], v[112:115]
  ds_read_b128 v[44:47], v5 offset:57344
  v_mfma_f32_16x16x32_bf16 v[116:119], a[52:55], v[48:51], v[116:119]
  v_exp_f32 v37, v89
  v_mfma_f32_16x16x32_bf16 v[104:107], a[56:59], v[48:51], v[104:107]
  v_exp_f32 v38, v90
  v_mfma_f32_16x16x32_bf16 v[108:111], a[60:63], v[48:51], v[108:111]
  v_exp_f32 v39, v91
  v_mfma_f32_16x16x32_bf16 v[96:99], a[64:67], v[48:51], v[96:99]
  v_fma_f32 v36, v36, s54, s54
  v_mfma_f32_16x16x32_bf16 v[100:103], a[68:71], v[48:51], v[100:103]
  v_fma_f32 v37, v37, s54, s54
  s_waitcnt lgkmcnt(2)
  v_mfma_f32_16x16x32_bf16 v[112:115], a[72:75], v[52:55], v[112:115]
  ds_read_b128 v[48:51], v6 offset:57344
  v_mfma_f32_16x16x32_bf16 v[116:119], a[76:79], v[52:55], v[116:119]
  v_fma_f32 v38, v38, s54, s54
  v_mfma_f32_16x16x32_bf16 v[104:107], a[80:83], v[52:55], v[104:107]
  v_fma_f32 v39, v39, s54, s54
  v_mfma_f32_16x16x32_bf16 v[108:111], a[84:87], v[52:55], v[108:111]
  v_rcp_f32 v36, v36
  v_mfma_f32_16x16x32_bf16 v[96:99], a[88:91], v[52:55], v[96:99]
  v_rcp_f32 v37, v37
  v_mfma_f32_16x16x32_bf16 v[100:103], a[92:95], v[52:55], v[100:103]
  s_waitcnt lgkmcnt(2)
  v_mfma_f32_16x16x32_bf16 v[112:115], a[96:99], v[40:43], v[112:115]
  ds_read_b128 v[52:55], v7 offset:57344
  s_add_u32 m0, s36, 12288
  v_mfma_f32_16x16x32_bf16 v[116:119], a[100:103], v[40:43], v[116:119]
  s_add_u32 s37, s86, 29696
  buffer_load_dwordx4 v15, s[8:11], s37 offen nt lds
  v_mfma_f32_16x16x32_bf16 v[104:107], a[104:107], v[40:43], v[104:107]
  v_rcp_f32 v38, v38
  v_mfma_f32_16x16x32_bf16 v[108:111], a[108:111], v[40:43], v[108:111]
  v_rcp_f32 v39, v39
  v_mfma_f32_16x16x32_bf16 v[96:99], a[112:115], v[40:43], v[96:99]
  v_mul_f32 v88, v88, v36
  v_mfma_f32_16x16x32_bf16 v[100:103], a[116:119], v[40:43], v[100:103]
  v_mul_f32 v89, v89, v37
  s_waitcnt lgkmcnt(2)
  v_mfma_f32_16x16x32_bf16 v[112:115], a[120:123], v[44:47], v[112:115]
  ds_read_b128 v[40:43], v8 offset:57344
  v_mfma_f32_16x16x32_bf16 v[116:119], a[124:127], v[44:47], v[116:119]
  v_mul_f32 v90, v90, v38
  v_mfma_f32_16x16x32_bf16 v[104:107], a[128:131], v[44:47], v[104:107]
  v_mul_f32 v91, v91, v39
  v_mfma_f32_16x16x32_bf16 v[108:111], a[132:135], v[44:47], v[108:111]
  v_fma_f32 v92, v92, v24, v32
  v_mfma_f32_16x16x32_bf16 v[96:99], a[136:139], v[44:47], v[96:99]
  v_fma_f32 v93, v93, v25, v33
  v_mfma_f32_16x16x32_bf16 v[100:103], a[140:143], v[44:47], v[100:103]
  v_fma_f32 v94, v94, v26, v34
  s_waitcnt lgkmcnt(2)
  v_mfma_f32_16x16x32_bf16 v[112:115], a[144:147], v[48:51], v[112:115]
  ds_read_b128 v[44:47], v9 offset:57344
  v_mfma_f32_16x16x32_bf16 v[116:119], a[148:151], v[48:51], v[116:119]
  v_fma_f32 v95, v95, v27, v35
  v_mfma_f32_16x16x32_bf16 v[104:107], a[152:155], v[48:51], v[104:107]
  v_exp_f32 v36, v92
  v_mfma_f32_16x16x32_bf16 v[108:111], a[156:159], v[48:51], v[108:111]
  v_exp_f32 v37, v93
  v_mfma_f32_16x16x32_bf16 v[96:99], a[160:163], v[48:51], v[96:99]
  v_exp_f32 v38, v94
  v_mfma_f32_16x16x32_bf16 v[100:103], a[164:167], v[48:51], v[100:103]
  s_waitcnt lgkmcnt(2)
  v_mfma_f32_16x16x32_bf16 v[112:115], a[168:171], v[52:55], v[112:115]
  ds_read_b128 v[48:51], v10 offset:57344
  v_mfma_f32_16x16x32_bf16 v[116:119], a[172:175], v[52:55], v[116:119]
  v_exp_f32 v39, v95
  v_mfma_f32_16x16x32_bf16 v[104:107], a[176:179], v[52:55], v[104:107]
  s_add_u32 m0, s36, 49152
  s_add_u32 s37, s87, 29696
  v_mfma_f32_16x16x32_bf16 v[108:111], a[180:183], v[52:55], v[108:111]
  buffer_load_dwordx4 v15, s[8:11], s37 offen nt lds
  v_mfma_f32_16x16x32_bf16 v[96:99], a[184:187], v[52:55], v[96:99]
  v_fma_f32 v36, v36, s54, s54
  v_mfma_f32_16x16x32_bf16 v[100:103], a[188:191], v[52:55], v[100:103]
  v_fma_f32 v37, v37, s54, s54
  s_waitcnt lgkmcnt(2)
  v_mfma_f32_16x16x32_bf16 v[112:115], a[192:195], v[40:43], v[112:115]
  ds_read_b128 v[52:55], v11 offset:57344
  v_mfma_f32_16x16x32_bf16 v[116:119], a[196:199], v[40:43], v[116:119]
  v_fma_f32 v38, v38, s54, s54
  v_mfma_f32_16x16x32_bf16 v[104:107], a[200:203], v[40:43], v[104:107]
  v_fma_f32 v39, v39, s54, s54
  v_mfma_f32_16x16x32_bf16 v[108:111], a[204:207], v[40:43], v[108:111]
  v_rcp_f32 v36, v36
  v_mfma_f32_16x16x32_bf16 v[96:99], a[208:211], v[40:43], v[96:99]
  v_rcp_f32 v37, v37
  v_mfma_f32_16x16x32_bf16 v[100:103], a[212:215], v[40:43], v[100:103]
  s_waitcnt lgkmcnt(2)
  v_mfma_f32_16x16x32_bf16 v[112:115], a[216:219], v[44:47], v[112:115]
  ds_read_b128 v[40:43], v8 offset:61440
  v_mfma_f32_16x16x32_bf16 v[116:119], a[220:223], v[44:47], v[116:119]
  v_rcp_f32 v38, v38
  v_mfma_f32_16x16x32_bf16 v[104:107], a[224:227], v[44:47], v[104:107]
  v_rcp_f32 v39, v39
  v_mfma_f32_16x16x32_bf16 v[108:111], a[228:231], v[44:47], v[108:111]
  v_mul_f32 v92, v92, v36
  v_mfma_f32_16x16x32_bf16 v[96:99], a[232:235], v[44:47], v[96:99]
  v_mul_f32 v93, v93, v37
  v_mfma_f32_16x16x32_bf16 v[100:103], a[236:239], v[44:47], v[100:103]
  v_mul_f32 v94, v94, v38
  s_waitcnt lgkmcnt(2)
  v_mfma_f32_16x16x32_bf16 v[112:115], a[240:243], v[48:51], v[112:115]
  ds_read_b128 v[44:47], v9 offset:61440
  v_mfma_f32_16x16x32_bf16 v[116:119], a[244:247], v[48:51], v[116:119]
  v_mul_f32 v95, v95, v39
  v_mfma_f32_16x16x32_bf16 v[104:107], a[248:251], v[48:51], v[104:107]
  v_cvt_pk_bf16_f32 v88, v88, v89
  v_mfma_f32_16x16x32_bf16 v[108:111], a[252:255], v[48:51], v[108:111]
  v_cvt_pk_bf16_f32 v89, v90, v91
  v_mfma_f32_16x16x32_bf16 v[96:99], v[128:131], v[48:51], v[96:99]
  s_add_u32 m0, s36, 24576
  s_add_u32 s37, s84, 30720
  v_mfma_f32_16x16x32_bf16 v[100:103], v[132:135], v[48:51], v[100:103]
  buffer_load_dwordx4 v15, s[8:11], s37 offen nt lds
  s_waitcnt lgkmcnt(2)
  v_mfma_f32_16x16x32_bf16 v[112:115], v[136:139], v[52:55], v[112:115]
  ds_read_b128 v[48:51], v10 offset:61440
  v_mfma_f32_16x16x32_bf16 v[116:119], v[140:143], v[52:55], v[116:119]
  v_cvt_pk_bf16_f32 v90, v92, v93
  v_mfma_f32_16x16x32_bf16 v[104:107], v[144:147], v[52:55], v[104:107]
  v_cvt_pk_bf16_f32 v91, v94, v95
  s_mov_b32 s38, 22528
  v_mfma_f32_16x16x32_bf16 v[108:111], v[148:151], v[52:55], v[108:111]
  buffer_store_dwordx4 v[88:91], v17, s[16:19], s38 offen sc1
  v_mfma_f32_16x16x32_bf16 v[96:99], v[152:155], v[52:55], v[96:99]
  v_mbcnt_lo_u32_b32 v12, -1, 0
  v_mfma_f32_16x16x32_bf16 v[100:103], v[156:159], v[52:55], v[100:103]
  v_mbcnt_hi_u32_b32 v12, -1, v12
  s_waitcnt lgkmcnt(2)
  v_mfma_f32_16x16x32_bf16 v[112:115], v[160:163], v[40:43], v[112:115]
  ds_read_b128 v[52:55], v11 offset:61440
  v_mfma_f32_16x16x32_bf16 v[116:119], v[164:167], v[40:43], v[116:119]
  v_lshl_add_u32 v12, v12, 3, s52
  v_mfma_f32_16x16x32_bf16 v[104:107], v[168:171], v[40:43], v[104:107]
  buffer_load_dword v13, v12, s[48:51], 0 offen
  v_mfma_f32_16x16x32_bf16 v[108:111], v[172:175], v[40:43], v[108:111]
  v_mfma_f32_16x16x32_bf16 v[96:99], v[176:179], v[40:43], v[96:99]
  v_mfma_f32_16x16x32_bf16 v[100:103], v[180:183], v[40:43], v[100:103]
  s_waitcnt lgkmcnt(2)
  v_mfma_f32_16x16x32_bf16 v[112:115], v[184:187], v[44:47], v[112:115]
  ds_read_b128 v[40:43], v4 offset:32768
  v_mfma_f32_16x16x32_bf16 v[116:119], v[188:191], v[44:47], v[116:119]
  v_mfma_f32_16x16x32_bf16 v[104:107], v[192:195], v[44:47], v[104:107]
  v_mfma_f32_16x16x32_bf16 v[108:111], v[196:199], v[44:47], v[108:111]
  v_mfma_f32_16x16x32_bf16 v[96:99], v[200:203], v[44:47], v[96:99]
  v_mfma_f32_16x16x32_bf16 v[100:103], v[204:207], v[44:47], v[100:103]
  s_waitcnt lgkmcnt(2)
  v_mfma_f32_16x16x32_bf16 v[112:115], v[208:211], v[48:51], v[112:115]
  ds_read_b128 v[44:47], v5 offset:32768
  v_mfma_f32_16x16x32_bf16 v[116:119], v[212:215], v[48:51], v[116:119]
  v_mfma_f32_16x16x32_bf16 v[104:107], v[216:219], v[48:51], v[104:107]
  v_mfma_f32_16x16x32_bf16 v[108:111], v[220:223], v[48:51], v[108:111]
  v_mfma_f32_16x16x32_bf16 v[96:99], v[224:227], v[48:51], v[96:99]
  v_mfma_f32_16x16x32_bf16 v[100:103], v[228:231], v[48:51], v[100:103]
  s_waitcnt lgkmcnt(2)
  v_mfma_f32_16x16x32_bf16 v[112:115], v[232:235], v[52:55], v[112:115]
  ds_read_b128 v[48:51], v6 offset:32768
  v_mfma_f32_16x16x32_bf16 v[116:119], v[236:239], v[52:55], v[116:119]
  v_mfma_f32_16x16x32_bf16 v[104:107], v[240:243], v[52:55], v[104:107]
  v_mfma_f32_16x16x32_bf16 v[108:111], v[244:247], v[52:55], v[108:111]
  v_mfma_f32_16x16x32_bf16 v[96:99], v[248:251], v[52:55], v[96:99]
  v_mfma_f32_16x16x32_bf16 v[100:103], v[252:255], v[52:55], v[100:103]
  s_waitcnt lgkmcnt(2)
  v_mfma_f32_16x16x32_bf16 v[120:123], a[0:3], v[40:43], 0
  ds_read_b128 v[52:55], v7 offset:32768
  v_mfma_f32_16x16x32_bf16 v[124:127], a[4:7], v[40:43], 0
  v_mfma_f32_16x16x32_bf16 v[112:115], a[8:11], v[40:43], v[112:115]
  v_mfma_f32_16x16x32_bf16 v[116:119], a[12:15], v[40:43], v[116:119]
  v_mfma_f32_16x16x32_bf16 v[104:107], a[16:19], v[40:43], v[104:107]
  v_mfma_f32_16x16x32_bf16 v[108:111], a[20:23], v[40:43], v[108:111]
  s_waitcnt lgkmcnt(2)
  v_mfma_f32_16x16x32_bf16 v[120:123], a[24:27], v[44:47], v[120:123]
  ds_read_b128 v[40:43], v4 offset:36864
  v_fma_f32 v96, v96, v20, v28
  v_mfma_f32_16x16x32_bf16 v[124:127], a[28:31], v[44:47], v[124:127]
  v_fma_f32 v97, v97, v21, v29
  v_mfma_f32_16x16x32_bf16 v[112:115], a[32:35], v[44:47], v[112:115]
  v_fma_f32 v98, v98, v22, v30
  v_mfma_f32_16x16x32_bf16 v[116:119], a[36:39], v[44:47], v[116:119]
  v_fma_f32 v99, v99, v23, v31
  v_mfma_f32_16x16x32_bf16 v[104:107], a[40:43], v[44:47], v[104:107]
  v_exp_f32 v36, v96
  v_mfma_f32_16x16x32_bf16 v[108:111], a[44:47], v[44:47], v[108:111]
  s_waitcnt lgkmcnt(2)
  v_mfma_f32_16x16x32_bf16 v[120:123], a[48:51], v[48:51], v[120:123]
  ds_read_b128 v[44:47], v5 offset:36864
  v_mfma_f32_16x16x32_bf16 v[124:127], a[52:55], v[48:51], v[124:127]
  v_exp_f32 v37, v97
  v_mfma_f32_16x16x32_bf16 v[112:115], a[56:59], v[48:51], v[112:115]
  v_exp_f32 v38, v98
  v_mfma_f32_16x16x32_bf16 v[116:119], a[60:63], v[48:51], v[116:119]
  v_exp_f32 v39, v99
  v_mfma_f32_16x16x32_bf16 v[104:107], a[64:67], v[48:51], v[104:107]
  v_fma_f32 v36, v36, s54, s54
  v_mfma_f32_16x16x32_bf16 v[108:111], a[68:71], v[48:51], v[108:111]
  v_fma_f32 v37, v37, s54, s54
  s_waitcnt lgkmcnt(2)
  v_mfma_f32_16x16x32_bf16 v[120:123], a[72:75], v[52:55], v[120:123]
  ds_read_b128 v[48:51], v6 offset:36864
  v_mfma_f32_16x16x32_bf16 v[124:127], a[76:79], v[52:55], v[124:127]
  v_fma_f32 v38, v38, s54, s54
  v_mfma_f32_16x16x32_bf16 v[112:115], a[80:83], v[52:55], v[112:115]
  v_fma_f32 v39, v39, s54, s54
  v_mfma_f32_16x16x32_bf16 v[116:119], a[84:87], v[52:55], v[116:119]
  v_rcp_f32 v36, v36
  v_mfma_f32_16x16x32_bf16 v[104:107], a[88:91], v[52:55], v[104:107]
  v_rcp_f32 v37, v37
  v_mfma_f32_16x16x32_bf16 v[108:111], a[92:95], v[52:55], v[108:111]
  s_waitcnt lgkmcnt(2)
  v_mfma_f32_16x16x32_bf16 v[120:123], a[96:99], v[40:43], v[120:123]
  ds_read_b128 v[52:55], v7 offset:36864
  v_mfma_f32_16x16x32_bf16 v[124:127], a[100:103], v[40:43], v[124:127]
  v_rcp_f32 v38, v38
  v_mfma_f32_16x16x32_bf16 v[112:115], a[104:107], v[40:43], v[112:115]
  v_rcp_f32 v39, v39
  v_mfma_f32_16x16x32_bf16 v[116:119], a[108:111], v[40:43], v[116:119]
  v_mul_f32 v96, v96, v36
  v_mfma_f32_16x16x32_bf16 v[104:107], a[112:115], v[40:43], v[104:107]
  v_mul_f32 v97, v97, v37
  v_mfma_f32_16x16x32_bf16 v[108:111], a[116:119], v[40:43], v[108:111]
  v_mul_f32 v98, v98, v38
  s_waitcnt lgkmcnt(2)
  v_mfma_f32_16x16x32_bf16 v[120:123], a[120:123], v[44:47], v[120:123]
  ds_read_b128 v[40:43], v4 offset:40960
  v_mfma_f32_16x16x32_bf16 v[124:127], a[124:127], v[44:47], v[124:127]
  v_mul_f32 v99, v99, v39
  v_mfma_f32_16x16x32_bf16 v[112:115], a[128:131], v[44:47], v[112:115]
  v_fma_f32 v100, v100, v24, v32
  v_mfma_f32_16x16x32_bf16 v[116:119], a[132:135], v[44:47], v[116:119]
  v_fma_f32 v101, v101, v25, v33
  v_mfma_f32_16x16x32_bf16 v[104:107], a[136:139], v[44:47], v[104:107]
  v_fma_f32 v102, v102, v26, v34
  v_mfma_f32_16x16x32_bf16 v[108:111], a[140:143], v[44:47], v[108:111]
  v_fma_f32 v103, v103, v27, v35
  s_waitcnt vmcnt(9)
  s_barrier
  s_waitcnt lgkmcnt(2)
  v_mfma_f32_16x16x32_bf16 v[120:123], a[144:147], v[48:51], v[120:123]
  ds_read_b128 v[44:47], v5 offset:40960
  s_add_u32 m0, s36, 28672
  v_mfma_f32_16x16x32_bf16 v[124:127], a[148:151], v[48:51], v[124:127]
  s_add_u32 s37, s85, 30720
  buffer_load_dwordx4 v15, s[8:11], s37 offen nt lds
  v_mfma_f32_16x16x32_bf16 v[112:115], a[152:155], v[48:51], v[112:115]
  v_exp_f32 v36, v100
  v_mfma_f32_16x16x32_bf16 v[116:119], a[156:159], v[48:51], v[116:119]
  v_exp_f32 v37, v101
  v_mfma_f32_16x16x32_bf16 v[104:107], a[160:163], v[48:51], v[104:107]
  v_exp_f32 v38, v102
  v_mfma_f32_16x16x32_bf16 v[108:111], a[164:167], v[48:51], v[108:111]
  s_waitcnt lgkmcnt(2)
  v_mfma_f32_16x16x32_bf16 v[120:123], a[168:171], v[52:55], v[120:123]
  ds_read_b128 v[48:51], v6 offset:40960
  v_mfma_f32_16x16x32_bf16 v[124:127], a[172:175], v[52:55], v[124:127]
  v_exp_f32 v39, v103
  v_mfma_f32_16x16x32_bf16 v[112:115], a[176:179], v[52:55], v[112:115]
  v_fma_f32 v36, v36, s54, s54
  v_mfma_f32_16x16x32_bf16 v[116:119], a[180:183], v[52:55], v[116:119]
  v_fma_f32 v37, v37, s54, s54
  v_mfma_f32_16x16x32_bf16 v[104:107], a[184:187], v[52:55], v[104:107]
  v_fma_f32 v38, v38, s54, s54
  v_mfma_f32_16x16x32_bf16 v[108:111], a[188:191], v[52:55], v[108:111]
  v_fma_f32 v39, v39, s54, s54
  s_waitcnt lgkmcnt(2)
  v_mfma_f32_16x16x32_bf16 v[120:123], a[192:195], v[40:43], v[120:123]
  ds_read_b128 v[52:55], v7 offset:40960
  v_mfma_f32_16x16x32_bf16 v[124:127], a[196:199], v[40:43], v[124:127]
  v_rcp_f32 v36, v36
  v_mfma_f32_16x16x32_bf16 v[112:115], a[200:203], v[40:43], v[112:115]
  v_rcp_f32 v37, v37
  v_mfma_f32_16x16x32_bf16 v[116:119], a[204:207], v[40:43], v[116:119]
  v_rcp_f32 v38, v38
  v_mfma_f32_16x16x32_bf16 v[104:107], a[208:211], v[40:43], v[104:107]
  v_rcp_f32 v39, v39
  v_mfma_f32_16x16x32_bf16 v[108:111], a[212:215], v[40:43], v[108:111]
  v_mul_f32 v100, v100, v36
  s_waitcnt lgkmcnt(2)
  v_mfma_f32_16x16x32_bf16 v[120:123], a[216:219], v[44:47], v[120:123]
  ds_read_b128 v[40:43], v4 offset:61440
  v_mfma_f32_16x16x32_bf16 v[124:127], a[220:223], v[44:47], v[124:127]
  v_mul_f32 v101, v101, v37
  v_mfma_f32_16x16x32_bf16 v[112:115], a[224:227], v[44:47], v[112:115]
  s_add_u32 m0, s36, 118784
  s_add_u32 s37, s86, 30720
  v_mfma_f32_16x16x32_bf16 v[116:119], a[228:231], v[44:47], v[116:119]
  buffer_load_dwordx4 v15, s[8:11], s37 offen nt lds
  v_mfma_f32_16x16x32_bf16 v[104:107], a[232:235], v[44:47], v[104:107]
  v_mul_f32 v102, v102, v38
  v_mfma_f32_16x16x32_bf16 v[108:111], a[236:239], v[44:47], v[108:111]
  v_mul_f32 v103, v103, v39
  s_waitcnt lgkmcnt(2)
  v_mfma_f32_16x16x32_bf16 v[120:123], a[240:243], v[48:51], v[120:123]
  ds_read_b128 v[44:47], v5 offset:61440
  v_mfma_f32_16x16x32_bf16 v[124:127], a[244:247], v[48:51], v[124:127]
  v_cvt_pk_bf16_f32 v96, v96, v97
  v_mfma_f32_16x16x32_bf16 v[112:115], a[248:251], v[48:51], v[112:115]
  v_cvt_pk_bf16_f32 v97, v98, v99
  v_mfma_f32_16x16x32_bf16 v[116:119], a[252:255], v[48:51], v[116:119]
  v_cvt_pk_bf16_f32 v98, v100, v101
  v_mfma_f32_16x16x32_bf16 v[104:107], v[128:131], v[48:51], v[104:107]
  v_cvt_pk_bf16_f32 v99, v102, v103
  s_mov_b32 s38, 23552
  v_mfma_f32_16x16x32_bf16 v[108:111], v[132:135], v[48:51], v[108:111]
  buffer_store_dwordx4 v[96:99], v17, s[16:19], s38 offen sc1
  s_waitcnt lgkmcnt(2)
  v_mfma_f32_16x16x32_bf16 v[120:123], v[136:139], v[52:55], v[120:123]
  ds_read_b128 v[48:51], v6 offset:61440
  v_mfma_f32_16x16x32_bf16 v[124:127], v[140:143], v[52:55], v[124:127]
  v_mfma_f32_16x16x32_bf16 v[112:115], v[144:147], v[52:55], v[112:115]
  v_mfma_f32_16x16x32_bf16 v[116:119], v[148:151], v[52:55], v[116:119]
  v_mfma_f32_16x16x32_bf16 v[104:107], v[152:155], v[52:55], v[104:107]
  v_mfma_f32_16x16x32_bf16 v[108:111], v[156:159], v[52:55], v[108:111]
  s_waitcnt lgkmcnt(2)
  v_mfma_f32_16x16x32_bf16 v[120:123], v[160:163], v[40:43], v[120:123]
  ds_read_b128 v[52:55], v7 offset:61440
  v_mfma_f32_16x16x32_bf16 v[124:127], v[164:167], v[40:43], v[124:127]
  v_mfma_f32_16x16x32_bf16 v[112:115], v[168:171], v[40:43], v[112:115]
  v_mfma_f32_16x16x32_bf16 v[116:119], v[172:175], v[40:43], v[116:119]
  v_mfma_f32_16x16x32_bf16 v[104:107], v[176:179], v[40:43], v[104:107]
  s_add_u32 m0, s36, 90112
  s_add_u32 s37, s87, 30720
  v_mfma_f32_16x16x32_bf16 v[108:111], v[180:183], v[40:43], v[108:111]
  buffer_load_dwordx4 v15, s[8:11], s37 offen nt lds
  s_waitcnt lgkmcnt(2)
  v_mfma_f32_16x16x32_bf16 v[120:123], v[184:187], v[44:47], v[120:123]
  ds_read_b128 v[40:43], v8 offset:0
  v_mfma_f32_16x16x32_bf16 v[124:127], v[188:191], v[44:47], v[124:127]
  v_mfma_f32_16x16x32_bf16 v[112:115], v[192:195], v[44:47], v[112:115]
  v_mfma_f32_16x16x32_bf16 v[116:119], v[196:199], v[44:47], v[116:119]
  v_mfma_f32_16x16x32_bf16 v[104:107], v[200:203], v[44:47], v[104:107]
  v_mfma_f32_16x16x32_bf16 v[108:111], v[204:207], v[44:47], v[108:111]
  s_waitcnt lgkmcnt(2)
  v_mfma_f32_16x16x32_bf16 v[120:123], v[208:211], v[48:51], v[120:123]
  ds_read_b128 v[44:47], v9 offset:0
  v_mfma_f32_16x16x32_bf16 v[124:127], v[212:215], v[48:51], v[124:127]
  v_mfma_f32_16x16x32_bf16 v[112:115], v[216:219], v[48:51], v[112:115]
  v_mfma_f32_16x16x32_bf16 v[116:119], v[220:223], v[48:51], v[116:119]
  v_mfma_f32_16x16x32_bf16 v[104:107], v[224:227], v[48:51], v[104:107]
  v_mfma_f32_16x16x32_bf16 v[108:111], v[228:231], v[48:51], v[108:111]
  s_waitcnt lgkmcnt(2)
  v_mfma_f32_16x16x32_bf16 v[120:123], v[232:235], v[52:55], v[120:123]
  ds_read_b128 v[48:51], v10 offset:0
  v_mfma_f32_16x16x32_bf16 v[124:127], v[236:239], v[52:55], v[124:127]
  v_mfma_f32_16x16x32_bf16 v[112:115], v[240:243], v[52:55], v[112:115]
  v_mfma_f32_16x16x32_bf16 v[116:119], v[244:247], v[52:55], v[116:119]
  v_mfma_f32_16x16x32_bf16 v[104:107], v[248:251], v[52:55], v[104:107]
  v_mfma_f32_16x16x32_bf16 v[108:111], v[252:255], v[52:55], v[108:111]
  s_waitcnt lgkmcnt(2)
  v_mfma_f32_16x16x32_bf16 v[64:67], a[0:3], v[40:43], 0
  ds_read_b128 v[52:55], v11 offset:0
  s_add_u32 m0, s36, 94208
  v_mfma_f32_16x16x32_bf16 v[68:71], a[4:7], v[40:43], 0
  s_add_u32 s37, s84, 31744
  buffer_load_dwordx4 v15, s[8:11], s37 offen nt lds
  v_mfma_f32_16x16x32_bf16 v[120:123], a[8:11], v[40:43], v[120:123]
  v_mfma_f32_16x16x32_bf16 v[124:127], a[12:15], v[40:43], v[124:127]
  v_mfma_f32_16x16x32_bf16 v[112:115], a[16:19], v[40:43], v[112:115]
  v_fma_f32 v104, v104, v20, v28
  v_fma_f32 v105, v105, v21, v29
  v_mfma_f32_16x16x32_bf16 v[116:119], a[20:23], v[40:43], v[116:119]
  v_fma_f32 v106, v106, v22, v30
  s_waitcnt lgkmcnt(2)
  v_mfma_f32_16x16x32_bf16 v[64:67], a[24:27], v[44:47], v[64:67]
  ds_read_b128 v[40:43], v4 offset:16384
  v_mfma_f32_16x16x32_bf16 v[68:71], a[28:31], v[44:47], v[68:71]
  v_fma_f32 v107, v107, v23, v31
  v_mfma_f32_16x16x32_bf16 v[120:123], a[32:35], v[44:47], v[120:123]
  v_exp_f32 v36, v104
  v_mfma_f32_16x16x32_bf16 v[124:127], a[36:39], v[44:47], v[124:127]
  v_exp_f32 v37, v105
  v_mfma_f32_16x16x32_bf16 v[112:115], a[40:43], v[44:47], v[112:115]
  v_exp_f32 v38, v106
  v_mfma_f32_16x16x32_bf16 v[116:119], a[44:47], v[44:47], v[116:119]
  s_waitcnt lgkmcnt(2)
  v_mfma_f32_16x16x32_bf16 v[64:67], a[48:51], v[48:51], v[64:67]
  ds_read_b128 v[44:47], v5 offset:16384
  v_mfma_f32_16x16x32_bf16 v[68:71], a[52:55], v[48:51], v[68:71]
  v_exp_f32 v39, v107
  v_mfma_f32_16x16x32_bf16 v[120:123], a[56:59], v[48:51], v[120:123]
  v_fma_f32 v36, v36, s54, s54
  v_mfma_f32_16x16x32_bf16 v[124:127], a[60:63], v[48:51], v[124:127]
  v_fma_f32 v37, v37, s54, s54
  v_mfma_f32_16x16x32_bf16 v[112:115], a[64:67], v[48:51], v[112:115]
  v_fma_f32 v38, v38, s54, s54
  v_mfma_f32_16x16x32_bf16 v[116:119], a[68:71], v[48:51], v[116:119]
  v_fma_f32 v39, v39, s54, s54
  s_waitcnt lgkmcnt(2)
  v_mfma_f32_16x16x32_bf16 v[64:67], a[72:75], v[52:55], v[64:67]
  ds_read_b128 v[48:51], v6 offset:16384
  v_mfma_f32_16x16x32_bf16 v[68:71], a[76:79], v[52:55], v[68:71]
  v_rcp_f32 v36, v36
  v_mfma_f32_16x16x32_bf16 v[120:123], a[80:83], v[52:55], v[120:123]
  s_add_u32 m0, s36, 0
  s_add_u32 s37, s85, 31744
  v_mfma_f32_16x16x32_bf16 v[124:127], a[84:87], v[52:55], v[124:127]
  buffer_load_dwordx4 v15, s[8:11], s37 offen nt lds
  v_mfma_f32_16x16x32_bf16 v[112:115], a[88:91], v[52:55], v[112:115]
  v_rcp_f32 v37, v37
  v_mfma_f32_16x16x32_bf16 v[116:119], a[92:95], v[52:55], v[116:119]
  s_waitcnt lgkmcnt(2)
  v_mfma_f32_16x16x32_bf16 v[64:67], a[96:99], v[40:43], v[64:67]
  ds_read_b128 v[52:55], v7 offset:16384
  v_mfma_f32_16x16x32_bf16 v[68:71], a[100:103], v[40:43], v[68:71]
  v_rcp_f32 v38, v38
  v_mfma_f32_16x16x32_bf16 v[120:123], a[104:107], v[40:43], v[120:123]
  v_rcp_f32 v39, v39
  v_mfma_f32_16x16x32_bf16 v[124:127], a[108:111], v[40:43], v[124:127]
  v_mul_f32 v104, v104, v36
  v_mfma_f32_16x16x32_bf16 v[112:115], a[112:115], v[40:43], v[112:115]
  v_mul_f32 v105, v105, v37
  v_mfma_f32_16x16x32_bf16 v[116:119], a[116:119], v[40:43], v[116:119]
  v_mul_f32 v106, v106, v38
  s_waitcnt lgkmcnt(2)
  v_mfma_f32_16x16x32_bf16 v[64:67], a[120:123], v[44:47], v[64:67]
  ds_read_b128 v[40:43], v8 offset:32768
  v_mfma_f32_16x16x32_bf16 v[68:71], a[124:127], v[44:47], v[68:71]
  v_mul_f32 v107, v107, v39
  v_mfma_f32_16x16x32_bf16 v[120:123], a[128:131], v[44:47], v[120:123]
  v_fma_f32 v108, v108, v24, v32
  v_mfma_f32_16x16x32_bf16 v[124:127], a[132:135], v[44:47], v[124:127]
  v_fma_f32 v109, v109, v25, v33
  v_mfma_f32_16x16x32_bf16 v[112:115], a[136:139], v[44:47], v[112:115]
  v_fma_f32 v110, v110, v26, v34
  v_mfma_f32_16x16x32_bf16 v[116:119], a[140:143], v[44:47], v[116:119]
  v_fma_f32 v111, v111, v27, v35
  s_waitcnt lgkmcnt(2)
  v_mfma_f32_16x16x32_bf16 v[64:67], a[144:147], v[48:51], v[64:67]
  ds_read_b128 v[44:47], v9 offset:32768
  v_mfma_f32_16x16x32_bf16 v[68:71], a[148:151], v[48:51], v[68:71]
  v_exp_f32 v36, v108
  v_mfma_f32_16x16x32_bf16 v[120:123], a[152:155], v[48:51], v[120:123]
  v_exp_f32 v37, v109
  v_mfma_f32_16x16x32_bf16 v[124:127], a[156:159], v[48:51], v[124:127]
  v_exp_f32 v38, v110
  v_mfma_f32_16x16x32_bf16 v[112:115], a[160:163], v[48:51], v[112:115]
  s_add_u32 m0, s36, 4096
  s_add_u32 s37, s86, 31744
  v_mfma_f32_16x16x32_bf16 v[116:119], a[164:167], v[48:51], v[116:119]
  buffer_load_dwordx4 v15, s[8:11], s37 offen nt lds
  s_waitcnt lgkmcnt(2)
  v_mfma_f32_16x16x32_bf16 v[64:67], a[168:171], v[52:55], v[64:67]
  ds_read_b128 v[48:51], v10 offset:32768
  v_mfma_f32_16x16x32_bf16 v[68:71], a[172:175], v[52:55], v[68:71]
  v_exp_f32 v39, v111
  v_mfma_f32_16x16x32_bf16 v[120:123], a[176:179], v[52:55], v[120:123]
  v_fma_f32 v36, v36, s54, s54
  v_mfma_f32_16x16x32_bf16 v[124:127], a[180:183], v[52:55], v[124:127]
  v_fma_f32 v37, v37, s54, s54
  v_mfma_f32_16x16x32_bf16 v[112:115], a[184:187], v[52:55], v[112:115]
  v_fma_f32 v38, v38, s54, s54
  v_mfma_f32_16x16x32_bf16 v[116:119], a[188:191], v[52:55], v[116:119]
  v_fma_f32 v39, v39, s54, s54
  s_waitcnt lgkmcnt(2)
  v_mfma_f32_16x16x32_bf16 v[64:67], a[192:195], v[40:43], v[64:67]
  ds_read_b128 v[52:55], v11 offset:32768
  v_mfma_f32_16x16x32_bf16 v[68:71], a[196:199], v[40:43], v[68:71]
  v_rcp_f32 v36, v36
  v_mfma_f32_16x16x32_bf16 v[120:123], a[200:203], v[40:43], v[120:123]
  v_rcp_f32 v37, v37
  v_mfma_f32_16x16x32_bf16 v[124:127], a[204:207], v[40:43], v[124:127]
  v_rcp_f32 v38, v38
  v_mfma_f32_16x16x32_bf16 v[112:115], a[208:211], v[40:43], v[112:115]
  v_rcp_f32 v39, v39
  v_mfma_f32_16x16x32_bf16 v[116:119], a[212:215], v[40:43], v[116:119]
  v_mul_f32 v108, v108, v36
  s_waitcnt lgkmcnt(2)
  v_mfma_f32_16x16x32_bf16 v[64:67], a[216:219], v[44:47], v[64:67]
  ds_read_b128 v[40:43], v4 offset:45056
  v_mfma_f32_16x16x32_bf16 v[68:71], a[220:223], v[44:47], v[68:71]
  v_mul_f32 v109, v109, v37
  v_mfma_f32_16x16x32_bf16 v[120:123], a[224:227], v[44:47], v[120:123]
  v_mul_f32 v110, v110, v38
  v_mfma_f32_16x16x32_bf16 v[124:127], a[228:231], v[44:47], v[124:127]
  v_mul_f32 v111, v111, v39
  v_mfma_f32_16x16x32_bf16 v[112:115], a[232:235], v[44:47], v[112:115]
  v_cvt_pk_bf16_f32 v104, v104, v105
  v_mfma_f32_16x16x32_bf16 v[116:119], a[236:239], v[44:47], v[116:119]
  v_cvt_pk_bf16_f32 v105, v106, v107
  s_waitcnt lgkmcnt(2)
  v_mfma_f32_16x16x32_bf16 v[64:67], a[240:243], v[48:51], v[64:67]
  ds_read_b128 v[44:47], v5 offset:45056
  s_add_u32 m0, s36, 8192
  v_mfma_f32_16x16x32_bf16 v[68:71], a[244:247], v[48:51], v[68:71]
  s_add_u32 s37, s87, 31744
  buffer_load_dwordx4 v15, s[8:11], s37 offen nt lds
  v_mfma_f32_16x16x32_bf16 v[120:123], a[248:251], v[48:51], v[120:123]
  v_cvt_pk_bf16_f32 v106, v108, v109
  v_mfma_f32_16x16x32_bf16 v[124:127], a[252:255], v[48:51], v[124:127]
  v_cvt_pk_bf16_f32 v107, v110, v111
  s_mov_b32 s38, 24576
  v_mfma_f32_16x16x32_bf16 v[112:115], v[128:131], v[48:51], v[112:115]
  buffer_store_dwordx4 v[104:107], v17, s[16:19], s38 offen sc1
  v_mfma_f32_16x16x32_bf16 v[116:119], v[132:135], v[48:51], v[116:119]
  s_waitcnt lgkmcnt(2)
  v_mfma_f32_16x16x32_bf16 v[64:67], v[136:139], v[52:55], v[64:67]
  ds_read_b128 v[48:51], v6 offset:45056
  v_mfma_f32_16x16x32_bf16 v[68:71], v[140:143], v[52:55], v[68:71]
  v_mfma_f32_16x16x32_bf16 v[120:123], v[144:147], v[52:55], v[120:123]
  v_mfma_f32_16x16x32_bf16 v[124:127], v[148:151], v[52:55], v[124:127]
  v_mfma_f32_16x16x32_bf16 v[112:115], v[152:155], v[52:55], v[112:115]
  v_mfma_f32_16x16x32_bf16 v[116:119], v[156:159], v[52:55], v[116:119]
  s_waitcnt lgkmcnt(2)
  v_mfma_f32_16x16x32_bf16 v[64:67], v[160:163], v[40:43], v[64:67]
  ds_read_b128 v[52:55], v7 offset:45056
  v_mfma_f32_16x16x32_bf16 v[68:71], v[164:167], v[40:43], v[68:71]
  v_mfma_f32_16x16x32_bf16 v[120:123], v[168:171], v[40:43], v[120:123]
  v_mfma_f32_16x16x32_bf16 v[124:127], v[172:175], v[40:43], v[124:127]
  v_mfma_f32_16x16x32_bf16 v[112:115], v[176:179], v[40:43], v[112:115]
  v_mfma_f32_16x16x32_bf16 v[116:119], v[180:183], v[40:43], v[116:119]
  s_waitcnt lgkmcnt(2)
  v_mfma_f32_16x16x32_bf16 v[64:67], v[184:187], v[44:47], v[64:67]
  ds_read_b128 v[40:43], v8 offset:16384
  v_mfma_f32_16x16x32_bf16 v[68:71], v[188:191], v[44:47], v[68:71]
  v_mfma_f32_16x16x32_bf16 v[120:123], v[192:195], v[44:47], v[120:123]
  v_mfma_f32_16x16x32_bf16 v[124:127], v[196:199], v[44:47], v[124:127]
  v_mfma_f32_16x16x32_bf16 v[112:115], v[200:203], v[44:47], v[112:115]
  v_mfma_f32_16x16x32_bf16 v[116:119], v[204:207], v[44:47], v[116:119]
  s_waitcnt lgkmcnt(2)
  v_mfma_f32_16x16x32_bf16 v[64:67], v[208:211], v[48:51], v[64:67]
  ds_read_b128 v[44:47], v9 offset:16384
  v_mfma_f32_16x16x32_bf16 v[68:71], v[212:215], v[48:51], v[68:71]
  v_mfma_f32_16x16x32_bf16 v[120:123], v[216:219], v[48:51], v[120:123]
  v_mfma_f32_16x16x32_bf16 v[124:127], v[220:223], v[48:51], v[124:127]
  v_mfma_f32_16x16x32_bf16 v[112:115], v[224:227], v[48:51], v[112:115]
  v_mfma_f32_16x16x32_bf16 v[116:119], v[228:231], v[48:51], v[116:119]
  s_waitcnt lgkmcnt(2)
  v_mfma_f32_16x16x32_bf16 v[64:67], v[232:235], v[52:55], v[64:67]
  ds_read_b128 v[48:51], v10 offset:16384
  v_mfma_f32_16x16x32_bf16 v[68:71], v[236:239], v[52:55], v[68:71]
  v_mfma_f32_16x16x32_bf16 v[120:123], v[240:243], v[52:55], v[120:123]
  v_mfma_f32_16x16x32_bf16 v[124:127], v[244:247], v[52:55], v[124:127]
  v_mfma_f32_16x16x32_bf16 v[112:115], v[248:251], v[52:55], v[112:115]
  v_mfma_f32_16x16x32_bf16 v[116:119], v[252:255], v[52:55], v[116:119]
  s_waitcnt lgkmcnt(2)
  v_mfma_f32_16x16x32_bf16 v[56:59], a[0:3], v[40:43], 0
  ds_read_b128 v[52:55], v11 offset:16384
  v_mfma_f32_16x16x32_bf16 v[60:63], a[4:7], v[40:43], 0
  v_mfma_f32_16x16x32_bf16 v[64:67], a[8:11], v[40:43], v[64:67]
  v_mfma_f32_16x16x32_bf16 v[68:71], a[12:15], v[40:43], v[68:71]
  v_mfma_f32_16x16x32_bf16 v[120:123], a[16:19], v[40:43], v[120:123]
  v_mfma_f32_16x16x32_bf16 v[124:127], a[20:23], v[40:43], v[124:127]
  s_waitcnt lgkmcnt(2)
  v_mfma_f32_16x16x32_bf16 v[56:59], a[24:27], v[44:47], v[56:59]
  ds_read_b128 v[40:43], v8 offset:20480
  v_fma_f32 v112, v112, v20, v28
  v_mfma_f32_16x16x32_bf16 v[60:63], a[28:31], v[44:47], v[60:63]
  v_fma_f32 v113, v113, v21, v29
  v_mfma_f32_16x16x32_bf16 v[64:67], a[32:35], v[44:47], v[64:67]
  v_fma_f32 v114, v114, v22, v30
  v_mfma_f32_16x16x32_bf16 v[68:71], a[36:39], v[44:47], v[68:71]
  v_fma_f32 v115, v115, v23, v31
  v_mfma_f32_16x16x32_bf16 v[120:123], a[40:43], v[44:47], v[120:123]
  v_exp_f32 v36, v112
  v_mfma_f32_16x16x32_bf16 v[124:127], a[44:47], v[44:47], v[124:127]
  s_waitcnt lgkmcnt(2)
  v_mfma_f32_16x16x32_bf16 v[56:59], a[48:51], v[48:51], v[56:59]
  ds_read_b128 v[44:47], v9 offset:20480
  v_mfma_f32_16x16x32_bf16 v[60:63], a[52:55], v[48:51], v[60:63]
  v_exp_f32 v37, v113
  v_mfma_f32_16x16x32_bf16 v[64:67], a[56:59], v[48:51], v[64:67]
  v_exp_f32 v38, v114
  v_mfma_f32_16x16x32_bf16 v[68:71], a[60:63], v[48:51], v[68:71]
  v_exp_f32 v39, v115
  v_mfma_f32_16x16x32_bf16 v[120:123], a[64:67], v[48:51], v[120:123]
  v_fma_f32 v36, v36, s54, s54
  v_mfma_f32_16x16x32_bf16 v[124:127], a[68:71], v[48:51], v[124:127]
  v_fma_f32 v37, v37, s54, s54
  s_waitcnt lgkmcnt(2)
  v_mfma_f32_16x16x32_bf16 v[56:59], a[72:75], v[52:55], v[56:59]
  ds_read_b128 v[48:51], v10 offset:20480
  v_mfma_f32_16x16x32_bf16 v[60:63], a[76:79], v[52:55], v[60:63]
  v_fma_f32 v38, v38, s54, s54
  v_mfma_f32_16x16x32_bf16 v[64:67], a[80:83], v[52:55], v[64:67]
  v_fma_f32 v39, v39, s54, s54
  v_mfma_f32_16x16x32_bf16 v[68:71], a[84:87], v[52:55], v[68:71]
  v_rcp_f32 v36, v36
  v_mfma_f32_16x16x32_bf16 v[120:123], a[88:91], v[52:55], v[120:123]
  v_rcp_f32 v37, v37
  v_mfma_f32_16x16x32_bf16 v[124:127], a[92:95], v[52:55], v[124:127]
  s_waitcnt lgkmcnt(2)
  v_mfma_f32_16x16x32_bf16 v[56:59], a[96:99], v[40:43], v[56:59]
  ds_read_b128 v[52:55], v11 offset:20480
  v_mfma_f32_16x16x32_bf16 v[60:63], a[100:103], v[40:43], v[60:63]
  v_rcp_f32 v38, v38
  v_mfma_f32_16x16x32_bf16 v[64:67], a[104:107], v[40:43], v[64:67]
  v_rcp_f32 v39, v39
  v_mfma_f32_16x16x32_bf16 v[68:71], a[108:111], v[40:43], v[68:71]
  v_mul_f32 v112, v112, v36
  v_mfma_f32_16x16x32_bf16 v[120:123], a[112:115], v[40:43], v[120:123]
  v_mul_f32 v113, v113, v37
  v_mfma_f32_16x16x32_bf16 v[124:127], a[116:119], v[40:43], v[124:127]
  v_mul_f32 v114, v114, v38
  s_waitcnt lgkmcnt(2)
  v_mfma_f32_16x16x32_bf16 v[56:59], a[120:123], v[44:47], v[56:59]
  ds_read_b128 v[40:43], v8 offset:36864
  v_mfma_f32_16x16x32_bf16 v[60:63], a[124:127], v[44:47], v[60:63]
  v_mul_f32 v115, v115, v39
  v_mfma_f32_16x16x32_bf16 v[64:67], a[128:131], v[44:47], v[64:67]
  v_fma_f32 v116, v116, v24, v32
  v_mfma_f32_16x16x32_bf16 v[68:71], a[132:135], v[44:47], v[68:71]
  v_fma_f32 v117, v117, v25, v33
  v_mfma_f32_16x16x32_bf16 v[120:123], a[136:139], v[44:47], v[120:123]
  v_fma_f32 v118, v118, v26, v34
  v_mfma_f32_16x16x32_bf16 v[124:127], a[140:143], v[44:47], v[124:127]
  v_fma_f32 v119, v119, v27, v35
  s_waitcnt lgkmcnt(2)
  v_mfma_f32_16x16x32_bf16 v[56:59], a[144:147], v[48:51], v[56:59]
  ds_read_b128 v[44:47], v9 offset:36864
  v_mfma_f32_16x16x32_bf16 v[60:63], a[148:151], v[48:51], v[60:63]
  v_exp_f32 v36, v116
  v_mfma_f32_16x16x32_bf16 v[64:67], a[152:155], v[48:51], v[64:67]
  v_exp_f32 v37, v117
  v_mfma_f32_16x16x32_bf16 v[68:71], a[156:159], v[48:51], v[68:71]
  v_exp_f32 v38, v118
  v_mfma_f32_16x16x32_bf16 v[120:123], a[160:163], v[48:51], v[120:123]
  v_exp_f32 v39, v119
  v_mfma_f32_16x16x32_bf16 v[124:127], a[164:167], v[48:51], v[124:127]
  v_fma_f32 v36, v36, s54, s54
  s_waitcnt lgkmcnt(2)
  v_mfma_f32_16x16x32_bf16 v[56:59], a[168:171], v[52:55], v[56:59]
  ds_read_b128 v[48:51], v10 offset:36864
  v_mfma_f32_16x16x32_bf16 v[60:63], a[172:175], v[52:55], v[60:63]
  v_fma_f32 v37, v37, s54, s54
  v_mfma_f32_16x16x32_bf16 v[64:67], a[176:179], v[52:55], v[64:67]
  v_fma_f32 v38, v38, s54, s54
  v_mfma_f32_16x16x32_bf16 v[68:71], a[180:183], v[52:55], v[68:71]
  v_fma_f32 v39, v39, s54, s54
  v_mfma_f32_16x16x32_bf16 v[120:123], a[184:187], v[52:55], v[120:123]
  v_rcp_f32 v36, v36
  v_mfma_f32_16x16x32_bf16 v[124:127], a[188:191], v[52:55], v[124:127]
  s_waitcnt lgkmcnt(2)
  v_mfma_f32_16x16x32_bf16 v[56:59], a[192:195], v[40:43], v[56:59]
  ds_read_b128 v[52:55], v11 offset:36864
  v_mfma_f32_16x16x32_bf16 v[60:63], a[196:199], v[40:43], v[60:63]
  v_rcp_f32 v37, v37
  v_mfma_f32_16x16x32_bf16 v[64:67], a[200:203], v[40:43], v[64:67]
  v_rcp_f32 v38, v38
  v_mfma_f32_16x16x32_bf16 v[68:71], a[204:207], v[40:43], v[68:71]
  v_rcp_f32 v39, v39
  v_mfma_f32_16x16x32_bf16 v[120:123], a[208:211], v[40:43], v[120:123]
  v_mul_f32 v116, v116, v36
  v_mfma_f32_16x16x32_bf16 v[124:127], a[212:215], v[40:43], v[124:127]
  v_mul_f32 v117, v117, v37
  s_waitcnt lgkmcnt(2)
  v_mfma_f32_16x16x32_bf16 v[56:59], a[216:219], v[44:47], v[56:59]
  ds_read_b128 v[40:43], v8 offset:4096
  v_mfma_f32_16x16x32_bf16 v[60:63], a[220:223], v[44:47], v[60:63]
  v_mul_f32 v118, v118, v38
  v_mfma_f32_16x16x32_bf16 v[64:67], a[224:227], v[44:47], v[64:67]
  v_mul_f32 v119, v119, v39
  v_mfma_f32_16x16x32_bf16 v[68:71], a[228:231], v[44:47], v[68:71]
  v_cvt_pk_bf16_f32 v112, v112, v113
  v_mfma_f32_16x16x32_bf16 v[120:123], a[232:235], v[44:47], v[120:123]
  v_cvt_pk_bf16_f32 v113, v114, v115
  v_mfma_f32_16x16x32_bf16 v[124:127], a[236:239], v[44:47], v[124:127]
  v_cvt_pk_bf16_f32 v114, v116, v117
  s_waitcnt lgkmcnt(2)
  v_mfma_f32_16x16x32_bf16 v[56:59], a[240:243], v[48:51], v[56:59]
  ds_read_b128 v[44:47], v9 offset:4096
  v_mfma_f32_16x16x32_bf16 v[60:63], a[244:247], v[48:51], v[60:63]
  v_cvt_pk_bf16_f32 v115, v118, v119
  s_mov_b32 s38, 25600
  v_mfma_f32_16x16x32_bf16 v[64:67], a[248:251], v[48:51], v[64:67]
  buffer_store_dwordx4 v[112:115], v17, s[16:19], s38 offen sc1
  v_mfma_f32_16x16x32_bf16 v[68:71], a[252:255], v[48:51], v[68:71]
  v_mfma_f32_16x16x32_bf16 v[120:123], v[128:131], v[48:51], v[120:123]
  v_mfma_f32_16x16x32_bf16 v[124:127], v[132:135], v[48:51], v[124:127]
  s_waitcnt lgkmcnt(2)
  v_mfma_f32_16x16x32_bf16 v[56:59], v[136:139], v[52:55], v[56:59]
  ds_read_b128 v[48:51], v10 offset:4096
  v_mfma_f32_16x16x32_bf16 v[60:63], v[140:143], v[52:55], v[60:63]
  v_mfma_f32_16x16x32_bf16 v[64:67], v[144:147], v[52:55], v[64:67]
  v_mfma_f32_16x16x32_bf16 v[68:71], v[148:151], v[52:55], v[68:71]
  v_mfma_f32_16x16x32_bf16 v[120:123], v[152:155], v[52:55], v[120:123]
  v_mfma_f32_16x16x32_bf16 v[124:127], v[156:159], v[52:55], v[124:127]
  s_waitcnt lgkmcnt(2)
  v_mfma_f32_16x16x32_bf16 v[56:59], v[160:163], v[40:43], v[56:59]
  ds_read_b128 v[52:55], v11 offset:4096
  v_mfma_f32_16x16x32_bf16 v[60:63], v[164:167], v[40:43], v[60:63]
  v_mfma_f32_16x16x32_bf16 v[64:67], v[168:171], v[40:43], v[64:67]
  v_mfma_f32_16x16x32_bf16 v[68:71], v[172:175], v[40:43], v[68:71]
  v_mfma_f32_16x16x32_bf16 v[120:123], v[176:179], v[40:43], v[120:123]
  v_mfma_f32_16x16x32_bf16 v[124:127], v[180:183], v[40:43], v[124:127]
  s_waitcnt lgkmcnt(2)
  v_mfma_f32_16x16x32_bf16 v[56:59], v[184:187], v[44:47], v[56:59]
  ds_read_b128 v[40:43], v8 offset:8192
  v_mfma_f32_16x16x32_bf16 v[60:63], v[188:191], v[44:47], v[60:63]
  v_mfma_f32_16x16x32_bf16 v[64:67], v[192:195], v[44:47], v[64:67]
  v_mfma_f32_16x16x32_bf16 v[68:71], v[196:199], v[44:47], v[68:71]
  v_mfma_f32_16x16x32_bf16 v[120:123], v[200:203], v[44:47], v[120:123]
  v_mfma_f32_16x16x32_bf16 v[124:127], v[204:207], v[44:47], v[124:127]
  s_waitcnt lgkmcnt(2)
  v_mfma_f32_16x16x32_bf16 v[56:59], v[208:211], v[48:51], v[56:59]
  ds_read_b128 v[44:47], v9 offset:8192
  v_mfma_f32_16x16x32_bf16 v[60:63], v[212:215], v[48:51], v[60:63]
  v_mfma_f32_16x16x32_bf16 v[64:67], v[216:219], v[48:51], v[64:67]
  v_mfma_f32_16x16x32_bf16 v[68:71], v[220:223], v[48:51], v[68:71]
  v_mfma_f32_16x16x32_bf16 v[120:123], v[224:227], v[48:51], v[120:123]
  v_mfma_f32_16x16x32_bf16 v[124:127], v[228:231], v[48:51], v[124:127]
  s_waitcnt lgkmcnt(2)
  v_mfma_f32_16x16x32_bf16 v[56:59], v[232:235], v[52:55], v[56:59]
  ds_read_b128 v[48:51], v10 offset:8192
  v_mfma_f32_16x16x32_bf16 v[60:63], v[236:239], v[52:55], v[60:63]
  v_mfma_f32_16x16x32_bf16 v[64:67], v[240:243], v[52:55], v[64:67]
  v_mfma_f32_16x16x32_bf16 v[68:71], v[244:247], v[52:55], v[68:71]
  v_mfma_f32_16x16x32_bf16 v[120:123], v[248:251], v[52:55], v[120:123]
  v_mfma_f32_16x16x32_bf16 v[124:127], v[252:255], v[52:55], v[124:127]
  s_waitcnt lgkmcnt(2)
  v_mfma_f32_16x16x32_bf16 v[72:75], a[0:3], v[40:43], 0
  ds_read_b128 v[52:55], v11 offset:8192
  v_mfma_f32_16x16x32_bf16 v[76:79], a[4:7], v[40:43], 0
  v_mfma_f32_16x16x32_bf16 v[56:59], a[8:11], v[40:43], v[56:59]
  v_mfma_f32_16x16x32_bf16 v[60:63], a[12:15], v[40:43], v[60:63]
  v_mfma_f32_16x16x32_bf16 v[64:67], a[16:19], v[40:43], v[64:67]
  v_mfma_f32_16x16x32_bf16 v[68:71], a[20:23], v[40:43], v[68:71]
  s_waitcnt lgkmcnt(2)
  v_mfma_f32_16x16x32_bf16 v[72:75], a[24:27], v[44:47], v[72:75]
  ds_read_b128 v[40:43], v8 offset:12288
  v_fma_f32 v120, v120, v20, v28
  v_mfma_f32_16x16x32_bf16 v[76:79], a[28:31], v[44:47], v[76:79]
  v_fma_f32 v121, v121, v21, v29
  v_mfma_f32_16x16x32_bf16 v[56:59], a[32:35], v[44:47], v[56:59]
  v_fma_f32 v122, v122, v22, v30
  v_mfma_f32_16x16x32_bf16 v[60:63], a[36:39], v[44:47], v[60:63]
  v_fma_f32 v123, v123, v23, v31
  v_mfma_f32_16x16x32_bf16 v[64:67], a[40:43], v[44:47], v[64:67]
  v_exp_f32 v36, v120
  v_mfma_f32_16x16x32_bf16 v[68:71], a[44:47], v[44:47], v[68:71]
  s_waitcnt lgkmcnt(2)
  v_mfma_f32_16x16x32_bf16 v[72:75], a[48:51], v[48:51], v[72:75]
  ds_read_b128 v[44:47], v9 offset:12288
  v_mfma_f32_16x16x32_bf16 v[76:79], a[52:55], v[48:51], v[76:79]
  v_exp_f32 v37, v121
  v_mfma_f32_16x16x32_bf16 v[56:59], a[56:59], v[48:51], v[56:59]
  v_exp_f32 v38, v122
  v_mfma_f32_16x16x32_bf16 v[60:63], a[60:63], v[48:51], v[60:63]
  v_exp_f32 v39, v123
  v_mfma_f32_16x16x32_bf16 v[64:67], a[64:67], v[48:51], v[64:67]
  v_fma_f32 v36, v36, s54, s54
  v_mfma_f32_16x16x32_bf16 v[68:71], a[68:71], v[48:51], v[68:71]
  v_fma_f32 v37, v37, s54, s54
  s_waitcnt lgkmcnt(2)
  v_mfma_f32_16x16x32_bf16 v[72:75], a[72:75], v[52:55], v[72:75]
  ds_read_b128 v[48:51], v10 offset:12288
  v_mfma_f32_16x16x32_bf16 v[76:79], a[76:79], v[52:55], v[76:79]
  v_fma_f32 v38, v38, s54, s54
  v_mfma_f32_16x16x32_bf16 v[56:59], a[80:83], v[52:55], v[56:59]
  v_fma_f32 v39, v39, s54, s54
  v_mfma_f32_16x16x32_bf16 v[60:63], a[84:87], v[52:55], v[60:63]
  v_rcp_f32 v36, v36
  v_mfma_f32_16x16x32_bf16 v[64:67], a[88:91], v[52:55], v[64:67]
  v_rcp_f32 v37, v37
  v_mfma_f32_16x16x32_bf16 v[68:71], a[92:95], v[52:55], v[68:71]
  s_waitcnt lgkmcnt(2)
  v_mfma_f32_16x16x32_bf16 v[72:75], a[96:99], v[40:43], v[72:75]
  ds_read_b128 v[52:55], v11 offset:12288
  v_mfma_f32_16x16x32_bf16 v[76:79], a[100:103], v[40:43], v[76:79]
  v_rcp_f32 v38, v38
  v_mfma_f32_16x16x32_bf16 v[56:59], a[104:107], v[40:43], v[56:59]
  v_rcp_f32 v39, v39
  v_mfma_f32_16x16x32_bf16 v[60:63], a[108:111], v[40:43], v[60:63]
  v_mul_f32 v120, v120, v36
  v_mfma_f32_16x16x32_bf16 v[64:67], a[112:115], v[40:43], v[64:67]
  v_mul_f32 v121, v121, v37
  v_mfma_f32_16x16x32_bf16 v[68:71], a[116:119], v[40:43], v[68:71]
  v_mul_f32 v122, v122, v38
  s_waitcnt lgkmcnt(2)
  v_mfma_f32_16x16x32_bf16 v[72:75], a[120:123], v[44:47], v[72:75]
  ds_read_b128 v[40:43], v8 offset:40960
  v_mfma_f32_16x16x32_bf16 v[76:79], a[124:127], v[44:47], v[76:79]
  v_mul_f32 v123, v123, v39
  v_mfma_f32_16x16x32_bf16 v[56:59], a[128:131], v[44:47], v[56:59]
  v_fma_f32 v124, v124, v24, v32
  v_mfma_f32_16x16x32_bf16 v[60:63], a[132:135], v[44:47], v[60:63]
  v_fma_f32 v125, v125, v25, v33
  v_mfma_f32_16x16x32_bf16 v[64:67], a[136:139], v[44:47], v[64:67]
  v_fma_f32 v126, v126, v26, v34
  v_mfma_f32_16x16x32_bf16 v[68:71], a[140:143], v[44:47], v[68:71]
  v_fma_f32 v127, v127, v27, v35
  s_waitcnt vmcnt(3)
  s_barrier
  s_waitcnt lgkmcnt(2)
  v_mfma_f32_16x16x32_bf16 v[72:75], a[144:147], v[48:51], v[72:75]
  ds_read_b128 v[44:47], v9 offset:40960
  v_mfma_f32_16x16x32_bf16 v[76:79], a[148:151], v[48:51], v[76:79]
  v_exp_f32 v36, v124
  v_mfma_f32_16x16x32_bf16 v[56:59], a[152:155], v[48:51], v[56:59]
  v_exp_f32 v37, v125
  v_mfma_f32_16x16x32_bf16 v[60:63], a[156:159], v[48:51], v[60:63]
  v_exp_f32 v38, v126
  v_mfma_f32_16x16x32_bf16 v[64:67], a[160:163], v[48:51], v[64:67]
  v_exp_f32 v39, v127
  v_mfma_f32_16x16x32_bf16 v[68:71], a[164:167], v[48:51], v[68:71]
  v_fma_f32 v36, v36, s54, s54
  s_waitcnt lgkmcnt(2)
  v_mfma_f32_16x16x32_bf16 v[72:75], a[168:171], v[52:55], v[72:75]
  ds_read_b128 v[48:51], v10 offset:40960
  v_mfma_f32_16x16x32_bf16 v[76:79], a[172:175], v[52:55], v[76:79]
  v_fma_f32 v37, v37, s54, s54
  v_mfma_f32_16x16x32_bf16 v[56:59], a[176:179], v[52:55], v[56:59]
  v_fma_f32 v38, v38, s54, s54
  v_mfma_f32_16x16x32_bf16 v[60:63], a[180:183], v[52:55], v[60:63]
  v_fma_f32 v39, v39, s54, s54
  v_mfma_f32_16x16x32_bf16 v[64:67], a[184:187], v[52:55], v[64:67]
  v_rcp_f32 v36, v36
  v_mfma_f32_16x16x32_bf16 v[68:71], a[188:191], v[52:55], v[68:71]
  s_waitcnt lgkmcnt(2)
  v_mfma_f32_16x16x32_bf16 v[72:75], a[192:195], v[40:43], v[72:75]
  ds_read_b128 v[52:55], v11 offset:40960
  v_mfma_f32_16x16x32_bf16 v[76:79], a[196:199], v[40:43], v[76:79]
  v_rcp_f32 v37, v37
  v_mfma_f32_16x16x32_bf16 v[56:59], a[200:203], v[40:43], v[56:59]
  v_rcp_f32 v38, v38
  v_mfma_f32_16x16x32_bf16 v[60:63], a[204:207], v[40:43], v[60:63]
  v_rcp_f32 v39, v39
  v_mfma_f32_16x16x32_bf16 v[64:67], a[208:211], v[40:43], v[64:67]
  v_mul_f32 v124, v124, v36
  v_mfma_f32_16x16x32_bf16 v[68:71], a[212:215], v[40:43], v[68:71]
  v_mul_f32 v125, v125, v37
  s_waitcnt lgkmcnt(2)
  v_mfma_f32_16x16x32_bf16 v[72:75], a[216:219], v[44:47], v[72:75]
  ds_read_b128 v[40:43], v8 offset:45056
  v_mfma_f32_16x16x32_bf16 v[76:79], a[220:223], v[44:47], v[76:79]
  v_mul_f32 v126, v126, v38
  v_mfma_f32_16x16x32_bf16 v[56:59], a[224:227], v[44:47], v[56:59]
  v_mul_f32 v127, v127, v39
  v_mfma_f32_16x16x32_bf16 v[60:63], a[228:231], v[44:47], v[60:63]
  v_cvt_pk_bf16_f32 v120, v120, v121
  v_mfma_f32_16x16x32_bf16 v[64:67], a[232:235], v[44:47], v[64:67]
  v_cvt_pk_bf16_f32 v121, v122, v123
  v_mfma_f32_16x16x32_bf16 v[68:71], a[236:239], v[44:47], v[68:71]
  v_cvt_pk_bf16_f32 v122, v124, v125
  s_waitcnt lgkmcnt(2)
  v_mfma_f32_16x16x32_bf16 v[72:75], a[240:243], v[48:51], v[72:75]
  ds_read_b128 v[44:47], v9 offset:45056
  v_mfma_f32_16x16x32_bf16 v[76:79], a[244:247], v[48:51], v[76:79]
  v_cvt_pk_bf16_f32 v123, v126, v127
  s_mov_b32 s38, 26624
  v_mfma_f32_16x16x32_bf16 v[56:59], a[248:251], v[48:51], v[56:59]
  buffer_store_dwordx4 v[120:123], v17, s[16:19], s38 offen sc1
  v_mfma_f32_16x16x32_bf16 v[60:63], a[252:255], v[48:51], v[60:63]
  v_mfma_f32_16x16x32_bf16 v[64:67], v[128:131], v[48:51], v[64:67]
  v_mfma_f32_16x16x32_bf16 v[68:71], v[132:135], v[48:51], v[68:71]
  s_waitcnt lgkmcnt(2)
  v_mfma_f32_16x16x32_bf16 v[72:75], v[136:139], v[52:55], v[72:75]
  ds_read_b128 v[48:51], v10 offset:45056
  v_mfma_f32_16x16x32_bf16 v[76:79], v[140:143], v[52:55], v[76:79]
  v_mfma_f32_16x16x32_bf16 v[56:59], v[144:147], v[52:55], v[56:59]
  v_mfma_f32_16x16x32_bf16 v[60:63], v[148:151], v[52:55], v[60:63]
  v_mfma_f32_16x16x32_bf16 v[64:67], v[152:155], v[52:55], v[64:67]
  v_mfma_f32_16x16x32_bf16 v[68:71], v[156:159], v[52:55], v[68:71]
  s_waitcnt lgkmcnt(2)
  v_mfma_f32_16x16x32_bf16 v[72:75], v[160:163], v[40:43], v[72:75]
  ds_read_b128 v[52:55], v11 offset:45056
  v_mfma_f32_16x16x32_bf16 v[76:79], v[164:167], v[40:43], v[76:79]
  v_mfma_f32_16x16x32_bf16 v[56:59], v[168:171], v[40:43], v[56:59]
  v_mfma_f32_16x16x32_bf16 v[60:63], v[172:175], v[40:43], v[60:63]
  v_mfma_f32_16x16x32_bf16 v[64:67], v[176:179], v[40:43], v[64:67]
  v_mfma_f32_16x16x32_bf16 v[68:71], v[180:183], v[40:43], v[68:71]
  s_waitcnt lgkmcnt(2)
  v_mfma_f32_16x16x32_bf16 v[72:75], v[184:187], v[44:47], v[72:75]
  ds_read_b128 v[40:43], v8 offset:49152
  v_mfma_f32_16x16x32_bf16 v[76:79], v[188:191], v[44:47], v[76:79]
  v_mfma_f32_16x16x32_bf16 v[56:59], v[192:195], v[44:47], v[56:59]
  v_mfma_f32_16x16x32_bf16 v[60:63], v[196:199], v[44:47], v[60:63]
  v_mfma_f32_16x16x32_bf16 v[64:67], v[200:203], v[44:47], v[64:67]
  v_mfma_f32_16x16x32_bf16 v[68:71], v[204:207], v[44:47], v[68:71]
  s_waitcnt lgkmcnt(2)
  v_mfma_f32_16x16x32_bf16 v[72:75], v[208:211], v[48:51], v[72:75]
  ds_read_b128 v[44:47], v9 offset:49152
  v_mfma_f32_16x16x32_bf16 v[76:79], v[212:215], v[48:51], v[76:79]
  v_mfma_f32_16x16x32_bf16 v[56:59], v[216:219], v[48:51], v[56:59]
  v_mfma_f32_16x16x32_bf16 v[60:63], v[220:223], v[48:51], v[60:63]
  v_mfma_f32_16x16x32_bf16 v[64:67], v[224:227], v[48:51], v[64:67]
  v_mfma_f32_16x16x32_bf16 v[68:71], v[228:231], v[48:51], v[68:71]
  s_waitcnt lgkmcnt(2)
  v_mfma_f32_16x16x32_bf16 v[72:75], v[232:235], v[52:55], v[72:75]
  ds_read_b128 v[48:51], v10 offset:49152
  v_mfma_f32_16x16x32_bf16 v[76:79], v[236:239], v[52:55], v[76:79]
  v_mfma_f32_16x16x32_bf16 v[56:59], v[240:243], v[52:55], v[56:59]
  v_mfma_f32_16x16x32_bf16 v[60:63], v[244:247], v[52:55], v[60:63]
  v_mfma_f32_16x16x32_bf16 v[64:67], v[248:251], v[52:55], v[64:67]
  v_mfma_f32_16x16x32_bf16 v[68:71], v[252:255], v[52:55], v[68:71]
  s_waitcnt lgkmcnt(2)
  v_mfma_f32_16x16x32_bf16 v[80:83], a[0:3], v[40:43], 0
  ds_read_b128 v[52:55], v11 offset:49152
  v_mfma_f32_16x16x32_bf16 v[84:87], a[4:7], v[40:43], 0
  v_mfma_f32_16x16x32_bf16 v[72:75], a[8:11], v[40:43], v[72:75]
  v_mfma_f32_16x16x32_bf16 v[76:79], a[12:15], v[40:43], v[76:79]
  v_mfma_f32_16x16x32_bf16 v[56:59], a[16:19], v[40:43], v[56:59]
  v_mfma_f32_16x16x32_bf16 v[60:63], a[20:23], v[40:43], v[60:63]
  s_waitcnt lgkmcnt(2)
  v_mfma_f32_16x16x32_bf16 v[80:83], a[24:27], v[44:47], v[80:83]
  ds_read_b128 v[40:43], v4 offset:20480
  v_fma_f32 v64, v64, v20, v28
  v_mfma_f32_16x16x32_bf16 v[84:87], a[28:31], v[44:47], v[84:87]
  v_fma_f32 v65, v65, v21, v29
  v_mfma_f32_16x16x32_bf16 v[72:75], a[32:35], v[44:47], v[72:75]
  v_fma_f32 v66, v66, v22, v30
  v_mfma_f32_16x16x32_bf16 v[76:79], a[36:39], v[44:47], v[76:79]
  v_fma_f32 v67, v67, v23, v31
  v_mfma_f32_16x16x32_bf16 v[56:59], a[40:43], v[44:47], v[56:59]
  v_exp_f32 v36, v64
  v_mfma_f32_16x16x32_bf16 v[60:63], a[44:47], v[44:47], v[60:63]
  s_waitcnt lgkmcnt(2)
  v_mfma_f32_16x16x32_bf16 v[80:83], a[48:51], v[48:51], v[80:83]
  ds_read_b128 v[44:47], v5 offset:20480
  v_mfma_f32_16x16x32_bf16 v[84:87], a[52:55], v[48:51], v[84:87]
  v_exp_f32 v37, v65
  v_mfma_f32_16x16x32_bf16 v[72:75], a[56:59], v[48:51], v[72:75]
  v_exp_f32 v38, v66
  v_mfma_f32_16x16x32_bf16 v[76:79], a[60:63], v[48:51], v[76:79]
  v_exp_f32 v39, v67
  v_mfma_f32_16x16x32_bf16 v[56:59], a[64:67], v[48:51], v[56:59]
  v_fma_f32 v36, v36, s54, s54
  v_mfma_f32_16x16x32_bf16 v[60:63], a[68:71], v[48:51], v[60:63]
  v_fma_f32 v37, v37, s54, s54
  s_waitcnt lgkmcnt(2)
  v_mfma_f32_16x16x32_bf16 v[80:83], a[72:75], v[52:55], v[80:83]
  ds_read_b128 v[48:51], v6 offset:20480
  v_mfma_f32_16x16x32_bf16 v[84:87], a[76:79], v[52:55], v[84:87]
  v_fma_f32 v38, v38, s54, s54
  v_mfma_f32_16x16x32_bf16 v[72:75], a[80:83], v[52:55], v[72:75]
  v_fma_f32 v39, v39, s54, s54
  v_mfma_f32_16x16x32_bf16 v[76:79], a[84:87], v[52:55], v[76:79]
  v_rcp_f32 v36, v36
  v_mfma_f32_16x16x32_bf16 v[56:59], a[88:91], v[52:55], v[56:59]
  v_rcp_f32 v37, v37
  v_mfma_f32_16x16x32_bf16 v[60:63], a[92:95], v[52:55], v[60:63]
  s_waitcnt lgkmcnt(2)
  v_mfma_f32_16x16x32_bf16 v[80:83], a[96:99], v[40:43], v[80:83]
  ds_read_b128 v[52:55], v7 offset:20480
  v_mfma_f32_16x16x32_bf16 v[84:87], a[100:103], v[40:43], v[84:87]
  v_rcp_f32 v38, v38
  v_mfma_f32_16x16x32_bf16 v[72:75], a[104:107], v[40:43], v[72:75]
  v_rcp_f32 v39, v39
  v_mfma_f32_16x16x32_bf16 v[76:79], a[108:111], v[40:43], v[76:79]
  v_mul_f32 v64, v64, v36
  v_mfma_f32_16x16x32_bf16 v[56:59], a[112:115], v[40:43], v[56:59]
  v_mul_f32 v65, v65, v37
  v_mfma_f32_16x16x32_bf16 v[60:63], a[116:119], v[40:43], v[60:63]
  v_mul_f32 v66, v66, v38
  s_waitcnt lgkmcnt(2)
  v_mfma_f32_16x16x32_bf16 v[80:83], a[120:123], v[44:47], v[80:83]
  ds_read_b128 v[40:43], v4 offset:12288
  v_mfma_f32_16x16x32_bf16 v[84:87], a[124:127], v[44:47], v[84:87]
  v_mul_f32 v67, v67, v39
  v_mfma_f32_16x16x32_bf16 v[72:75], a[128:131], v[44:47], v[72:75]
  v_fma_f32 v68, v68, v24, v32
  v_mfma_f32_16x16x32_bf16 v[76:79], a[132:135], v[44:47], v[76:79]
  v_fma_f32 v69, v69, v25, v33
  v_mfma_f32_16x16x32_bf16 v[56:59], a[136:139], v[44:47], v[56:59]
  v_fma_f32 v70, v70, v26, v34
  v_mfma_f32_16x16x32_bf16 v[60:63], a[140:143], v[44:47], v[60:63]
  v_fma_f32 v71, v71, v27, v35
  s_waitcnt lgkmcnt(2)
  v_mfma_f32_16x16x32_bf16 v[80:83], a[144:147], v[48:51], v[80:83]
  ds_read_b128 v[44:47], v5 offset:12288
  v_mfma_f32_16x16x32_bf16 v[84:87], a[148:151], v[48:51], v[84:87]
  v_exp_f32 v36, v68
  v_mfma_f32_16x16x32_bf16 v[72:75], a[152:155], v[48:51], v[72:75]
  v_exp_f32 v37, v69
  v_mfma_f32_16x16x32_bf16 v[76:79], a[156:159], v[48:51], v[76:79]
  v_exp_f32 v38, v70
  v_mfma_f32_16x16x32_bf16 v[56:59], a[160:163], v[48:51], v[56:59]
  v_exp_f32 v39, v71
  v_mfma_f32_16x16x32_bf16 v[60:63], a[164:167], v[48:51], v[60:63]
  v_fma_f32 v36, v36, s54, s54
  s_waitcnt lgkmcnt(2)
  v_mfma_f32_16x16x32_bf16 v[80:83], a[168:171], v[52:55], v[80:83]
  ds_read_b128 v[48:51], v6 offset:12288
  v_mfma_f32_16x16x32_bf16 v[84:87], a[172:175], v[52:55], v[84:87]
  v_fma_f32 v37, v37, s54, s54
  v_mfma_f32_16x16x32_bf16 v[72:75], a[176:179], v[52:55], v[72:75]
  v_fma_f32 v38, v38, s54, s54
  v_mfma_f32_16x16x32_bf16 v[76:79], a[180:183], v[52:55], v[76:79]
  v_fma_f32 v39, v39, s54, s54
  v_mfma_f32_16x16x32_bf16 v[56:59], a[184:187], v[52:55], v[56:59]
  v_rcp_f32 v36, v36
  v_mfma_f32_16x16x32_bf16 v[60:63], a[188:191], v[52:55], v[60:63]
  s_waitcnt lgkmcnt(2)
  v_mfma_f32_16x16x32_bf16 v[80:83], a[192:195], v[40:43], v[80:83]
  ds_read_b128 v[52:55], v7 offset:12288
  v_mfma_f32_16x16x32_bf16 v[84:87], a[196:199], v[40:43], v[84:87]
  v_rcp_f32 v37, v37
  v_mfma_f32_16x16x32_bf16 v[72:75], a[200:203], v[40:43], v[72:75]
  v_rcp_f32 v38, v38
  v_mfma_f32_16x16x32_bf16 v[76:79], a[204:207], v[40:43], v[76:79]
  v_rcp_f32 v39, v39
  v_mfma_f32_16x16x32_bf16 v[56:59], a[208:211], v[40:43], v[56:59]
  v_mul_f32 v68, v68, v36
  v_mfma_f32_16x16x32_bf16 v[60:63], a[212:215], v[40:43], v[60:63]
  v_mul_f32 v69, v69, v37
  s_waitcnt lgkmcnt(2)
  v_mfma_f32_16x16x32_bf16 v[80:83], a[216:219], v[44:47], v[80:83]
  ds_read_b128 v[40:43], v4 offset:49152
  v_mfma_f32_16x16x32_bf16 v[84:87], a[220:223], v[44:47], v[84:87]
  v_mul_f32 v70, v70, v38
  v_mfma_f32_16x16x32_bf16 v[72:75], a[224:227], v[44:47], v[72:75]
  v_mul_f32 v71, v71, v39
  v_mfma_f32_16x16x32_bf16 v[76:79], a[228:231], v[44:47], v[76:79]
  v_cvt_pk_bf16_f32 v64, v64, v65
  v_mfma_f32_16x16x32_bf16 v[56:59], a[232:235], v[44:47], v[56:59]
  v_cvt_pk_bf16_f32 v65, v66, v67
  v_mfma_f32_16x16x32_bf16 v[60:63], a[236:239], v[44:47], v[60:63]
  v_cvt_pk_bf16_f32 v66, v68, v69
  s_waitcnt lgkmcnt(2)
  v_mfma_f32_16x16x32_bf16 v[80:83], a[240:243], v[48:51], v[80:83]
  ds_read_b128 v[44:47], v5 offset:49152
  v_mfma_f32_16x16x32_bf16 v[84:87], a[244:247], v[48:51], v[84:87]
  v_cvt_pk_bf16_f32 v67, v70, v71
  s_mov_b32 s38, 27648
  v_mfma_f32_16x16x32_bf16 v[72:75], a[248:251], v[48:51], v[72:75]
  buffer_store_dwordx4 v[64:67], v17, s[16:19], s38 offen sc1
  v_mfma_f32_16x16x32_bf16 v[76:79], a[252:255], v[48:51], v[76:79]
  v_mfma_f32_16x16x32_bf16 v[56:59], v[128:131], v[48:51], v[56:59]
  v_mfma_f32_16x16x32_bf16 v[60:63], v[132:135], v[48:51], v[60:63]
  s_waitcnt lgkmcnt(2)
  v_mfma_f32_16x16x32_bf16 v[80:83], v[136:139], v[52:55], v[80:83]
  ds_read_b128 v[48:51], v6 offset:49152
  v_mfma_f32_16x16x32_bf16 v[84:87], v[140:143], v[52:55], v[84:87]
  v_mfma_f32_16x16x32_bf16 v[72:75], v[144:147], v[52:55], v[72:75]
  v_mfma_f32_16x16x32_bf16 v[76:79], v[148:151], v[52:55], v[76:79]
  v_mfma_f32_16x16x32_bf16 v[56:59], v[152:155], v[52:55], v[56:59]
  v_mfma_f32_16x16x32_bf16 v[60:63], v[156:159], v[52:55], v[60:63]
  s_waitcnt lgkmcnt(2)
  v_mfma_f32_16x16x32_bf16 v[80:83], v[160:163], v[40:43], v[80:83]
  ds_read_b128 v[52:55], v7 offset:49152
  v_mfma_f32_16x16x32_bf16 v[84:87], v[164:167], v[40:43], v[84:87]
  v_mfma_f32_16x16x32_bf16 v[72:75], v[168:171], v[40:43], v[72:75]
  v_mfma_f32_16x16x32_bf16 v[76:79], v[172:175], v[40:43], v[76:79]
  v_mfma_f32_16x16x32_bf16 v[56:59], v[176:179], v[40:43], v[56:59]
  v_mfma_f32_16x16x32_bf16 v[60:63], v[180:183], v[40:43], v[60:63]
  s_waitcnt lgkmcnt(2)
  v_mfma_f32_16x16x32_bf16 v[80:83], v[184:187], v[44:47], v[80:83]
  ds_read_b128 v[40:43], v4 offset:24576
  v_mfma_f32_16x16x32_bf16 v[84:87], v[188:191], v[44:47], v[84:87]
  v_mfma_f32_16x16x32_bf16 v[72:75], v[192:195], v[44:47], v[72:75]
  v_mfma_f32_16x16x32_bf16 v[76:79], v[196:199], v[44:47], v[76:79]
  v_mfma_f32_16x16x32_bf16 v[56:59], v[200:203], v[44:47], v[56:59]
  v_mfma_f32_16x16x32_bf16 v[60:63], v[204:207], v[44:47], v[60:63]
  s_waitcnt lgkmcnt(2)
  v_mfma_f32_16x16x32_bf16 v[80:83], v[208:211], v[48:51], v[80:83]
  ds_read_b128 v[44:47], v5 offset:24576
  v_mfma_f32_16x16x32_bf16 v[84:87], v[212:215], v[48:51], v[84:87]
  v_mfma_f32_16x16x32_bf16 v[72:75], v[216:219], v[48:51], v[72:75]
  v_mfma_f32_16x16x32_bf16 v[76:79], v[220:223], v[48:51], v[76:79]
  v_mfma_f32_16x16x32_bf16 v[56:59], v[224:227], v[48:51], v[56:59]
  v_mfma_f32_16x16x32_bf16 v[60:63], v[228:231], v[48:51], v[60:63]
  s_waitcnt lgkmcnt(2)
  v_mfma_f32_16x16x32_bf16 v[80:83], v[232:235], v[52:55], v[80:83]
  ds_read_b128 v[48:51], v6 offset:24576
  v_mfma_f32_16x16x32_bf16 v[84:87], v[236:239], v[52:55], v[84:87]
  v_mfma_f32_16x16x32_bf16 v[72:75], v[240:243], v[52:55], v[72:75]
  v_mfma_f32_16x16x32_bf16 v[76:79], v[244:247], v[52:55], v[76:79]
  v_mfma_f32_16x16x32_bf16 v[56:59], v[248:251], v[52:55], v[56:59]
  v_mfma_f32_16x16x32_bf16 v[60:63], v[252:255], v[52:55], v[60:63]
  s_waitcnt lgkmcnt(2)
  v_mfma_f32_16x16x32_bf16 v[88:91], a[0:3], v[40:43], 0
  ds_read_b128 v[52:55], v7 offset:24576
  v_mfma_f32_16x16x32_bf16 v[92:95], a[4:7], v[40:43], 0
  v_mfma_f32_16x16x32_bf16 v[80:83], a[8:11], v[40:43], v[80:83]
  v_mfma_f32_16x16x32_bf16 v[84:87], a[12:15], v[40:43], v[84:87]
  v_mfma_f32_16x16x32_bf16 v[72:75], a[16:19], v[40:43], v[72:75]
  v_mfma_f32_16x16x32_bf16 v[76:79], a[20:23], v[40:43], v[76:79]
  s_waitcnt lgkmcnt(2)
  v_mfma_f32_16x16x32_bf16 v[88:91], a[24:27], v[44:47], v[88:91]
  ds_read_b128 v[40:43], v4 offset:28672
  v_fma_f32 v56, v56, v20, v28
  v_mfma_f32_16x16x32_bf16 v[92:95], a[28:31], v[44:47], v[92:95]
  v_fma_f32 v57, v57, v21, v29
  v_mfma_f32_16x16x32_bf16 v[80:83], a[32:35], v[44:47], v[80:83]
  v_fma_f32 v58, v58, v22, v30
  v_mfma_f32_16x16x32_bf16 v[84:87], a[36:39], v[44:47], v[84:87]
  v_fma_f32 v59, v59, v23, v31
  v_mfma_f32_16x16x32_bf16 v[72:75], a[40:43], v[44:47], v[72:75]
  v_exp_f32 v36, v56
  v_mfma_f32_16x16x32_bf16 v[76:79], a[44:47], v[44:47], v[76:79]
  s_waitcnt lgkmcnt(2)
  v_mfma_f32_16x16x32_bf16 v[88:91], a[48:51], v[48:51], v[88:91]
  ds_read_b128 v[44:47], v5 offset:28672
  v_mfma_f32_16x16x32_bf16 v[92:95], a[52:55], v[48:51], v[92:95]
  v_exp_f32 v37, v57
  v_mfma_f32_16x16x32_bf16 v[80:83], a[56:59], v[48:51], v[80:83]
  v_exp_f32 v38, v58
  v_mfma_f32_16x16x32_bf16 v[84:87], a[60:63], v[48:51], v[84:87]
  v_exp_f32 v39, v59
  v_mfma_f32_16x16x32_bf16 v[72:75], a[64:67], v[48:51], v[72:75]
  v_fma_f32 v36, v36, s54, s54
  v_mfma_f32_16x16x32_bf16 v[76:79], a[68:71], v[48:51], v[76:79]
  v_fma_f32 v37, v37, s54, s54
  s_waitcnt lgkmcnt(2)
  v_mfma_f32_16x16x32_bf16 v[88:91], a[72:75], v[52:55], v[88:91]
  ds_read_b128 v[48:51], v6 offset:28672
  v_mfma_f32_16x16x32_bf16 v[92:95], a[76:79], v[52:55], v[92:95]
  v_fma_f32 v38, v38, s54, s54
  v_mfma_f32_16x16x32_bf16 v[80:83], a[80:83], v[52:55], v[80:83]
  v_fma_f32 v39, v39, s54, s54
  v_mfma_f32_16x16x32_bf16 v[84:87], a[84:87], v[52:55], v[84:87]
  v_rcp_f32 v36, v36
  v_mfma_f32_16x16x32_bf16 v[72:75], a[88:91], v[52:55], v[72:75]
  v_rcp_f32 v37, v37
  v_mfma_f32_16x16x32_bf16 v[76:79], a[92:95], v[52:55], v[76:79]
  s_waitcnt lgkmcnt(2)
  v_mfma_f32_16x16x32_bf16 v[88:91], a[96:99], v[40:43], v[88:91]
  ds_read_b128 v[52:55], v7 offset:28672
  v_mfma_f32_16x16x32_bf16 v[92:95], a[100:103], v[40:43], v[92:95]
  v_rcp_f32 v38, v38
  v_mfma_f32_16x16x32_bf16 v[80:83], a[104:107], v[40:43], v[80:83]
  v_rcp_f32 v39, v39
  v_mfma_f32_16x16x32_bf16 v[84:87], a[108:111], v[40:43], v[84:87]
  v_mul_f32 v56, v56, v36
  v_mfma_f32_16x16x32_bf16 v[72:75], a[112:115], v[40:43], v[72:75]
  v_mul_f32 v57, v57, v37
  v_mfma_f32_16x16x32_bf16 v[76:79], a[116:119], v[40:43], v[76:79]
  v_mul_f32 v58, v58, v38
  s_waitcnt lgkmcnt(2)
  v_mfma_f32_16x16x32_bf16 v[88:91], a[120:123], v[44:47], v[88:91]
  ds_read_b128 v[40:43], v8 offset:53248
  v_mfma_f32_16x16x32_bf16 v[92:95], a[124:127], v[44:47], v[92:95]
  v_mul_f32 v59, v59, v39
  v_mfma_f32_16x16x32_bf16 v[80:83], a[128:131], v[44:47], v[80:83]
  v_fma_f32 v60, v60, v24, v32
  v_mfma_f32_16x16x32_bf16 v[84:87], a[132:135], v[44:47], v[84:87]
  v_fma_f32 v61, v61, v25, v33
  v_mfma_f32_16x16x32_bf16 v[72:75], a[136:139], v[44:47], v[72:75]
  v_fma_f32 v62, v62, v26, v34
  v_mfma_f32_16x16x32_bf16 v[76:79], a[140:143], v[44:47], v[76:79]
  v_fma_f32 v63, v63, v27, v35
  s_waitcnt lgkmcnt(2)
  v_mfma_f32_16x16x32_bf16 v[88:91], a[144:147], v[48:51], v[88:91]
  ds_read_b128 v[44:47], v9 offset:53248
  v_mfma_f32_16x16x32_bf16 v[92:95], a[148:151], v[48:51], v[92:95]
  v_exp_f32 v36, v60
  v_mfma_f32_16x16x32_bf16 v[80:83], a[152:155], v[48:51], v[80:83]
  v_exp_f32 v37, v61
  v_mfma_f32_16x16x32_bf16 v[84:87], a[156:159], v[48:51], v[84:87]
  v_exp_f32 v38, v62
  v_mfma_f32_16x16x32_bf16 v[72:75], a[160:163], v[48:51], v[72:75]
  v_exp_f32 v39, v63
  v_mfma_f32_16x16x32_bf16 v[76:79], a[164:167], v[48:51], v[76:79]
  v_fma_f32 v36, v36, s54, s54
  s_waitcnt lgkmcnt(2)
  v_mfma_f32_16x16x32_bf16 v[88:91], a[168:171], v[52:55], v[88:91]
  ds_read_b128 v[48:51], v10 offset:53248
  v_mfma_f32_16x16x32_bf16 v[92:95], a[172:175], v[52:55], v[92:95]
  v_fma_f32 v37, v37, s54, s54
  v_mfma_f32_16x16x32_bf16 v[80:83], a[176:179], v[52:55], v[80:83]
  v_fma_f32 v38, v38, s54, s54
  v_mfma_f32_16x16x32_bf16 v[84:87], a[180:183], v[52:55], v[84:87]
  v_fma_f32 v39, v39, s54, s54
  v_mfma_f32_16x16x32_bf16 v[72:75], a[184:187], v[52:55], v[72:75]
  v_rcp_f32 v36, v36
  v_mfma_f32_16x16x32_bf16 v[76:79], a[188:191], v[52:55], v[76:79]
  s_waitcnt lgkmcnt(2)
  v_mfma_f32_16x16x32_bf16 v[88:91], a[192:195], v[40:43], v[88:91]
  ds_read_b128 v[52:55], v11 offset:53248
  v_mfma_f32_16x16x32_bf16 v[92:95], a[196:199], v[40:43], v[92:95]
  v_rcp_f32 v37, v37
  v_mfma_f32_16x16x32_bf16 v[80:83], a[200:203], v[40:43], v[80:83]
  v_rcp_f32 v38, v38
  v_mfma_f32_16x16x32_bf16 v[84:87], a[204:207], v[40:43], v[84:87]
  v_rcp_f32 v39, v39
  v_mfma_f32_16x16x32_bf16 v[72:75], a[208:211], v[40:43], v[72:75]
  v_mul_f32 v60, v60, v36
  v_mfma_f32_16x16x32_bf16 v[76:79], a[212:215], v[40:43], v[76:79]
  v_mul_f32 v61, v61, v37
  s_waitcnt lgkmcnt(2)
  v_mfma_f32_16x16x32_bf16 v[88:91], a[216:219], v[44:47], v[88:91]
  ds_read_b128 v[40:43], v8 offset:24576
  v_mfma_f32_16x16x32_bf16 v[92:95], a[220:223], v[44:47], v[92:95]
  v_mul_f32 v62, v62, v38
  v_mfma_f32_16x16x32_bf16 v[80:83], a[224:227], v[44:47], v[80:83]
  v_mul_f32 v63, v63, v39
  v_mfma_f32_16x16x32_bf16 v[84:87], a[228:231], v[44:47], v[84:87]
  v_cvt_pk_bf16_f32 v56, v56, v57
  v_mfma_f32_16x16x32_bf16 v[72:75], a[232:235], v[44:47], v[72:75]
  v_cvt_pk_bf16_f32 v57, v58, v59
  v_mfma_f32_16x16x32_bf16 v[76:79], a[236:239], v[44:47], v[76:79]
  v_cvt_pk_bf16_f32 v58, v60, v61
  s_waitcnt lgkmcnt(2)
  v_mfma_f32_16x16x32_bf16 v[88:91], a[240:243], v[48:51], v[88:91]
  ds_read_b128 v[44:47], v9 offset:24576
  v_mfma_f32_16x16x32_bf16 v[92:95], a[244:247], v[48:51], v[92:95]
  v_cvt_pk_bf16_f32 v59, v62, v63
  s_mov_b32 s38, 28672
  v_mfma_f32_16x16x32_bf16 v[80:83], a[248:251], v[48:51], v[80:83]
  buffer_store_dwordx4 v[56:59], v17, s[16:19], s38 offen sc1
  v_mfma_f32_16x16x32_bf16 v[84:87], a[252:255], v[48:51], v[84:87]
  v_mfma_f32_16x16x32_bf16 v[72:75], v[128:131], v[48:51], v[72:75]
  v_mfma_f32_16x16x32_bf16 v[76:79], v[132:135], v[48:51], v[76:79]
  s_waitcnt lgkmcnt(2)
  v_mfma_f32_16x16x32_bf16 v[88:91], v[136:139], v[52:55], v[88:91]
  ds_read_b128 v[48:51], v10 offset:24576
  v_mfma_f32_16x16x32_bf16 v[92:95], v[140:143], v[52:55], v[92:95]
  v_mfma_f32_16x16x32_bf16 v[80:83], v[144:147], v[52:55], v[80:83]
  v_mfma_f32_16x16x32_bf16 v[84:87], v[148:151], v[52:55], v[84:87]
  v_mfma_f32_16x16x32_bf16 v[72:75], v[152:155], v[52:55], v[72:75]
  v_mfma_f32_16x16x32_bf16 v[76:79], v[156:159], v[52:55], v[76:79]
  s_waitcnt lgkmcnt(2)
  v_mfma_f32_16x16x32_bf16 v[88:91], v[160:163], v[40:43], v[88:91]
  ds_read_b128 v[52:55], v11 offset:24576
  v_mfma_f32_16x16x32_bf16 v[92:95], v[164:167], v[40:43], v[92:95]
  v_mfma_f32_16x16x32_bf16 v[80:83], v[168:171], v[40:43], v[80:83]
  v_mfma_f32_16x16x32_bf16 v[84:87], v[172:175], v[40:43], v[84:87]
  v_mfma_f32_16x16x32_bf16 v[72:75], v[176:179], v[40:43], v[72:75]
  v_mfma_f32_16x16x32_bf16 v[76:79], v[180:183], v[40:43], v[76:79]
  s_waitcnt lgkmcnt(2)
  v_mfma_f32_16x16x32_bf16 v[88:91], v[184:187], v[44:47], v[88:91]
  ds_read_b128 v[40:43], v8 offset:28672
  v_mfma_f32_16x16x32_bf16 v[92:95], v[188:191], v[44:47], v[92:95]
  v_mfma_f32_16x16x32_bf16 v[80:83], v[192:195], v[44:47], v[80:83]
  v_mfma_f32_16x16x32_bf16 v[84:87], v[196:199], v[44:47], v[84:87]
  v_mfma_f32_16x16x32_bf16 v[72:75], v[200:203], v[44:47], v[72:75]
  v_mfma_f32_16x16x32_bf16 v[76:79], v[204:207], v[44:47], v[76:79]
  s_waitcnt lgkmcnt(2)
  v_mfma_f32_16x16x32_bf16 v[88:91], v[208:211], v[48:51], v[88:91]
  ds_read_b128 v[44:47], v9 offset:28672
  v_mfma_f32_16x16x32_bf16 v[92:95], v[212:215], v[48:51], v[92:95]
  v_mfma_f32_16x16x32_bf16 v[80:83], v[216:219], v[48:51], v[80:83]
  v_mfma_f32_16x16x32_bf16 v[84:87], v[220:223], v[48:51], v[84:87]
  v_mfma_f32_16x16x32_bf16 v[72:75], v[224:227], v[48:51], v[72:75]
  v_mfma_f32_16x16x32_bf16 v[76:79], v[228:231], v[48:51], v[76:79]
  s_waitcnt lgkmcnt(2)
  v_mfma_f32_16x16x32_bf16 v[88:91], v[232:235], v[52:55], v[88:91]
  ds_read_b128 v[48:51], v10 offset:28672
  v_mfma_f32_16x16x32_bf16 v[92:95], v[236:239], v[52:55], v[92:95]
  v_mfma_f32_16x16x32_bf16 v[80:83], v[240:243], v[52:55], v[80:83]
  v_mfma_f32_16x16x32_bf16 v[84:87], v[244:247], v[52:55], v[84:87]
  v_mfma_f32_16x16x32_bf16 v[72:75], v[248:251], v[52:55], v[72:75]
  v_mfma_f32_16x16x32_bf16 v[76:79], v[252:255], v[52:55], v[76:79]
  s_waitcnt lgkmcnt(2)
  v_mfma_f32_16x16x32_bf16 v[80:83], a[16:19], v[40:43], v[80:83]
  ds_read_b128 v[52:55], v11 offset:28672
  v_mfma_f32_16x16x32_bf16 v[84:87], a[20:23], v[40:43], v[84:87]
  s_waitcnt lgkmcnt(2)
  v_mfma_f32_16x16x32_bf16 v[80:83], a[40:43], v[44:47], v[80:83]
  ds_read_b128 v[40:43], v4 offset:0
  v_mfma_f32_16x16x32_bf16 v[84:87], a[44:47], v[44:47], v[84:87]
  s_waitcnt lgkmcnt(2)
  v_mfma_f32_16x16x32_bf16 v[80:83], a[64:67], v[48:51], v[80:83]
  ds_read_b128 v[44:47], v5 offset:0
  v_fma_f32 v72, v72, v20, v28
  v_mfma_f32_16x16x32_bf16 v[84:87], a[68:71], v[48:51], v[84:87]
  v_fma_f32 v73, v73, v21, v29
  s_waitcnt lgkmcnt(2)
  v_mfma_f32_16x16x32_bf16 v[80:83], a[88:91], v[52:55], v[80:83]
  ds_read_b128 v[48:51], v6 offset:0
  v_mfma_f32_16x16x32_bf16 v[84:87], a[92:95], v[52:55], v[84:87]
  v_fma_f32 v74, v74, v22, v30
  s_waitcnt lgkmcnt(2)
  v_mfma_f32_16x16x32_bf16 v[80:83], a[112:115], v[40:43], v[80:83]
  ds_read_b128 v[52:55], v7 offset:0
  v_mfma_f32_16x16x32_bf16 v[84:87], a[116:119], v[40:43], v[84:87]
  v_fma_f32 v75, v75, v23, v31
  s_waitcnt lgkmcnt(2)
  v_mfma_f32_16x16x32_bf16 v[80:83], a[136:139], v[44:47], v[80:83]
  ds_read_b128 v[40:43], v4 offset:4096
  v_mfma_f32_16x16x32_bf16 v[84:87], a[140:143], v[44:47], v[84:87]
  s_waitcnt vmcnt(5)
  s_barrier
  s_waitcnt lgkmcnt(2)
  v_mfma_f32_16x16x32_bf16 v[80:83], a[160:163], v[48:51], v[80:83]
  ds_read_b128 v[44:47], v5 offset:4096
  v_mfma_f32_16x16x32_bf16 v[84:87], a[164:167], v[48:51], v[84:87]
  s_waitcnt lgkmcnt(2)
  v_mfma_f32_16x16x32_bf16 v[80:83], a[184:187], v[52:55], v[80:83]
  ds_read_b128 v[48:51], v6 offset:4096
  v_mfma_f32_16x16x32_bf16 v[84:87], a[188:191], v[52:55], v[84:87]
  s_waitcnt lgkmcnt(2)
  v_mfma_f32_16x16x32_bf16 v[80:83], a[208:211], v[40:43], v[80:83]
  ds_read_b128 v[52:55], v7 offset:4096
  v_mfma_f32_16x16x32_bf16 v[84:87], a[212:215], v[40:43], v[84:87]
  s_waitcnt lgkmcnt(2)
  v_mfma_f32_16x16x32_bf16 v[80:83], a[232:235], v[44:47], v[80:83]
  ds_read_b128 v[40:43], v4 offset:8192
  v_mfma_f32_16x16x32_bf16 v[84:87], a[236:239], v[44:47], v[84:87]
  s_waitcnt lgkmcnt(2)
  v_mfma_f32_16x16x32_bf16 v[80:83], v[128:131], v[48:51], v[80:83]
  ds_read_b128 v[44:47], v5 offset:8192
  v_mfma_f32_16x16x32_bf16 v[84:87], v[132:135], v[48:51], v[84:87]
  s_waitcnt lgkmcnt(2)
  v_mfma_f32_16x16x32_bf16 v[80:83], v[152:155], v[52:55], v[80:83]
  ds_read_b128 v[48:51], v6 offset:8192
  v_mfma_f32_16x16x32_bf16 v[84:87], v[156:159], v[52:55], v[84:87]
  s_waitcnt lgkmcnt(2)
  v_mfma_f32_16x16x32_bf16 v[80:83], v[176:179], v[40:43], v[80:83]
  ds_read_b128 v[52:55], v7 offset:8192
  v_mfma_f32_16x16x32_bf16 v[84:87], v[180:183], v[40:43], v[84:87]
  s_waitcnt lgkmcnt(2)
  v_mfma_f32_16x16x32_bf16 v[80:83], v[200:203], v[44:47], v[80:83]
  ds_read_b128 v[40:43], v8 offset:28672
  v_mfma_f32_16x16x32_bf16 v[84:87], v[204:207], v[44:47], v[84:87]
  s_waitcnt lgkmcnt(2)
  v_mfma_f32_16x16x32_bf16 v[80:83], v[224:227], v[48:51], v[80:83]
  ds_read_b128 v[44:47], v9 offset:28672
  v_mfma_f32_16x16x32_bf16 v[84:87], v[228:231], v[48:51], v[84:87]
  s_waitcnt lgkmcnt(2)
  v_mfma_f32_16x16x32_bf16 v[80:83], v[248:251], v[52:55], v[80:83]
  ds_read_b128 v[48:51], v10 offset:28672
  v_mfma_f32_16x16x32_bf16 v[84:87], v[252:255], v[52:55], v[84:87]
  s_waitcnt lgkmcnt(2)
  v_mfma_f32_16x16x32_bf16 v[88:91], a[8:11], v[40:43], v[88:91]
  ds_read_b128 v[52:55], v11 offset:28672
  v_mfma_f32_16x16x32_bf16 v[92:95], a[12:15], v[40:43], v[92:95]
  s_waitcnt lgkmcnt(2)
  v_mfma_f32_16x16x32_bf16 v[88:91], a[32:35], v[44:47], v[88:91]
  ds_read_b128 v[40:43], v4 offset:0
  v_mfma_f32_16x16x32_bf16 v[92:95], a[36:39], v[44:47], v[92:95]
  s_waitcnt lgkmcnt(2)
  v_mfma_f32_16x16x32_bf16 v[88:91], a[56:59], v[48:51], v[88:91]
  ds_read_b128 v[44:47], v5 offset:0
  v_mfma_f32_16x16x32_bf16 v[92:95], a[60:63], v[48:51], v[92:95]
  s_waitcnt lgkmcnt(2)
  v_mfma_f32_16x16x32_bf16 v[88:91], a[80:83], v[52:55], v[88:91]
  ds_read_b128 v[48:51], v6 offset:0
  v_mfma_f32_16x16x32_bf16 v[92:95], a[84:87], v[52:55], v[92:95]
  s_waitcnt lgkmcnt(2)
  v_mfma_f32_16x16x32_bf16 v[88:91], a[104:107], v[40:43], v[88:91]
  ds_read_b128 v[52:55], v7 offset:0
  v_mfma_f32_16x16x32_bf16 v[92:95], a[108:111], v[40:43], v[92:95]
  s_waitcnt lgkmcnt(2)
  v_mfma_f32_16x16x32_bf16 v[88:91], a[128:131], v[44:47], v[88:91]
  ds_read_b128 v[40:43], v4 offset:4096
  v_mfma_f32_16x16x32_bf16 v[92:95], a[132:135], v[44:47], v[92:95]
  s_waitcnt lgkmcnt(2)
  v_mfma_f32_16x16x32_bf16 v[88:91], a[152:155], v[48:51], v[88:91]
  ds_read_b128 v[44:47], v5 offset:4096
  v_mfma_f32_16x16x32_bf16 v[92:95], a[156:159], v[48:51], v[92:95]
  s_waitcnt lgkmcnt(2)
  v_mfma_f32_16x16x32_bf16 v[88:91], a[176:179], v[52:55], v[88:91]
  ds_read_b128 v[48:51], v6 offset:4096
  v_mfma_f32_16x16x32_bf16 v[92:95], a[180:183], v[52:55], v[92:95]
  s_waitcnt lgkmcnt(2)
  v_mfma_f32_16x16x32_bf16 v[88:91], a[200:203], v[40:43], v[88:91]
  ds_read_b128 v[52:55], v7 offset:4096
  v_mfma_f32_16x16x32_bf16 v[92:95], a[204:207], v[40:43], v[92:95]
  s_waitcnt lgkmcnt(2)
  v_mfma_f32_16x16x32_bf16 v[88:91], a[224:227], v[44:47], v[88:91]
  ds_read_b128 v[40:43], v4 offset:8192
  v_mfma_f32_16x16x32_bf16 v[92:95], a[228:231], v[44:47], v[92:95]
  s_waitcnt lgkmcnt(2)
  v_mfma_f32_16x16x32_bf16 v[88:91], a[248:251], v[48:51], v[88:91]
  ds_read_b128 v[44:47], v5 offset:8192
  v_mfma_f32_16x16x32_bf16 v[92:95], a[252:255], v[48:51], v[92:95]
  s_waitcnt lgkmcnt(2)
  v_mfma_f32_16x16x32_bf16 v[88:91], v[144:147], v[52:55], v[88:91]
  ds_read_b128 v[48:51], v6 offset:8192
  v_mfma_f32_16x16x32_bf16 v[92:95], v[148:151], v[52:55], v[92:95]
  s_waitcnt lgkmcnt(2)
  v_mfma_f32_16x16x32_bf16 v[88:91], v[168:171], v[40:43], v[88:91]
  ds_read_b128 v[52:55], v7 offset:8192
  v_mfma_f32_16x16x32_bf16 v[92:95], v[172:175], v[40:43], v[92:95]
  s_waitcnt lgkmcnt(2)
  v_mfma_f32_16x16x32_bf16 v[88:91], v[192:195], v[44:47], v[88:91]
  v_exp_f32 v36, v72
  v_mfma_f32_16x16x32_bf16 v[92:95], v[196:199], v[44:47], v[92:95]
  s_waitcnt lgkmcnt(1)
  v_mfma_f32_16x16x32_bf16 v[88:91], v[216:219], v[48:51], v[88:91]
  v_exp_f32 v37, v73
  v_mfma_f32_16x16x32_bf16 v[92:95], v[220:223], v[48:51], v[92:95]
  s_waitcnt lgkmcnt(0)
  v_mfma_f32_16x16x32_bf16 v[88:91], v[240:243], v[52:55], v[88:91]
  v_exp_f32 v38, v74
  v_mfma_f32_16x16x32_bf16 v[92:95], v[244:247], v[52:55], v[92:95]
  v_exp_f32 v39, v75
  v_fma_f32 v36, v36, s54, s54
  v_fma_f32 v37, v37, s54, s54
  v_fma_f32 v38, v38, s54, s54
  v_fma_f32 v39, v39, s54, s54
  v_rcp_f32 v36, v36
  v_rcp_f32 v37, v37
  v_rcp_f32 v38, v38
  v_rcp_f32 v39, v39
  v_mul_f32 v72, v72, v36
  v_mul_f32 v73, v73, v37
  v_mul_f32 v74, v74, v38
  v_mul_f32 v75, v75, v39
  v_fma_f32 v76, v76, v24, v32
  v_fma_f32 v77, v77, v25, v33
  v_fma_f32 v78, v78, v26, v34
  v_fma_f32 v79, v79, v27, v35
  v_exp_f32 v36, v76
  v_exp_f32 v37, v77
  v_exp_f32 v38, v78
  v_exp_f32 v39, v79
  v_fma_f32 v36, v36, s54, s54
  v_fma_f32 v37, v37, s54, s54
  v_fma_f32 v38, v38, s54, s54
  v_fma_f32 v39, v39, s54, s54
  v_rcp_f32 v36, v36
  v_rcp_f32 v37, v37
  v_rcp_f32 v38, v38
  v_rcp_f32 v39, v39
  v_mul_f32 v76, v76, v36
  v_mul_f32 v77, v77, v37
  v_mul_f32 v78, v78, v38
  v_mul_f32 v79, v79, v39
  v_cvt_pk_bf16_f32 v72, v72, v73
  v_cvt_pk_bf16_f32 v73, v74, v75
  v_cvt_pk_bf16_f32 v74, v76, v77
  v_cvt_pk_bf16_f32 v75, v78, v79
  s_mov_b32 s38, 29696
  buffer_store_dwordx4 v[72:75], v17, s[16:19], s38 offen sc1
  v_fma_f32 v80, v80, v20, v28
  v_fma_f32 v81, v81, v21, v29
  v_fma_f32 v82, v82, v22, v30
  v_fma_f32 v83, v83, v23, v31
  v_exp_f32 v36, v80
  v_exp_f32 v37, v81
  v_exp_f32 v38, v82
  v_exp_f32 v39, v83
  v_fma_f32 v36, v36, s54, s54
  v_fma_f32 v37, v37, s54, s54
  v_fma_f32 v38, v38, s54, s54
  v_fma_f32 v39, v39, s54, s54
  v_rcp_f32 v36, v36
  v_rcp_f32 v37, v37
  v_rcp_f32 v38, v38
  v_rcp_f32 v39, v39
  v_mul_f32 v80, v80, v36
  v_mul_f32 v81, v81, v37
  v_mul_f32 v82, v82, v38
  v_mul_f32 v83, v83, v39
  v_fma_f32 v84, v84, v24, v32
  v_fma_f32 v85, v85, v25, v33
  v_fma_f32 v86, v86, v26, v34
  v_fma_f32 v87, v87, v27, v35
  v_exp_f32 v36, v84
  v_exp_f32 v37, v85
  v_exp_f32 v38, v86
  v_exp_f32 v39, v87
  v_fma_f32 v36, v36, s54, s54
  v_fma_f32 v37, v37, s54, s54
  v_fma_f32 v38, v38, s54, s54
  v_fma_f32 v39, v39, s54, s54
  v_rcp_f32 v36, v36
  v_rcp_f32 v37, v37
  v_rcp_f32 v38, v38
  v_rcp_f32 v39, v39
  v_mul_f32 v84, v84, v36
  v_mul_f32 v85, v85, v37
  v_mul_f32 v86, v86, v38
  v_mul_f32 v87, v87, v39
  v_cvt_pk_bf16_f32 v80, v80, v81
  v_cvt_pk_bf16_f32 v81, v82, v83
  v_cvt_pk_bf16_f32 v82, v84, v85
  v_cvt_pk_bf16_f32 v83, v86, v87
  s_mov_b32 s38, 30720
  buffer_store_dwordx4 v[80:83], v17, s[16:19], s38 offen sc1
  v_fma_f32 v88, v88, v20, v28
  v_fma_f32 v89, v89, v21, v29
  v_fma_f32 v90, v90, v22, v30
  v_fma_f32 v91, v91, v23, v31
  v_exp_f32 v36, v88
  v_exp_f32 v37, v89
  v_exp_f32 v38, v90
  v_exp_f32 v39, v91
  v_fma_f32 v36, v36, s54, s54
  v_fma_f32 v37, v37, s54, s54
  v_fma_f32 v38, v38, s54, s54
  v_fma_f32 v39, v39, s54, s54
  v_rcp_f32 v36, v36
  v_rcp_f32 v37, v37
  v_rcp_f32 v38, v38
  v_rcp_f32 v39, v39
  v_mul_f32 v88, v88, v36
  v_mul_f32 v89, v89, v37
  v_mul_f32 v90, v90, v38
  v_mul_f32 v91, v91, v39
  v_fma_f32 v92, v92, v24, v32
  v_fma_f32 v93, v93, v25, v33
  v_fma_f32 v94, v94, v26, v34
  v_fma_f32 v95, v95, v27, v35
  v_exp_f32 v36, v92
  v_exp_f32 v37, v93
  v_exp_f32 v38, v94
  v_exp_f32 v39, v95
  v_fma_f32 v36, v36, s54, s54
  v_fma_f32 v37, v37, s54, s54
  v_fma_f32 v38, v38, s54, s54
  v_fma_f32 v39, v39, s54, s54
  v_rcp_f32 v36, v36
  v_rcp_f32 v37, v37
  v_rcp_f32 v38, v38
  v_rcp_f32 v39, v39
  v_mul_f32 v92, v92, v36
  v_mul_f32 v93, v93, v37
  v_mul_f32 v94, v94, v38
  v_mul_f32 v95, v95, v39
  v_cvt_pk_bf16_f32 v88, v88, v89
  v_cvt_pk_bf16_f32 v89, v90, v91
  v_cvt_pk_bf16_f32 v90, v92, v93
  v_cvt_pk_bf16_f32 v91, v94, v95
  s_mov_b32 s38, 31744
  buffer_store_dwordx4 v[88:91], v17, s[16:19], s38 offen sc1
L_end:
  s_endpgm
.section .rodata,"a"
.p2align 6
.amdhsa_kernel standalone__batchnorm__sampling_kernel
  .amdhsa_next_free_vgpr 512
  .amdhsa_next_free_sgpr 102
  .amdhsa_accum_offset 256
  .amdhsa_group_segment_fixed_size 0
  .amdhsa_kernarg_size 72
  .amdhsa_user_sgpr_count 2
  .amdhsa_user_sgpr_kernarg_segment_ptr 1
  .amdhsa_system_sgpr_workgroup_id_x 1
.end_amdhsa_kernel
```
